```python
import torch

def _softmax(x, axis=-1):
    return torch.softmax(x, dim=axis)
def _gelu(x):
    return torch.nn.functional.gelu(x, approximate="tanh")
def _silu(x):
    return torch.nn.functional.silu(x)
def _sigmoid(x):
    return torch.sigmoid(x)
def _layernorm(x, axis=-1, eps=1e-5):
    m = x.mean(dim=axis, keepdim=True)
    v = x.var(dim=axis, keepdim=True, unbiased=False)
    return (x - m) / torch.sqrt(v + eps)
def _scatter_add(tgt, idx, src, axis=0):
    return tgt.clone().index_add_(axis, idx, src)
def _segment_sum(src, seg, n):
    out = torch.zeros((n,) + src.shape[1:], dtype=src.dtype)
    return out.index_add_(0, seg, src)
def _pad(x, pw):
    flat = tuple(v for pair in reversed(pw) for v in pair)
    return torch.nn.functional.pad(x, flat)

kernel_name = 'gated_mix__spectral_fnet__mha_block__prompt'

def setup_inputs():

    _w = (lambda a: (lambda t: t.to(torch.bfloat16) if t.is_floating_point() else t)(torch.as_tensor(a)))
    def _A_setup():
        B, S, D = 1, 2048, 512
        ns = torch.arange(S)[:, None] * torch.arange(S)[None, :]
        nd = torch.arange(D)[:, None] * torch.arange(D)[None, :]
        Ws_re = torch.cos(-2.0 * torch.pi * ns / S).to(float)
        Ws_im = torch.sin(-2.0 * torch.pi * ns / S).to(float)
        Wd_re = torch.cos(-2.0 * torch.pi * nd / D).to(float)
        Wd_im = torch.sin(-2.0 * torch.pi * nd / D).to(float)
        return {
            "x": _w((lambda *s: torch.randn(*s, dtype=torch.bfloat16) * 0.05)(B, S, D)),
            "dft_seq_re": _w(Ws_re),
            "dft_seq_im": _w(Ws_im),
            "dft_hid_re": _w(Wd_re),
            "dft_hid_im": _w(Wd_im),
        }
    _A_in = _A_setup()

    def _B_setup():
        B, S, D, H = 1, 2048, 512, 32
        return {
            "x": _w((lambda *s: torch.randn(*s, dtype=torch.bfloat16) * 0.05)(B, S, D)),
            "wqkv": _w((lambda *s: torch.randn(*s, dtype=torch.bfloat16) * 1.6)(D, 3 * D)),
            "wo": _w((lambda *s: torch.randn(*s, dtype=torch.bfloat16) * 1.6)(D, D)),
        }
    _B_in = _B_setup()

    return {
        "A_x": _A_in["x"],
        "A_dft_seq_re": _A_in["dft_seq_re"],
        "A_dft_seq_im": _A_in["dft_seq_im"],
        "A_dft_hid_re": _A_in["dft_hid_re"],
        "A_dft_hid_im": _A_in["dft_hid_im"],
        "B_x": _B_in["x"],
        "B_wqkv": _B_in["wqkv"],
        "B_wo": _B_in["wo"],
        "gate_w": _w((lambda *s: torch.randn(*s, dtype=torch.bfloat16) * 0.05)(512) * 16.0),
    }

def reference(A_x, A_dft_seq_re, A_dft_seq_im, A_dft_hid_re, A_dft_hid_im, B_x, B_wqkv, B_wo, gate_w):
    def _A_ref(x, dft_seq_re, dft_seq_im, dft_hid_re, dft_hid_im):
        a = torch.einsum("bsd,ed->bse", x, dft_hid_re)
        b = torch.einsum("bsd,ed->bse", x, dft_hid_im)
        y = torch.einsum("ts,bse->bte", dft_seq_re, a) - torch.einsum("ts,bse->bte", dft_seq_im, b)
        return y

    def _B_ref(x, wqkv, wo):
        B, S, D = x.shape
        H = 32
        Dh = D // H
        qkv = (lambda x, *d: x.permute(*d))((x @ wqkv).reshape(B, S, 3, H, Dh), 2, 0, 3, 1, 4)
        q, k, v = qkv[0], qkv[1], qkv[2]
        scores = torch.einsum("bhqd,bhkd->bhqk", q, k) * (Dh ** -0.5)
        p = _softmax(scores, axis=-1)
        o = torch.einsum("bhqk,bhkd->bhqd", p, v)
        return (lambda x, *d: x.permute(*d))(o, 0, 2, 1, 3).reshape(B, S, D) @ wo

    x = A_x
    g = _sigmoid((x * gate_w).sum(-1, keepdims=True))
    a = _A_ref(x, A_dft_seq_re, A_dft_seq_im, A_dft_hid_re, A_dft_hid_im)
    b = _B_ref(x, B_wqkv, B_wo)
    return g * a + (1 - g) * b
```

```asm
; @launch grid=(256,1,1) block=(768,1,1) lds=163840
.amdgcn_target "amdgcn-amd-amdhsa--gfx950"
.text
.globl gated_mix__spectral_fnet__mha_block__prompt_kernel
.p2align 8
.type gated_mix__spectral_fnet__mha_block__prompt_kernel,@function
gated_mix__spectral_fnet__mha_block__prompt_kernel:
    s_cmp_ge_u32 s2, 256
    s_cbranch_scc1 done_1
    s_load_dwordx2 s[4:5], s[0:1], 0
    s_load_dwordx4 s[8:11], s[0:1], 24
    s_load_dwordx4 s[12:15], s[0:1], 48
    s_load_dwordx2 s[16:17], s[0:1], 64
    s_load_dwordx2 s[6:7], s[0:1], 72
    s_load_dwordx2 s[18:19], s[0:1], 88
    s_and_b32 s46, s2, 3
    s_lshl_b32 s46, s46, 2
    s_lshr_b32 s47, s2, 3
    s_and_b32 s48, s47, 3
    s_add_u32 s40, s46, s48
    s_lshr_b32 s47, s47, 2
    s_bfe_u32 s48, s2, 0x10002
    s_lshl_b32 s48, s48, 3
    s_add_u32 s41, s47, s48
    v_lshrrev_b32 v1, 6, v0
    v_and_b32 v2, 63, v0
    v_readfirstlane_b32 s42, v1
    s_nop 2
    s_and_b32 s43, s42, 3
    s_lshr_b32 s44, s42, 2
    s_lshl_b32 s51, s41, 2
    s_add_u32 s51, s51, s43
    s_cmp_ge_u32 s42, 8
    s_cbranch_scc1 P1_helper_4
    s_cmp_ge_u32 s42, 4
    s_cbranch_scc1 P1_loader_2
    s_and_b32 s46, s42, 1
    s_lshr_b32 s47, s42, 1
    v_and_b32 v4, 31, v2
    v_lshrrev_b32 v5, 5, v2
    v_lshrrev_b32 v6, 1, v4
    v_and_b32 v6, 7, v6
    v_lshlrev_b32 v7, 7, v4
    s_lshl_b32 s56, s46, 13
    v_add_u32 v8, 0, v5
    v_xor_b32 v8, v8, v6
    v_lshl_add_u32 v8, v8, 4, v7
    v_add_u32 v144, s56, v8
    v_add_u32 v148, 0x1000, v144
    v_add_u32 v152, 0x10000, v144
    v_add_u32 v156, 0x11000, v144
    v_add_u32 v160, 135168, v8
    v_add_u32 v8, 2, v5
    v_xor_b32 v8, v8, v6
    v_lshl_add_u32 v8, v8, 4, v7
    v_add_u32 v145, s56, v8
    v_add_u32 v149, 0x1000, v145
    v_add_u32 v153, 0x10000, v145
    v_add_u32 v157, 0x11000, v145
    v_add_u32 v161, 135168, v8
    v_add_u32 v8, 4, v5
    v_xor_b32 v8, v8, v6
    v_lshl_add_u32 v8, v8, 4, v7
    v_add_u32 v146, s56, v8
    v_add_u32 v150, 0x1000, v146
    v_add_u32 v154, 0x10000, v146
    v_add_u32 v158, 0x11000, v146
    v_add_u32 v162, 135168, v8
    v_add_u32 v8, 6, v5
    v_xor_b32 v8, v8, v6
    v_lshl_add_u32 v8, v8, 4, v7
    v_add_u32 v147, s56, v8
    v_add_u32 v151, 0x1000, v147
    v_add_u32 v155, 0x10000, v147
    v_add_u32 v159, 0x11000, v147
    v_add_u32 v163, 135168, v8
    v_lshrrev_b32 v8, 4, v2
    v_and_b32 v8, 1, v8
    v_and_b32 v9, 15, v2
    v_lshrrev_b32 v10, 2, v9
    v_and_b32 v9, 3, v9
    v_lshlrev_b32 v10, 6, v10
    v_lshl_add_u32 v10, v9, 3, v10
    v_lshl_add_u32 v10, v8, 5, v10
    v_add_u32 v10, 131072, v10
    v_lshl_add_u32 v165, v5, 9, v10
    v_lshl_add_u32 v164, v5, 10, v10
    s_lshl_b32 s56, s47, 8
    v_add_u32 v164, s56, v164
    v_mov_b32 v80, 0
    v_mov_b32 v81, 0
    v_mov_b32 v82, 0
    v_mov_b32 v83, 0
    v_mov_b32 v84, 0
    v_mov_b32 v85, 0
    v_mov_b32 v86, 0
    v_mov_b32 v87, 0
    v_mov_b32 v88, 0
    v_mov_b32 v89, 0
    v_mov_b32 v90, 0
    v_mov_b32 v91, 0
    v_mov_b32 v92, 0
    v_mov_b32 v93, 0
    v_mov_b32 v94, 0
    v_mov_b32 v95, 0
    v_mov_b32 v96, 0
    v_mov_b32 v97, 0
    v_mov_b32 v98, 0
    v_mov_b32 v99, 0
    v_mov_b32 v100, 0
    v_mov_b32 v101, 0
    v_mov_b32 v102, 0
    v_mov_b32 v103, 0
    v_mov_b32 v104, 0
    v_mov_b32 v105, 0
    v_mov_b32 v106, 0
    v_mov_b32 v107, 0
    v_mov_b32 v108, 0
    v_mov_b32 v109, 0
    v_mov_b32 v110, 0
    v_mov_b32 v111, 0
    v_mov_b32 v112, 0
    v_mov_b32 v113, 0
    v_mov_b32 v114, 0
    v_mov_b32 v115, 0
    v_mov_b32 v116, 0
    v_mov_b32 v117, 0
    v_mov_b32 v118, 0
    v_mov_b32 v119, 0
    v_mov_b32 v120, 0
    v_mov_b32 v121, 0
    v_mov_b32 v122, 0
    v_mov_b32 v123, 0
    v_mov_b32 v124, 0
    v_mov_b32 v125, 0
    v_mov_b32 v126, 0
    v_mov_b32 v127, 0
    v_mov_b32 v128, 0
    v_mov_b32 v129, 0
    v_mov_b32 v130, 0
    v_mov_b32 v131, 0
    v_mov_b32 v132, 0
    v_mov_b32 v133, 0
    v_mov_b32 v134, 0
    v_mov_b32 v135, 0
    v_mov_b32 v136, 0
    v_mov_b32 v137, 0
    v_mov_b32 v138, 0
    v_mov_b32 v139, 0
    v_mov_b32 v140, 0
    v_mov_b32 v141, 0
    v_mov_b32 v142, 0
    v_mov_b32 v143, 0
    v_lshlrev_b32 v3, 4, v2
    s_waitcnt lgkmcnt(0)
    s_mov_b32 s28, s18
    s_and_b32 s29, s19, 0xffff
    s_mov_b32 s30, 0x1100000
    s_mov_b32 s31, 0x20000
    s_lshl_b32 s58, s40, 4
    s_add_u32 s58, s58, s41
    s_lshl_b32 s58, s58, 15
    s_add_u32 s55, s58, 16384
    s_lshl_b32 s59, s46, 12
    s_add_u32 s58, s58, s59
    s_cmp_eq_u32 s47, 1
    s_cbranch_scc1 P1_vz2_5
    s_barrier
    ds_read_b128 v[16:19], v144 offset:0
    ds_read_b128 v[20:23], v148 offset:0
    ds_read_b64_tr_b16 v[32:33], v164 offset:0
    ds_read_b64_tr_b16 v[34:35], v164 offset:512
    ds_read_b128 v[24:27], v145 offset:0
    ds_read_b128 v[28:31], v149 offset:0
    ds_read_b64_tr_b16 v[36:37], v164 offset:2048
    ds_read_b64_tr_b16 v[38:39], v164 offset:2560
    s_waitcnt lgkmcnt(4)
    v_mfma_f32_32x32x16_bf16 v[80:95], v[32:35], v[16:19], v[80:95]
    v_mfma_f32_32x32x16_bf16 v[96:111], v[32:35], v[20:23], v[96:111]
    ds_read_b128 v[16:19], v146 offset:0
    ds_read_b128 v[20:23], v150 offset:0
    ds_read_b64_tr_b16 v[32:33], v164 offset:4096
    ds_read_b64_tr_b16 v[34:35], v164 offset:4608
    s_waitcnt lgkmcnt(4)
    v_mfma_f32_32x32x16_bf16 v[80:95], v[36:39], v[24:27], v[80:95]
    v_mfma_f32_32x32x16_bf16 v[96:111], v[36:39], v[28:31], v[96:111]
    ds_read_b128 v[24:27], v147 offset:0
    ds_read_b128 v[28:31], v151 offset:0
    ds_read_b64_tr_b16 v[36:37], v164 offset:6144
    ds_read_b64_tr_b16 v[38:39], v164 offset:6656
    s_barrier
    s_waitcnt lgkmcnt(4)
    v_mfma_f32_32x32x16_bf16 v[80:95], v[32:35], v[16:19], v[80:95]
    v_mfma_f32_32x32x16_bf16 v[96:111], v[32:35], v[20:23], v[96:111]
    ds_read_b128 v[16:19], v144 offset:16384
    ds_read_b128 v[20:23], v148 offset:16384
    ds_read_b64_tr_b16 v[32:33], v164 offset:8192
    ds_read_b64_tr_b16 v[34:35], v164 offset:8704
    s_waitcnt lgkmcnt(4)
    v_mfma_f32_32x32x16_bf16 v[80:95], v[36:39], v[24:27], v[80:95]
    v_mfma_f32_32x32x16_bf16 v[96:111], v[36:39], v[28:31], v[96:111]
    ds_read_b128 v[24:27], v145 offset:16384
    ds_read_b128 v[28:31], v149 offset:16384
    ds_read_b64_tr_b16 v[36:37], v164 offset:10240
    ds_read_b64_tr_b16 v[38:39], v164 offset:10752
    s_waitcnt lgkmcnt(4)
    v_mfma_f32_32x32x16_bf16 v[80:95], v[32:35], v[16:19], v[80:95]
    v_mfma_f32_32x32x16_bf16 v[96:111], v[32:35], v[20:23], v[96:111]
    ds_read_b128 v[16:19], v146 offset:16384
    ds_read_b128 v[20:23], v150 offset:16384
    ds_read_b64_tr_b16 v[32:33], v164 offset:12288
    ds_read_b64_tr_b16 v[34:35], v164 offset:12800
    s_waitcnt lgkmcnt(4)
    v_mfma_f32_32x32x16_bf16 v[80:95], v[36:39], v[24:27], v[80:95]
    v_mfma_f32_32x32x16_bf16 v[96:111], v[36:39], v[28:31], v[96:111]
    ds_read_b128 v[24:27], v147 offset:16384
    ds_read_b128 v[28:31], v151 offset:16384
    ds_read_b64_tr_b16 v[36:37], v164 offset:14336
    ds_read_b64_tr_b16 v[38:39], v164 offset:14848
    s_barrier
    s_waitcnt lgkmcnt(4)
    v_mfma_f32_32x32x16_bf16 v[80:95], v[32:35], v[16:19], v[80:95]
    v_mfma_f32_32x32x16_bf16 v[96:111], v[32:35], v[20:23], v[96:111]
    ds_read_b128 v[16:19], v144 offset:32768
    ds_read_b128 v[20:23], v148 offset:32768
    ds_read_b64_tr_b16 v[32:33], v164 offset:16384
    ds_read_b64_tr_b16 v[34:35], v164 offset:16896
    s_waitcnt lgkmcnt(4)
    v_mfma_f32_32x32x16_bf16 v[80:95], v[36:39], v[24:27], v[80:95]
    v_mfma_f32_32x32x16_bf16 v[96:111], v[36:39], v[28:31], v[96:111]
    ds_read_b128 v[24:27], v145 offset:32768
    ds_read_b128 v[28:31], v149 offset:32768
    ds_read_b64_tr_b16 v[36:37], v164 offset:18432
    ds_read_b64_tr_b16 v[38:39], v164 offset:18944
    s_waitcnt lgkmcnt(4)
    v_mfma_f32_32x32x16_bf16 v[80:95], v[32:35], v[16:19], v[80:95]
    v_mfma_f32_32x32x16_bf16 v[96:111], v[32:35], v[20:23], v[96:111]
    ds_read_b128 v[16:19], v146 offset:32768
    ds_read_b128 v[20:23], v150 offset:32768
    ds_read_b64_tr_b16 v[32:33], v164 offset:20480
    ds_read_b64_tr_b16 v[34:35], v164 offset:20992
    s_waitcnt lgkmcnt(4)
    v_mfma_f32_32x32x16_bf16 v[80:95], v[36:39], v[24:27], v[80:95]
    v_mfma_f32_32x32x16_bf16 v[96:111], v[36:39], v[28:31], v[96:111]
    ds_read_b128 v[24:27], v147 offset:32768
    ds_read_b128 v[28:31], v151 offset:32768
    ds_read_b64_tr_b16 v[36:37], v164 offset:22528
    ds_read_b64_tr_b16 v[38:39], v164 offset:23040
    s_barrier
    s_waitcnt lgkmcnt(4)
    v_mfma_f32_32x32x16_bf16 v[80:95], v[32:35], v[16:19], v[80:95]
    v_mfma_f32_32x32x16_bf16 v[96:111], v[32:35], v[20:23], v[96:111]
    ds_read_b128 v[16:19], v144 offset:49152
    ds_read_b128 v[20:23], v148 offset:49152
    ds_read_b64_tr_b16 v[32:33], v164 offset:24576
    ds_read_b64_tr_b16 v[34:35], v164 offset:25088
    s_waitcnt lgkmcnt(4)
    v_mfma_f32_32x32x16_bf16 v[80:95], v[36:39], v[24:27], v[80:95]
    v_mfma_f32_32x32x16_bf16 v[96:111], v[36:39], v[28:31], v[96:111]
    ds_read_b128 v[24:27], v145 offset:49152
    ds_read_b128 v[28:31], v149 offset:49152
    ds_read_b64_tr_b16 v[36:37], v164 offset:26624
    ds_read_b64_tr_b16 v[38:39], v164 offset:27136
    s_waitcnt lgkmcnt(4)
    v_mfma_f32_32x32x16_bf16 v[80:95], v[32:35], v[16:19], v[80:95]
    v_mfma_f32_32x32x16_bf16 v[96:111], v[32:35], v[20:23], v[96:111]
    ds_read_b128 v[16:19], v146 offset:49152
    ds_read_b128 v[20:23], v150 offset:49152
    ds_read_b64_tr_b16 v[32:33], v164 offset:28672
    ds_read_b64_tr_b16 v[34:35], v164 offset:29184
    s_waitcnt lgkmcnt(4)
    v_mfma_f32_32x32x16_bf16 v[80:95], v[36:39], v[24:27], v[80:95]
    v_mfma_f32_32x32x16_bf16 v[96:111], v[36:39], v[28:31], v[96:111]
    ds_read_b128 v[24:27], v147 offset:49152
    ds_read_b128 v[28:31], v151 offset:49152
    ds_read_b64_tr_b16 v[36:37], v164 offset:30720
    ds_read_b64_tr_b16 v[38:39], v164 offset:31232
    s_barrier
    s_waitcnt lgkmcnt(4)
    v_mfma_f32_32x32x16_bf16 v[80:95], v[32:35], v[16:19], v[80:95]
    v_mfma_f32_32x32x16_bf16 v[96:111], v[32:35], v[20:23], v[96:111]
    ds_read_b128 v[16:19], v152 offset:0
    ds_read_b128 v[20:23], v156 offset:0
    ds_read_b64_tr_b16 v[32:33], v164 offset:0
    ds_read_b64_tr_b16 v[34:35], v164 offset:512
    s_waitcnt lgkmcnt(4)
    v_mfma_f32_32x32x16_bf16 v[80:95], v[36:39], v[24:27], v[80:95]
    v_mfma_f32_32x32x16_bf16 v[96:111], v[36:39], v[28:31], v[96:111]
    ds_read_b128 v[24:27], v153 offset:0
    ds_read_b128 v[28:31], v157 offset:0
    ds_read_b64_tr_b16 v[36:37], v164 offset:2048
    ds_read_b64_tr_b16 v[38:39], v164 offset:2560
    s_waitcnt lgkmcnt(4)
    v_mfma_f32_32x32x16_bf16 v[80:95], v[32:35], v[16:19], v[80:95]
    v_mfma_f32_32x32x16_bf16 v[96:111], v[32:35], v[20:23], v[96:111]
    ds_read_b128 v[16:19], v154 offset:0
    ds_read_b128 v[20:23], v158 offset:0
    ds_read_b64_tr_b16 v[32:33], v164 offset:4096
    ds_read_b64_tr_b16 v[34:35], v164 offset:4608
    s_waitcnt lgkmcnt(4)
    v_mfma_f32_32x32x16_bf16 v[80:95], v[36:39], v[24:27], v[80:95]
    v_mfma_f32_32x32x16_bf16 v[96:111], v[36:39], v[28:31], v[96:111]
    ds_read_b128 v[24:27], v155 offset:0
    ds_read_b128 v[28:31], v159 offset:0
    ds_read_b64_tr_b16 v[36:37], v164 offset:6144
    ds_read_b64_tr_b16 v[38:39], v164 offset:6656
    s_barrier
    s_waitcnt lgkmcnt(4)
    v_mfma_f32_32x32x16_bf16 v[80:95], v[32:35], v[16:19], v[80:95]
    v_mfma_f32_32x32x16_bf16 v[96:111], v[32:35], v[20:23], v[96:111]
    ds_read_b128 v[16:19], v152 offset:16384
    ds_read_b128 v[20:23], v156 offset:16384
    ds_read_b64_tr_b16 v[32:33], v164 offset:8192
    ds_read_b64_tr_b16 v[34:35], v164 offset:8704
    s_waitcnt lgkmcnt(4)
    v_mfma_f32_32x32x16_bf16 v[80:95], v[36:39], v[24:27], v[80:95]
    v_mfma_f32_32x32x16_bf16 v[96:111], v[36:39], v[28:31], v[96:111]
    ds_read_b128 v[24:27], v153 offset:16384
    ds_read_b128 v[28:31], v157 offset:16384
    ds_read_b64_tr_b16 v[36:37], v164 offset:10240
    ds_read_b64_tr_b16 v[38:39], v164 offset:10752
    s_waitcnt lgkmcnt(4)
    v_mfma_f32_32x32x16_bf16 v[80:95], v[32:35], v[16:19], v[80:95]
    v_mfma_f32_32x32x16_bf16 v[96:111], v[32:35], v[20:23], v[96:111]
    ds_read_b128 v[16:19], v154 offset:16384
    ds_read_b128 v[20:23], v158 offset:16384
    ds_read_b64_tr_b16 v[32:33], v164 offset:12288
    ds_read_b64_tr_b16 v[34:35], v164 offset:12800
    s_waitcnt lgkmcnt(4)
    v_mfma_f32_32x32x16_bf16 v[80:95], v[36:39], v[24:27], v[80:95]
    v_mfma_f32_32x32x16_bf16 v[96:111], v[36:39], v[28:31], v[96:111]
    ds_read_b128 v[24:27], v155 offset:16384
    ds_read_b128 v[28:31], v159 offset:16384
    ds_read_b64_tr_b16 v[36:37], v164 offset:14336
    ds_read_b64_tr_b16 v[38:39], v164 offset:14848
    s_barrier
    s_waitcnt lgkmcnt(4)
    v_mfma_f32_32x32x16_bf16 v[80:95], v[32:35], v[16:19], v[80:95]
    v_mfma_f32_32x32x16_bf16 v[96:111], v[32:35], v[20:23], v[96:111]
    ds_read_b128 v[16:19], v152 offset:32768
    ds_read_b128 v[20:23], v156 offset:32768
    ds_read_b64_tr_b16 v[32:33], v164 offset:16384
    ds_read_b64_tr_b16 v[34:35], v164 offset:16896
    s_waitcnt lgkmcnt(4)
    v_mfma_f32_32x32x16_bf16 v[80:95], v[36:39], v[24:27], v[80:95]
    v_mfma_f32_32x32x16_bf16 v[96:111], v[36:39], v[28:31], v[96:111]
    ds_read_b128 v[24:27], v153 offset:32768
    ds_read_b128 v[28:31], v157 offset:32768
    ds_read_b64_tr_b16 v[36:37], v164 offset:18432
    ds_read_b64_tr_b16 v[38:39], v164 offset:18944
    s_waitcnt lgkmcnt(4)
    v_mfma_f32_32x32x16_bf16 v[80:95], v[32:35], v[16:19], v[80:95]
    v_mfma_f32_32x32x16_bf16 v[96:111], v[32:35], v[20:23], v[96:111]
    ds_read_b128 v[16:19], v154 offset:32768
    ds_read_b128 v[20:23], v158 offset:32768
    ds_read_b64_tr_b16 v[32:33], v164 offset:20480
    ds_read_b64_tr_b16 v[34:35], v164 offset:20992
    s_waitcnt lgkmcnt(4)
    v_mfma_f32_32x32x16_bf16 v[80:95], v[36:39], v[24:27], v[80:95]
    v_mfma_f32_32x32x16_bf16 v[96:111], v[36:39], v[28:31], v[96:111]
    ds_read_b128 v[24:27], v155 offset:32768
    ds_read_b128 v[28:31], v159 offset:32768
    ds_read_b64_tr_b16 v[36:37], v164 offset:22528
    ds_read_b64_tr_b16 v[38:39], v164 offset:23040
    s_barrier
    s_waitcnt lgkmcnt(4)
    v_mfma_f32_32x32x16_bf16 v[80:95], v[32:35], v[16:19], v[80:95]
    v_mfma_f32_32x32x16_bf16 v[96:111], v[32:35], v[20:23], v[96:111]
    ds_read_b128 v[16:19], v152 offset:49152
    ds_read_b128 v[20:23], v156 offset:49152
    ds_read_b64_tr_b16 v[32:33], v164 offset:24576
    ds_read_b64_tr_b16 v[34:35], v164 offset:25088
    s_waitcnt lgkmcnt(4)
    v_mfma_f32_32x32x16_bf16 v[80:95], v[36:39], v[24:27], v[80:95]
    v_mfma_f32_32x32x16_bf16 v[96:111], v[36:39], v[28:31], v[96:111]
    ds_read_b128 v[24:27], v153 offset:49152
    ds_read_b128 v[28:31], v157 offset:49152
    ds_read_b64_tr_b16 v[36:37], v164 offset:26624
    ds_read_b64_tr_b16 v[38:39], v164 offset:27136
    s_waitcnt lgkmcnt(4)
    v_mfma_f32_32x32x16_bf16 v[80:95], v[32:35], v[16:19], v[80:95]
    v_mfma_f32_32x32x16_bf16 v[96:111], v[32:35], v[20:23], v[96:111]
    ds_read_b128 v[16:19], v154 offset:49152
    ds_read_b128 v[20:23], v158 offset:49152
    ds_read_b64_tr_b16 v[32:33], v164 offset:28672
    ds_read_b64_tr_b16 v[34:35], v164 offset:29184
    s_waitcnt lgkmcnt(4)
    v_mfma_f32_32x32x16_bf16 v[80:95], v[36:39], v[24:27], v[80:95]
    v_mfma_f32_32x32x16_bf16 v[96:111], v[36:39], v[28:31], v[96:111]
    ds_read_b128 v[24:27], v155 offset:49152
    ds_read_b128 v[28:31], v159 offset:49152
    ds_read_b64_tr_b16 v[36:37], v164 offset:30720
    ds_read_b64_tr_b16 v[38:39], v164 offset:31232
    s_barrier
    s_waitcnt lgkmcnt(4)
    v_mfma_f32_32x32x16_bf16 v[80:95], v[32:35], v[16:19], v[80:95]
    v_mfma_f32_32x32x16_bf16 v[96:111], v[32:35], v[20:23], v[96:111]
    ds_read_b128 v[16:19], v144 offset:0
    ds_read_b128 v[20:23], v148 offset:0
    ds_read_b64_tr_b16 v[32:33], v165 offset:0
    ds_read_b64_tr_b16 v[34:35], v165 offset:256
    s_waitcnt lgkmcnt(4)
    v_mfma_f32_32x32x16_bf16 v[80:95], v[36:39], v[24:27], v[80:95]
    v_mfma_f32_32x32x16_bf16 v[96:111], v[36:39], v[28:31], v[96:111]
    ds_read_b128 v[24:27], v145 offset:0
    ds_read_b128 v[28:31], v149 offset:0
    ds_read_b64_tr_b16 v[36:37], v165 offset:1024
    ds_read_b64_tr_b16 v[38:39], v165 offset:1280
    s_waitcnt lgkmcnt(4)
    v_mfma_f32_32x32x16_bf16 v[112:127], v[32:35], v[16:19], v[112:127]
    v_mfma_f32_32x32x16_bf16 v[128:143], v[32:35], v[20:23], v[128:143]
    ds_read_b128 v[16:19], v146 offset:0
    ds_read_b128 v[20:23], v150 offset:0
    ds_read_b64_tr_b16 v[32:33], v165 offset:2048
    ds_read_b64_tr_b16 v[34:35], v165 offset:2304
    s_waitcnt lgkmcnt(4)
    v_mfma_f32_32x32x16_bf16 v[112:127], v[36:39], v[24:27], v[112:127]
    v_mfma_f32_32x32x16_bf16 v[128:143], v[36:39], v[28:31], v[128:143]
    ds_read_b128 v[24:27], v147 offset:0
    ds_read_b128 v[28:31], v151 offset:0
    ds_read_b64_tr_b16 v[36:37], v165 offset:3072
    ds_read_b64_tr_b16 v[38:39], v165 offset:3328
    v_cvt_pk_bf16_f32 v48, v80, v81
    v_cvt_pk_bf16_f32 v49, v82, v83
    v_cvt_pk_bf16_f32 v50, v84, v85
    v_cvt_pk_bf16_f32 v51, v86, v87
    buffer_store_dwordx4 v[48:51], v3, s[28:31], s58 offen offset:0 sc1
    v_cvt_pk_bf16_f32 v56, v88, v89
    v_cvt_pk_bf16_f32 v57, v90, v91
    v_cvt_pk_bf16_f32 v58, v92, v93
    v_cvt_pk_bf16_f32 v59, v94, v95
    s_add_u32 s57, s58, 8192
    buffer_store_dwordx4 v[56:59], v3, s[28:31], s57 offen offset:0 sc1
    v_cvt_pk_bf16_f32 v52, v96, v97
    v_cvt_pk_bf16_f32 v53, v98, v99
    v_cvt_pk_bf16_f32 v54, v100, v101
    v_cvt_pk_bf16_f32 v55, v102, v103
    buffer_store_dwordx4 v[52:55], v3, s[28:31], s58 offen offset:2048 sc1
    v_cvt_pk_bf16_f32 v60, v104, v105
    v_cvt_pk_bf16_f32 v61, v106, v107
    v_cvt_pk_bf16_f32 v62, v108, v109
    v_cvt_pk_bf16_f32 v63, v110, v111
    s_add_u32 s57, s58, 8192
    buffer_store_dwordx4 v[60:63], v3, s[28:31], s57 offen offset:2048 sc1
    s_barrier
    s_waitcnt lgkmcnt(4)
    v_mfma_f32_32x32x16_bf16 v[112:127], v[32:35], v[16:19], v[112:127]
    v_mfma_f32_32x32x16_bf16 v[128:143], v[32:35], v[20:23], v[128:143]
    ds_read_b128 v[16:19], v144 offset:16384
    ds_read_b128 v[20:23], v148 offset:16384
    ds_read_b64_tr_b16 v[32:33], v165 offset:8192
    ds_read_b64_tr_b16 v[34:35], v165 offset:8448
    s_waitcnt lgkmcnt(4)
    v_mfma_f32_32x32x16_bf16 v[112:127], v[36:39], v[24:27], v[112:127]
    v_mfma_f32_32x32x16_bf16 v[128:143], v[36:39], v[28:31], v[128:143]
    ds_read_b128 v[24:27], v145 offset:16384
    ds_read_b128 v[28:31], v149 offset:16384
    ds_read_b64_tr_b16 v[36:37], v165 offset:9216
    ds_read_b64_tr_b16 v[38:39], v165 offset:9472
    s_waitcnt lgkmcnt(4)
    v_mfma_f32_32x32x16_bf16 v[112:127], v[32:35], v[16:19], v[112:127]
    v_mfma_f32_32x32x16_bf16 v[128:143], v[32:35], v[20:23], v[128:143]
    ds_read_b128 v[16:19], v146 offset:16384
    ds_read_b128 v[20:23], v150 offset:16384
    ds_read_b64_tr_b16 v[32:33], v165 offset:10240
    ds_read_b64_tr_b16 v[34:35], v165 offset:10496
    s_waitcnt lgkmcnt(4)
    v_mfma_f32_32x32x16_bf16 v[112:127], v[36:39], v[24:27], v[112:127]
    v_mfma_f32_32x32x16_bf16 v[128:143], v[36:39], v[28:31], v[128:143]
    ds_read_b128 v[24:27], v147 offset:16384
    ds_read_b128 v[28:31], v151 offset:16384
    ds_read_b64_tr_b16 v[36:37], v165 offset:11264
    ds_read_b64_tr_b16 v[38:39], v165 offset:11520
    s_barrier
    s_waitcnt lgkmcnt(4)
    v_mfma_f32_32x32x16_bf16 v[112:127], v[32:35], v[16:19], v[112:127]
    v_mfma_f32_32x32x16_bf16 v[128:143], v[32:35], v[20:23], v[128:143]
    ds_read_b128 v[16:19], v144 offset:32768
    ds_read_b128 v[20:23], v148 offset:32768
    ds_read_b64_tr_b16 v[32:33], v165 offset:16384
    ds_read_b64_tr_b16 v[34:35], v165 offset:16640
    s_waitcnt lgkmcnt(4)
    v_mfma_f32_32x32x16_bf16 v[112:127], v[36:39], v[24:27], v[112:127]
    v_mfma_f32_32x32x16_bf16 v[128:143], v[36:39], v[28:31], v[128:143]
    ds_read_b128 v[24:27], v145 offset:32768
    ds_read_b128 v[28:31], v149 offset:32768
    ds_read_b64_tr_b16 v[36:37], v165 offset:17408
    ds_read_b64_tr_b16 v[38:39], v165 offset:17664
    s_waitcnt lgkmcnt(4)
    v_mfma_f32_32x32x16_bf16 v[112:127], v[32:35], v[16:19], v[112:127]
    v_mfma_f32_32x32x16_bf16 v[128:143], v[32:35], v[20:23], v[128:143]
    ds_read_b128 v[16:19], v146 offset:32768
    ds_read_b128 v[20:23], v150 offset:32768
    ds_read_b64_tr_b16 v[32:33], v165 offset:18432
    ds_read_b64_tr_b16 v[34:35], v165 offset:18688
    s_waitcnt lgkmcnt(4)
    v_mfma_f32_32x32x16_bf16 v[112:127], v[36:39], v[24:27], v[112:127]
    v_mfma_f32_32x32x16_bf16 v[128:143], v[36:39], v[28:31], v[128:143]
    ds_read_b128 v[24:27], v147 offset:32768
    ds_read_b128 v[28:31], v151 offset:32768
    ds_read_b64_tr_b16 v[36:37], v165 offset:19456
    ds_read_b64_tr_b16 v[38:39], v165 offset:19712
    s_barrier
    s_waitcnt lgkmcnt(4)
    v_mfma_f32_32x32x16_bf16 v[112:127], v[32:35], v[16:19], v[112:127]
    v_mfma_f32_32x32x16_bf16 v[128:143], v[32:35], v[20:23], v[128:143]
    ds_read_b128 v[16:19], v144 offset:49152
    ds_read_b128 v[20:23], v148 offset:49152
    ds_read_b64_tr_b16 v[32:33], v165 offset:24576
    ds_read_b64_tr_b16 v[34:35], v165 offset:24832
    s_waitcnt lgkmcnt(4)
    v_mfma_f32_32x32x16_bf16 v[112:127], v[36:39], v[24:27], v[112:127]
    v_mfma_f32_32x32x16_bf16 v[128:143], v[36:39], v[28:31], v[128:143]
    ds_read_b128 v[24:27], v145 offset:49152
    ds_read_b128 v[28:31], v149 offset:49152
    ds_read_b64_tr_b16 v[36:37], v165 offset:25600
    ds_read_b64_tr_b16 v[38:39], v165 offset:25856
    s_waitcnt lgkmcnt(4)
    v_mfma_f32_32x32x16_bf16 v[112:127], v[32:35], v[16:19], v[112:127]
    v_mfma_f32_32x32x16_bf16 v[128:143], v[32:35], v[20:23], v[128:143]
    ds_read_b128 v[16:19], v146 offset:49152
    ds_read_b128 v[20:23], v150 offset:49152
    ds_read_b64_tr_b16 v[32:33], v165 offset:26624
    ds_read_b64_tr_b16 v[34:35], v165 offset:26880
    s_waitcnt lgkmcnt(4)
    v_mfma_f32_32x32x16_bf16 v[112:127], v[36:39], v[24:27], v[112:127]
    v_mfma_f32_32x32x16_bf16 v[128:143], v[36:39], v[28:31], v[128:143]
    ds_read_b128 v[24:27], v147 offset:49152
    ds_read_b128 v[28:31], v151 offset:49152
    ds_read_b64_tr_b16 v[36:37], v165 offset:27648
    ds_read_b64_tr_b16 v[38:39], v165 offset:27904
    s_barrier
    s_waitcnt lgkmcnt(4)
    v_mfma_f32_32x32x16_bf16 v[112:127], v[32:35], v[16:19], v[112:127]
    v_mfma_f32_32x32x16_bf16 v[128:143], v[32:35], v[20:23], v[128:143]
    ds_read_b128 v[16:19], v152 offset:0
    ds_read_b128 v[20:23], v156 offset:0
    ds_read_b64_tr_b16 v[32:33], v165 offset:0
    ds_read_b64_tr_b16 v[34:35], v165 offset:256
    s_waitcnt lgkmcnt(4)
    v_mfma_f32_32x32x16_bf16 v[112:127], v[36:39], v[24:27], v[112:127]
    v_mfma_f32_32x32x16_bf16 v[128:143], v[36:39], v[28:31], v[128:143]
    ds_read_b128 v[24:27], v153 offset:0
    ds_read_b128 v[28:31], v157 offset:0
    ds_read_b64_tr_b16 v[36:37], v165 offset:1024
    ds_read_b64_tr_b16 v[38:39], v165 offset:1280
    s_waitcnt lgkmcnt(4)
    v_mfma_f32_32x32x16_bf16 v[112:127], v[32:35], v[16:19], v[112:127]
    v_mfma_f32_32x32x16_bf16 v[128:143], v[32:35], v[20:23], v[128:143]
    ds_read_b128 v[16:19], v154 offset:0
    ds_read_b128 v[20:23], v158 offset:0
    ds_read_b64_tr_b16 v[32:33], v165 offset:2048
    ds_read_b64_tr_b16 v[34:35], v165 offset:2304
    s_waitcnt lgkmcnt(4)
    v_mfma_f32_32x32x16_bf16 v[112:127], v[36:39], v[24:27], v[112:127]
    v_mfma_f32_32x32x16_bf16 v[128:143], v[36:39], v[28:31], v[128:143]
    ds_read_b128 v[24:27], v155 offset:0
    ds_read_b128 v[28:31], v159 offset:0
    ds_read_b64_tr_b16 v[36:37], v165 offset:3072
    ds_read_b64_tr_b16 v[38:39], v165 offset:3328
    s_barrier
    s_waitcnt lgkmcnt(4)
    v_mfma_f32_32x32x16_bf16 v[112:127], v[32:35], v[16:19], v[112:127]
    v_mfma_f32_32x32x16_bf16 v[128:143], v[32:35], v[20:23], v[128:143]
    ds_read_b128 v[16:19], v152 offset:16384
    ds_read_b128 v[20:23], v156 offset:16384
    ds_read_b64_tr_b16 v[32:33], v165 offset:8192
    ds_read_b64_tr_b16 v[34:35], v165 offset:8448
    s_waitcnt lgkmcnt(4)
    v_mfma_f32_32x32x16_bf16 v[112:127], v[36:39], v[24:27], v[112:127]
    v_mfma_f32_32x32x16_bf16 v[128:143], v[36:39], v[28:31], v[128:143]
    ds_read_b128 v[24:27], v153 offset:16384
    ds_read_b128 v[28:31], v157 offset:16384
    ds_read_b64_tr_b16 v[36:37], v165 offset:9216
    ds_read_b64_tr_b16 v[38:39], v165 offset:9472
    s_waitcnt lgkmcnt(4)
    v_mfma_f32_32x32x16_bf16 v[112:127], v[32:35], v[16:19], v[112:127]
    v_mfma_f32_32x32x16_bf16 v[128:143], v[32:35], v[20:23], v[128:143]
    ds_read_b128 v[16:19], v154 offset:16384
    ds_read_b128 v[20:23], v158 offset:16384
    ds_read_b64_tr_b16 v[32:33], v165 offset:10240
    ds_read_b64_tr_b16 v[34:35], v165 offset:10496
    s_waitcnt lgkmcnt(4)
    v_mfma_f32_32x32x16_bf16 v[112:127], v[36:39], v[24:27], v[112:127]
    v_mfma_f32_32x32x16_bf16 v[128:143], v[36:39], v[28:31], v[128:143]
    ds_read_b128 v[24:27], v155 offset:16384
    ds_read_b128 v[28:31], v159 offset:16384
    ds_read_b64_tr_b16 v[36:37], v165 offset:11264
    ds_read_b64_tr_b16 v[38:39], v165 offset:11520
    s_waitcnt vmcnt(0)
    s_barrier
    s_waitcnt lgkmcnt(4)
    v_mfma_f32_32x32x16_bf16 v[112:127], v[32:35], v[16:19], v[112:127]
    v_mfma_f32_32x32x16_bf16 v[128:143], v[32:35], v[20:23], v[128:143]
    ds_read_b128 v[16:19], v152 offset:32768
    ds_read_b128 v[20:23], v156 offset:32768
    ds_read_b64_tr_b16 v[32:33], v165 offset:16384
    ds_read_b64_tr_b16 v[34:35], v165 offset:16640
    s_waitcnt lgkmcnt(4)
    v_mfma_f32_32x32x16_bf16 v[112:127], v[36:39], v[24:27], v[112:127]
    v_mfma_f32_32x32x16_bf16 v[128:143], v[36:39], v[28:31], v[128:143]
    ds_read_b128 v[24:27], v153 offset:32768
    ds_read_b128 v[28:31], v157 offset:32768
    ds_read_b64_tr_b16 v[36:37], v165 offset:17408
    ds_read_b64_tr_b16 v[38:39], v165 offset:17664
    s_waitcnt lgkmcnt(4)
    v_mfma_f32_32x32x16_bf16 v[112:127], v[32:35], v[16:19], v[112:127]
    v_mfma_f32_32x32x16_bf16 v[128:143], v[32:35], v[20:23], v[128:143]
    ds_read_b128 v[16:19], v154 offset:32768
    ds_read_b128 v[20:23], v158 offset:32768
    ds_read_b64_tr_b16 v[32:33], v165 offset:18432
    ds_read_b64_tr_b16 v[34:35], v165 offset:18688
    s_waitcnt lgkmcnt(4)
    v_mfma_f32_32x32x16_bf16 v[112:127], v[36:39], v[24:27], v[112:127]
    v_mfma_f32_32x32x16_bf16 v[128:143], v[36:39], v[28:31], v[128:143]
    ds_read_b128 v[24:27], v155 offset:32768
    ds_read_b128 v[28:31], v159 offset:32768
    ds_read_b64_tr_b16 v[36:37], v165 offset:19456
    ds_read_b64_tr_b16 v[38:39], v165 offset:19712
    s_barrier
    s_waitcnt lgkmcnt(4)
    v_mfma_f32_32x32x16_bf16 v[112:127], v[32:35], v[16:19], v[112:127]
    v_mfma_f32_32x32x16_bf16 v[128:143], v[32:35], v[20:23], v[128:143]
    ds_read_b128 v[16:19], v152 offset:49152
    ds_read_b128 v[20:23], v156 offset:49152
    ds_read_b64_tr_b16 v[32:33], v165 offset:24576
    ds_read_b64_tr_b16 v[34:35], v165 offset:24832
    s_waitcnt lgkmcnt(4)
    v_mfma_f32_32x32x16_bf16 v[112:127], v[36:39], v[24:27], v[112:127]
    v_mfma_f32_32x32x16_bf16 v[128:143], v[36:39], v[28:31], v[128:143]
    ds_read_b128 v[24:27], v153 offset:49152
    ds_read_b128 v[28:31], v157 offset:49152
    ds_read_b64_tr_b16 v[36:37], v165 offset:25600
    ds_read_b64_tr_b16 v[38:39], v165 offset:25856
    s_waitcnt lgkmcnt(4)
    v_mfma_f32_32x32x16_bf16 v[112:127], v[32:35], v[16:19], v[112:127]
    v_mfma_f32_32x32x16_bf16 v[128:143], v[32:35], v[20:23], v[128:143]
    ds_read_b128 v[16:19], v154 offset:49152
    ds_read_b128 v[20:23], v158 offset:49152
    ds_read_b64_tr_b16 v[32:33], v165 offset:26624
    ds_read_b64_tr_b16 v[34:35], v165 offset:26880
    s_waitcnt lgkmcnt(4)
    v_mfma_f32_32x32x16_bf16 v[112:127], v[36:39], v[24:27], v[112:127]
    v_mfma_f32_32x32x16_bf16 v[128:143], v[36:39], v[28:31], v[128:143]
    ds_read_b128 v[24:27], v155 offset:49152
    ds_read_b128 v[28:31], v159 offset:49152
    ds_read_b64_tr_b16 v[36:37], v165 offset:27648
    ds_read_b64_tr_b16 v[38:39], v165 offset:27904
    s_waitcnt lgkmcnt(4)
    v_mfma_f32_32x32x16_bf16 v[112:127], v[32:35], v[16:19], v[112:127]
    v_mfma_f32_32x32x16_bf16 v[128:143], v[32:35], v[20:23], v[128:143]
    s_waitcnt lgkmcnt(0)
    v_mfma_f32_32x32x16_bf16 v[112:127], v[36:39], v[24:27], v[112:127]
    v_mfma_f32_32x32x16_bf16 v[128:143], v[36:39], v[28:31], v[128:143]
    s_mov_b32 s56, 0x3eb8aa3b
    s_nop 9
    v_mul_f32 v112, s56, v112
    v_mul_f32 v113, s56, v113
    v_mul_f32 v114, s56, v114
    v_mul_f32 v115, s56, v115
    v_mul_f32 v116, s56, v116
    v_mul_f32 v117, s56, v117
    v_mul_f32 v118, s56, v118
    v_mul_f32 v119, s56, v119
    v_cvt_pk_bf16_f32 v64, v112, v113
    v_cvt_pk_bf16_f32 v65, v114, v115
    v_cvt_pk_bf16_f32 v66, v116, v117
    v_cvt_pk_bf16_f32 v67, v118, v119
    v_mul_f32 v120, s56, v120
    v_mul_f32 v121, s56, v121
    v_mul_f32 v122, s56, v122
    v_mul_f32 v123, s56, v123
    v_mul_f32 v124, s56, v124
    v_mul_f32 v125, s56, v125
    v_mul_f32 v126, s56, v126
    v_mul_f32 v127, s56, v127
    v_cvt_pk_bf16_f32 v68, v120, v121
    v_cvt_pk_bf16_f32 v69, v122, v123
    v_cvt_pk_bf16_f32 v70, v124, v125
    v_cvt_pk_bf16_f32 v71, v126, v127
    v_mul_f32 v128, s56, v128
    v_mul_f32 v129, s56, v129
    v_mul_f32 v130, s56, v130
    v_mul_f32 v131, s56, v131
    v_mul_f32 v132, s56, v132
    v_mul_f32 v133, s56, v133
    v_mul_f32 v134, s56, v134
    v_mul_f32 v135, s56, v135
    v_cvt_pk_bf16_f32 v72, v128, v129
    v_cvt_pk_bf16_f32 v73, v130, v131
    v_cvt_pk_bf16_f32 v74, v132, v133
    v_cvt_pk_bf16_f32 v75, v134, v135
    v_mul_f32 v136, s56, v136
    v_mul_f32 v137, s56, v137
    v_mul_f32 v138, s56, v138
    v_mul_f32 v139, s56, v139
    v_mul_f32 v140, s56, v140
    v_mul_f32 v141, s56, v141
    v_mul_f32 v142, s56, v142
    v_mul_f32 v143, s56, v143
    v_cvt_pk_bf16_f32 v76, v136, v137
    v_cvt_pk_bf16_f32 v77, v138, v139
    v_cvt_pk_bf16_f32 v78, v140, v141
    v_cvt_pk_bf16_f32 v79, v142, v143
    v_add_u32 v4, s59, v3
    s_lshl_b32 s57, s46, 12
    s_add_u32 s57, s57, 155648
    v_add_u32 v5, s57, v3
    s_barrier
    ds_write_b128 v4, v[48:51] offset:0
    ds_write_b128 v4, v[52:55] offset:2048
    ds_write_b128 v4, v[56:59] offset:8192
    ds_write_b128 v4, v[60:63] offset:10240
    ds_write_b128 v5, v[64:67] offset:0
    ds_write_b128 v5, v[68:71] offset:1024
    ds_write_b128 v5, v[72:75] offset:2048
    ds_write_b128 v5, v[76:79] offset:3072
    s_branch P1_join_3
P1_vz2_5:
    v_and_b32 v4, 15, v2
    v_lshrrev_b32 v5, 5, v2
    v_lshl_add_u32 v6, v5, 4, v4
    v_lshlrev_b32 v6, 4, v6
    v_lshrrev_b32 v7, 4, v2
    v_and_b32 v7, 1, v7
    v_lshl_add_u32 v6, v7, 13, v6
    v_add_u32 v9, s59, v6
    s_lshl_b32 s56, s46, 11
    s_add_u32 s55, s55, s56
    s_barrier
    ds_read_b128 v[16:19], v144 offset:0
    ds_read_b128 v[20:23], v148 offset:0
    ds_read_b64_tr_b16 v[32:33], v164 offset:0
    ds_read_b64_tr_b16 v[34:35], v164 offset:512
    ds_read_b128 v[24:27], v145 offset:0
    ds_read_b128 v[28:31], v149 offset:0
    ds_read_b64_tr_b16 v[36:37], v164 offset:2048
    ds_read_b64_tr_b16 v[38:39], v164 offset:2560
    s_waitcnt lgkmcnt(4)
    v_mfma_f32_32x32x16_bf16 v[80:95], v[16:19], v[32:35], v[80:95]
    v_mfma_f32_32x32x16_bf16 v[96:111], v[20:23], v[32:35], v[96:111]
    ds_read_b128 v[16:19], v146 offset:0
    ds_read_b128 v[20:23], v150 offset:0
    ds_read_b64_tr_b16 v[32:33], v164 offset:4096
    ds_read_b64_tr_b16 v[34:35], v164 offset:4608
    s_waitcnt lgkmcnt(4)
    v_mfma_f32_32x32x16_bf16 v[80:95], v[24:27], v[36:39], v[80:95]
    v_mfma_f32_32x32x16_bf16 v[96:111], v[28:31], v[36:39], v[96:111]
    ds_read_b128 v[24:27], v147 offset:0
    ds_read_b128 v[28:31], v151 offset:0
    ds_read_b64_tr_b16 v[36:37], v164 offset:6144
    ds_read_b64_tr_b16 v[38:39], v164 offset:6656
    s_barrier
    s_waitcnt lgkmcnt(4)
    v_mfma_f32_32x32x16_bf16 v[80:95], v[16:19], v[32:35], v[80:95]
    v_mfma_f32_32x32x16_bf16 v[96:111], v[20:23], v[32:35], v[96:111]
    ds_read_b128 v[16:19], v144 offset:16384
    ds_read_b128 v[20:23], v148 offset:16384
    ds_read_b64_tr_b16 v[32:33], v164 offset:8192
    ds_read_b64_tr_b16 v[34:35], v164 offset:8704
    s_waitcnt lgkmcnt(4)
    v_mfma_f32_32x32x16_bf16 v[80:95], v[24:27], v[36:39], v[80:95]
    v_mfma_f32_32x32x16_bf16 v[96:111], v[28:31], v[36:39], v[96:111]
    ds_read_b128 v[24:27], v145 offset:16384
    ds_read_b128 v[28:31], v149 offset:16384
    ds_read_b64_tr_b16 v[36:37], v164 offset:10240
    ds_read_b64_tr_b16 v[38:39], v164 offset:10752
    s_waitcnt lgkmcnt(4)
    v_mfma_f32_32x32x16_bf16 v[80:95], v[16:19], v[32:35], v[80:95]
    v_mfma_f32_32x32x16_bf16 v[96:111], v[20:23], v[32:35], v[96:111]
    ds_read_b128 v[16:19], v146 offset:16384
    ds_read_b128 v[20:23], v150 offset:16384
    ds_read_b64_tr_b16 v[32:33], v164 offset:12288
    ds_read_b64_tr_b16 v[34:35], v164 offset:12800
    s_waitcnt lgkmcnt(4)
    v_mfma_f32_32x32x16_bf16 v[80:95], v[24:27], v[36:39], v[80:95]
    v_mfma_f32_32x32x16_bf16 v[96:111], v[28:31], v[36:39], v[96:111]
    ds_read_b128 v[24:27], v147 offset:16384
    ds_read_b128 v[28:31], v151 offset:16384
    ds_read_b64_tr_b16 v[36:37], v164 offset:14336
    ds_read_b64_tr_b16 v[38:39], v164 offset:14848
    s_barrier
    s_waitcnt lgkmcnt(4)
    v_mfma_f32_32x32x16_bf16 v[80:95], v[16:19], v[32:35], v[80:95]
    v_mfma_f32_32x32x16_bf16 v[96:111], v[20:23], v[32:35], v[96:111]
    ds_read_b128 v[16:19], v144 offset:32768
    ds_read_b128 v[20:23], v148 offset:32768
    ds_read_b64_tr_b16 v[32:33], v164 offset:16384
    ds_read_b64_tr_b16 v[34:35], v164 offset:16896
    s_waitcnt lgkmcnt(4)
    v_mfma_f32_32x32x16_bf16 v[80:95], v[24:27], v[36:39], v[80:95]
    v_mfma_f32_32x32x16_bf16 v[96:111], v[28:31], v[36:39], v[96:111]
    ds_read_b128 v[24:27], v145 offset:32768
    ds_read_b128 v[28:31], v149 offset:32768
    ds_read_b64_tr_b16 v[36:37], v164 offset:18432
    ds_read_b64_tr_b16 v[38:39], v164 offset:18944
    s_waitcnt lgkmcnt(4)
    v_mfma_f32_32x32x16_bf16 v[80:95], v[16:19], v[32:35], v[80:95]
    v_mfma_f32_32x32x16_bf16 v[96:111], v[20:23], v[32:35], v[96:111]
    ds_read_b128 v[16:19], v146 offset:32768
    ds_read_b128 v[20:23], v150 offset:32768
    ds_read_b64_tr_b16 v[32:33], v164 offset:20480
    ds_read_b64_tr_b16 v[34:35], v164 offset:20992
    s_waitcnt lgkmcnt(4)
    v_mfma_f32_32x32x16_bf16 v[80:95], v[24:27], v[36:39], v[80:95]
    v_mfma_f32_32x32x16_bf16 v[96:111], v[28:31], v[36:39], v[96:111]
    ds_read_b128 v[24:27], v147 offset:32768
    ds_read_b128 v[28:31], v151 offset:32768
    ds_read_b64_tr_b16 v[36:37], v164 offset:22528
    ds_read_b64_tr_b16 v[38:39], v164 offset:23040
    s_barrier
    s_waitcnt lgkmcnt(4)
    v_mfma_f32_32x32x16_bf16 v[80:95], v[16:19], v[32:35], v[80:95]
    v_mfma_f32_32x32x16_bf16 v[96:111], v[20:23], v[32:35], v[96:111]
    ds_read_b128 v[16:19], v144 offset:49152
    ds_read_b128 v[20:23], v148 offset:49152
    ds_read_b64_tr_b16 v[32:33], v164 offset:24576
    ds_read_b64_tr_b16 v[34:35], v164 offset:25088
    s_waitcnt lgkmcnt(4)
    v_mfma_f32_32x32x16_bf16 v[80:95], v[24:27], v[36:39], v[80:95]
    v_mfma_f32_32x32x16_bf16 v[96:111], v[28:31], v[36:39], v[96:111]
    ds_read_b128 v[24:27], v145 offset:49152
    ds_read_b128 v[28:31], v149 offset:49152
    ds_read_b64_tr_b16 v[36:37], v164 offset:26624
    ds_read_b64_tr_b16 v[38:39], v164 offset:27136
    s_waitcnt lgkmcnt(4)
    v_mfma_f32_32x32x16_bf16 v[80:95], v[16:19], v[32:35], v[80:95]
    v_mfma_f32_32x32x16_bf16 v[96:111], v[20:23], v[32:35], v[96:111]
    ds_read_b128 v[16:19], v146 offset:49152
    ds_read_b128 v[20:23], v150 offset:49152
    ds_read_b64_tr_b16 v[32:33], v164 offset:28672
    ds_read_b64_tr_b16 v[34:35], v164 offset:29184
    s_waitcnt lgkmcnt(4)
    v_mfma_f32_32x32x16_bf16 v[80:95], v[24:27], v[36:39], v[80:95]
    v_mfma_f32_32x32x16_bf16 v[96:111], v[28:31], v[36:39], v[96:111]
    ds_read_b128 v[24:27], v147 offset:49152
    ds_read_b128 v[28:31], v151 offset:49152
    ds_read_b64_tr_b16 v[36:37], v164 offset:30720
    ds_read_b64_tr_b16 v[38:39], v164 offset:31232
    s_barrier
    s_waitcnt lgkmcnt(4)
    v_mfma_f32_32x32x16_bf16 v[80:95], v[16:19], v[32:35], v[80:95]
    v_mfma_f32_32x32x16_bf16 v[96:111], v[20:23], v[32:35], v[96:111]
    ds_read_b128 v[16:19], v152 offset:0
    ds_read_b128 v[20:23], v156 offset:0
    ds_read_b64_tr_b16 v[32:33], v164 offset:0
    ds_read_b64_tr_b16 v[34:35], v164 offset:512
    s_waitcnt lgkmcnt(4)
    v_mfma_f32_32x32x16_bf16 v[80:95], v[24:27], v[36:39], v[80:95]
    v_mfma_f32_32x32x16_bf16 v[96:111], v[28:31], v[36:39], v[96:111]
    ds_read_b128 v[24:27], v153 offset:0
    ds_read_b128 v[28:31], v157 offset:0
    ds_read_b64_tr_b16 v[36:37], v164 offset:2048
    ds_read_b64_tr_b16 v[38:39], v164 offset:2560
    s_waitcnt lgkmcnt(4)
    v_mfma_f32_32x32x16_bf16 v[80:95], v[16:19], v[32:35], v[80:95]
    v_mfma_f32_32x32x16_bf16 v[96:111], v[20:23], v[32:35], v[96:111]
    ds_read_b128 v[16:19], v154 offset:0
    ds_read_b128 v[20:23], v158 offset:0
    ds_read_b64_tr_b16 v[32:33], v164 offset:4096
    ds_read_b64_tr_b16 v[34:35], v164 offset:4608
    s_waitcnt lgkmcnt(4)
    v_mfma_f32_32x32x16_bf16 v[80:95], v[24:27], v[36:39], v[80:95]
    v_mfma_f32_32x32x16_bf16 v[96:111], v[28:31], v[36:39], v[96:111]
    ds_read_b128 v[24:27], v155 offset:0
    ds_read_b128 v[28:31], v159 offset:0
    ds_read_b64_tr_b16 v[36:37], v164 offset:6144
    ds_read_b64_tr_b16 v[38:39], v164 offset:6656
    s_barrier
    s_waitcnt lgkmcnt(4)
    v_mfma_f32_32x32x16_bf16 v[80:95], v[16:19], v[32:35], v[80:95]
    v_mfma_f32_32x32x16_bf16 v[96:111], v[20:23], v[32:35], v[96:111]
    ds_read_b128 v[16:19], v152 offset:16384
    ds_read_b128 v[20:23], v156 offset:16384
    ds_read_b64_tr_b16 v[32:33], v164 offset:8192
    ds_read_b64_tr_b16 v[34:35], v164 offset:8704
    s_waitcnt lgkmcnt(4)
    v_mfma_f32_32x32x16_bf16 v[80:95], v[24:27], v[36:39], v[80:95]
    v_mfma_f32_32x32x16_bf16 v[96:111], v[28:31], v[36:39], v[96:111]
    ds_read_b128 v[24:27], v153 offset:16384
    ds_read_b128 v[28:31], v157 offset:16384
    ds_read_b64_tr_b16 v[36:37], v164 offset:10240
    ds_read_b64_tr_b16 v[38:39], v164 offset:10752
    s_waitcnt lgkmcnt(4)
    v_mfma_f32_32x32x16_bf16 v[80:95], v[16:19], v[32:35], v[80:95]
    v_mfma_f32_32x32x16_bf16 v[96:111], v[20:23], v[32:35], v[96:111]
    ds_read_b128 v[16:19], v154 offset:16384
    ds_read_b128 v[20:23], v158 offset:16384
    ds_read_b64_tr_b16 v[32:33], v164 offset:12288
    ds_read_b64_tr_b16 v[34:35], v164 offset:12800
    s_waitcnt lgkmcnt(4)
    v_mfma_f32_32x32x16_bf16 v[80:95], v[24:27], v[36:39], v[80:95]
    v_mfma_f32_32x32x16_bf16 v[96:111], v[28:31], v[36:39], v[96:111]
    ds_read_b128 v[24:27], v155 offset:16384
    ds_read_b128 v[28:31], v159 offset:16384
    ds_read_b64_tr_b16 v[36:37], v164 offset:14336
    ds_read_b64_tr_b16 v[38:39], v164 offset:14848
    s_barrier
    s_waitcnt lgkmcnt(4)
    v_mfma_f32_32x32x16_bf16 v[80:95], v[16:19], v[32:35], v[80:95]
    v_mfma_f32_32x32x16_bf16 v[96:111], v[20:23], v[32:35], v[96:111]
    ds_read_b128 v[16:19], v152 offset:32768
    ds_read_b128 v[20:23], v156 offset:32768
    ds_read_b64_tr_b16 v[32:33], v164 offset:16384
    ds_read_b64_tr_b16 v[34:35], v164 offset:16896
    s_waitcnt lgkmcnt(4)
    v_mfma_f32_32x32x16_bf16 v[80:95], v[24:27], v[36:39], v[80:95]
    v_mfma_f32_32x32x16_bf16 v[96:111], v[28:31], v[36:39], v[96:111]
    ds_read_b128 v[24:27], v153 offset:32768
    ds_read_b128 v[28:31], v157 offset:32768
    ds_read_b64_tr_b16 v[36:37], v164 offset:18432
    ds_read_b64_tr_b16 v[38:39], v164 offset:18944
    s_waitcnt lgkmcnt(4)
    v_mfma_f32_32x32x16_bf16 v[80:95], v[16:19], v[32:35], v[80:95]
    v_mfma_f32_32x32x16_bf16 v[96:111], v[20:23], v[32:35], v[96:111]
    ds_read_b128 v[16:19], v154 offset:32768
    ds_read_b128 v[20:23], v158 offset:32768
    ds_read_b64_tr_b16 v[32:33], v164 offset:20480
    ds_read_b64_tr_b16 v[34:35], v164 offset:20992
    s_waitcnt lgkmcnt(4)
    v_mfma_f32_32x32x16_bf16 v[80:95], v[24:27], v[36:39], v[80:95]
    v_mfma_f32_32x32x16_bf16 v[96:111], v[28:31], v[36:39], v[96:111]
    ds_read_b128 v[24:27], v155 offset:32768
    ds_read_b128 v[28:31], v159 offset:32768
    ds_read_b64_tr_b16 v[36:37], v164 offset:22528
    ds_read_b64_tr_b16 v[38:39], v164 offset:23040
    s_barrier
    s_waitcnt lgkmcnt(4)
    v_mfma_f32_32x32x16_bf16 v[80:95], v[16:19], v[32:35], v[80:95]
    v_mfma_f32_32x32x16_bf16 v[96:111], v[20:23], v[32:35], v[96:111]
    ds_read_b128 v[16:19], v152 offset:49152
    ds_read_b128 v[20:23], v156 offset:49152
    ds_read_b64_tr_b16 v[32:33], v164 offset:24576
    ds_read_b64_tr_b16 v[34:35], v164 offset:25088
    s_waitcnt lgkmcnt(4)
    v_mfma_f32_32x32x16_bf16 v[80:95], v[24:27], v[36:39], v[80:95]
    v_mfma_f32_32x32x16_bf16 v[96:111], v[28:31], v[36:39], v[96:111]
    ds_read_b128 v[24:27], v153 offset:49152
    ds_read_b128 v[28:31], v157 offset:49152
    ds_read_b64_tr_b16 v[36:37], v164 offset:26624
    ds_read_b64_tr_b16 v[38:39], v164 offset:27136
    s_waitcnt lgkmcnt(4)
    v_mfma_f32_32x32x16_bf16 v[80:95], v[16:19], v[32:35], v[80:95]
    v_mfma_f32_32x32x16_bf16 v[96:111], v[20:23], v[32:35], v[96:111]
    ds_read_b128 v[16:19], v154 offset:49152
    ds_read_b128 v[20:23], v158 offset:49152
    ds_read_b64_tr_b16 v[32:33], v164 offset:28672
    ds_read_b64_tr_b16 v[34:35], v164 offset:29184
    s_waitcnt lgkmcnt(4)
    v_mfma_f32_32x32x16_bf16 v[80:95], v[24:27], v[36:39], v[80:95]
    v_mfma_f32_32x32x16_bf16 v[96:111], v[28:31], v[36:39], v[96:111]
    ds_read_b128 v[24:27], v155 offset:49152
    ds_read_b128 v[28:31], v159 offset:49152
    ds_read_b64_tr_b16 v[36:37], v164 offset:30720
    ds_read_b64_tr_b16 v[38:39], v164 offset:31232
    s_barrier
    s_waitcnt lgkmcnt(4)
    v_mfma_f32_32x32x16_bf16 v[80:95], v[16:19], v[32:35], v[80:95]
    v_mfma_f32_32x32x16_bf16 v[96:111], v[20:23], v[32:35], v[96:111]
    ds_read_b128 v[16:19], v144 offset:0
    ds_read_b128 v[20:23], v148 offset:0
    ds_read_b128 v[32:35], v160 offset:0
    s_waitcnt lgkmcnt(3)
    v_mfma_f32_32x32x16_bf16 v[80:95], v[24:27], v[36:39], v[80:95]
    v_mfma_f32_32x32x16_bf16 v[96:111], v[28:31], v[36:39], v[96:111]
    ds_read_b128 v[24:27], v145 offset:0
    ds_read_b128 v[28:31], v149 offset:0
    ds_read_b128 v[36:39], v161 offset:0
    s_waitcnt lgkmcnt(3)
    v_mfma_f32_32x32x16_bf16 v[112:127], v[16:19], v[32:35], v[112:127]
    v_mfma_f32_32x32x16_bf16 v[128:143], v[20:23], v[32:35], v[128:143]
    ds_read_b128 v[16:19], v146 offset:0
    ds_read_b128 v[20:23], v150 offset:0
    ds_read_b128 v[32:35], v162 offset:0
    s_waitcnt lgkmcnt(3)
    v_mfma_f32_32x32x16_bf16 v[112:127], v[24:27], v[36:39], v[112:127]
    v_mfma_f32_32x32x16_bf16 v[128:143], v[28:31], v[36:39], v[128:143]
    ds_read_b128 v[24:27], v147 offset:0
    ds_read_b128 v[28:31], v151 offset:0
    ds_read_b128 v[36:39], v163 offset:0
    v_cvt_pk_bf16_f32 v48, v80, v81
    v_cvt_pk_bf16_f32 v49, v82, v83
    v_cvt_pk_bf16_f32 v50, v84, v85
    v_cvt_pk_bf16_f32 v51, v86, v87
    v_cvt_pk_bf16_f32 v52, v88, v89
    v_cvt_pk_bf16_f32 v53, v90, v91
    v_cvt_pk_bf16_f32 v54, v92, v93
    v_cvt_pk_bf16_f32 v55, v94, v95
    buffer_store_dwordx4 v[48:51], v6, s[28:31], s58 offen offset:1024 sc1
    buffer_store_dwordx4 v[52:55], v6, s[28:31], s58 offen offset:1536 sc1
    v_cvt_pk_bf16_f32 v56, v96, v97
    v_cvt_pk_bf16_f32 v57, v98, v99
    v_cvt_pk_bf16_f32 v58, v100, v101
    v_cvt_pk_bf16_f32 v59, v102, v103
    v_cvt_pk_bf16_f32 v60, v104, v105
    v_cvt_pk_bf16_f32 v61, v106, v107
    v_cvt_pk_bf16_f32 v62, v108, v109
    v_cvt_pk_bf16_f32 v63, v110, v111
    buffer_store_dwordx4 v[56:59], v6, s[28:31], s58 offen offset:3072 sc1
    buffer_store_dwordx4 v[60:63], v6, s[28:31], s58 offen offset:3584 sc1
    s_barrier
    s_waitcnt lgkmcnt(3)
    v_mfma_f32_32x32x16_bf16 v[112:127], v[16:19], v[32:35], v[112:127]
    v_mfma_f32_32x32x16_bf16 v[128:143], v[20:23], v[32:35], v[128:143]
    ds_read_b128 v[16:19], v144 offset:16384
    ds_read_b128 v[20:23], v148 offset:16384
    ds_read_b128 v[32:35], v160 offset:8192
    s_waitcnt lgkmcnt(3)
    v_mfma_f32_32x32x16_bf16 v[112:127], v[24:27], v[36:39], v[112:127]
    v_mfma_f32_32x32x16_bf16 v[128:143], v[28:31], v[36:39], v[128:143]
    ds_read_b128 v[24:27], v145 offset:16384
    ds_read_b128 v[28:31], v149 offset:16384
    ds_read_b128 v[36:39], v161 offset:8192
    s_waitcnt lgkmcnt(3)
    v_mfma_f32_32x32x16_bf16 v[112:127], v[16:19], v[32:35], v[112:127]
    v_mfma_f32_32x32x16_bf16 v[128:143], v[20:23], v[32:35], v[128:143]
    ds_read_b128 v[16:19], v146 offset:16384
    ds_read_b128 v[20:23], v150 offset:16384
    ds_read_b128 v[32:35], v162 offset:8192
    s_waitcnt lgkmcnt(3)
    v_mfma_f32_32x32x16_bf16 v[112:127], v[24:27], v[36:39], v[112:127]
    v_mfma_f32_32x32x16_bf16 v[128:143], v[28:31], v[36:39], v[128:143]
    ds_read_b128 v[24:27], v147 offset:16384
    ds_read_b128 v[28:31], v151 offset:16384
    ds_read_b128 v[36:39], v163 offset:8192
    s_barrier
    s_waitcnt lgkmcnt(3)
    v_mfma_f32_32x32x16_bf16 v[112:127], v[16:19], v[32:35], v[112:127]
    v_mfma_f32_32x32x16_bf16 v[128:143], v[20:23], v[32:35], v[128:143]
    ds_read_b128 v[16:19], v144 offset:32768
    ds_read_b128 v[20:23], v148 offset:32768
    ds_read_b128 v[32:35], v160 offset:16384
    s_waitcnt lgkmcnt(3)
    v_mfma_f32_32x32x16_bf16 v[112:127], v[24:27], v[36:39], v[112:127]
    v_mfma_f32_32x32x16_bf16 v[128:143], v[28:31], v[36:39], v[128:143]
    ds_read_b128 v[24:27], v145 offset:32768
    ds_read_b128 v[28:31], v149 offset:32768
    ds_read_b128 v[36:39], v161 offset:16384
    s_waitcnt lgkmcnt(3)
    v_mfma_f32_32x32x16_bf16 v[112:127], v[16:19], v[32:35], v[112:127]
    v_mfma_f32_32x32x16_bf16 v[128:143], v[20:23], v[32:35], v[128:143]
    ds_read_b128 v[16:19], v146 offset:32768
    ds_read_b128 v[20:23], v150 offset:32768
    ds_read_b128 v[32:35], v162 offset:16384
    s_waitcnt lgkmcnt(3)
    v_mfma_f32_32x32x16_bf16 v[112:127], v[24:27], v[36:39], v[112:127]
    v_mfma_f32_32x32x16_bf16 v[128:143], v[28:31], v[36:39], v[128:143]
    ds_read_b128 v[24:27], v147 offset:32768
    ds_read_b128 v[28:31], v151 offset:32768
    ds_read_b128 v[36:39], v163 offset:16384
    s_barrier
    s_waitcnt lgkmcnt(3)
    v_mfma_f32_32x32x16_bf16 v[112:127], v[16:19], v[32:35], v[112:127]
    v_mfma_f32_32x32x16_bf16 v[128:143], v[20:23], v[32:35], v[128:143]
    ds_read_b128 v[16:19], v144 offset:49152
    ds_read_b128 v[20:23], v148 offset:49152
    ds_read_b128 v[32:35], v160 offset:24576
    s_waitcnt lgkmcnt(3)
    v_mfma_f32_32x32x16_bf16 v[112:127], v[24:27], v[36:39], v[112:127]
    v_mfma_f32_32x32x16_bf16 v[128:143], v[28:31], v[36:39], v[128:143]
    ds_read_b128 v[24:27], v145 offset:49152
    ds_read_b128 v[28:31], v149 offset:49152
    ds_read_b128 v[36:39], v161 offset:24576
    s_waitcnt lgkmcnt(3)
    v_mfma_f32_32x32x16_bf16 v[112:127], v[16:19], v[32:35], v[112:127]
    v_mfma_f32_32x32x16_bf16 v[128:143], v[20:23], v[32:35], v[128:143]
    ds_read_b128 v[16:19], v146 offset:49152
    ds_read_b128 v[20:23], v150 offset:49152
    ds_read_b128 v[32:35], v162 offset:24576
    s_waitcnt lgkmcnt(3)
    v_mfma_f32_32x32x16_bf16 v[112:127], v[24:27], v[36:39], v[112:127]
    v_mfma_f32_32x32x16_bf16 v[128:143], v[28:31], v[36:39], v[128:143]
    ds_read_b128 v[24:27], v147 offset:49152
    ds_read_b128 v[28:31], v151 offset:49152
    ds_read_b128 v[36:39], v163 offset:24576
    s_barrier
    s_waitcnt lgkmcnt(3)
    v_mfma_f32_32x32x16_bf16 v[112:127], v[16:19], v[32:35], v[112:127]
    v_mfma_f32_32x32x16_bf16 v[128:143], v[20:23], v[32:35], v[128:143]
    ds_read_b128 v[16:19], v152 offset:0
    ds_read_b128 v[20:23], v156 offset:0
    ds_read_b128 v[32:35], v160 offset:0
    s_waitcnt lgkmcnt(3)
    v_mfma_f32_32x32x16_bf16 v[112:127], v[24:27], v[36:39], v[112:127]
    v_mfma_f32_32x32x16_bf16 v[128:143], v[28:31], v[36:39], v[128:143]
    ds_read_b128 v[24:27], v153 offset:0
    ds_read_b128 v[28:31], v157 offset:0
    ds_read_b128 v[36:39], v161 offset:0
    s_waitcnt lgkmcnt(3)
    v_mfma_f32_32x32x16_bf16 v[112:127], v[16:19], v[32:35], v[112:127]
    v_mfma_f32_32x32x16_bf16 v[128:143], v[20:23], v[32:35], v[128:143]
    ds_read_b128 v[16:19], v154 offset:0
    ds_read_b128 v[20:23], v158 offset:0
    ds_read_b128 v[32:35], v162 offset:0
    s_waitcnt lgkmcnt(3)
    v_mfma_f32_32x32x16_bf16 v[112:127], v[24:27], v[36:39], v[112:127]
    v_mfma_f32_32x32x16_bf16 v[128:143], v[28:31], v[36:39], v[128:143]
    ds_read_b128 v[24:27], v155 offset:0
    ds_read_b128 v[28:31], v159 offset:0
    ds_read_b128 v[36:39], v163 offset:0
    s_barrier
    s_waitcnt lgkmcnt(3)
    v_mfma_f32_32x32x16_bf16 v[112:127], v[16:19], v[32:35], v[112:127]
    v_mfma_f32_32x32x16_bf16 v[128:143], v[20:23], v[32:35], v[128:143]
    ds_read_b128 v[16:19], v152 offset:16384
    ds_read_b128 v[20:23], v156 offset:16384
    ds_read_b128 v[32:35], v160 offset:8192
    s_waitcnt lgkmcnt(3)
    v_mfma_f32_32x32x16_bf16 v[112:127], v[24:27], v[36:39], v[112:127]
    v_mfma_f32_32x32x16_bf16 v[128:143], v[28:31], v[36:39], v[128:143]
    ds_read_b128 v[24:27], v153 offset:16384
    ds_read_b128 v[28:31], v157 offset:16384
    ds_read_b128 v[36:39], v161 offset:8192
    s_waitcnt lgkmcnt(3)
    v_mfma_f32_32x32x16_bf16 v[112:127], v[16:19], v[32:35], v[112:127]
    v_mfma_f32_32x32x16_bf16 v[128:143], v[20:23], v[32:35], v[128:143]
    ds_read_b128 v[16:19], v154 offset:16384
    ds_read_b128 v[20:23], v158 offset:16384
    ds_read_b128 v[32:35], v162 offset:8192
    s_waitcnt lgkmcnt(3)
    v_mfma_f32_32x32x16_bf16 v[112:127], v[24:27], v[36:39], v[112:127]
    v_mfma_f32_32x32x16_bf16 v[128:143], v[28:31], v[36:39], v[128:143]
    ds_read_b128 v[24:27], v155 offset:16384
    ds_read_b128 v[28:31], v159 offset:16384
    ds_read_b128 v[36:39], v163 offset:8192
    s_waitcnt vmcnt(0)
    s_barrier
    s_waitcnt lgkmcnt(3)
    v_mfma_f32_32x32x16_bf16 v[112:127], v[16:19], v[32:35], v[112:127]
    v_mfma_f32_32x32x16_bf16 v[128:143], v[20:23], v[32:35], v[128:143]
    ds_read_b128 v[16:19], v152 offset:32768
    ds_read_b128 v[20:23], v156 offset:32768
    ds_read_b128 v[32:35], v160 offset:16384
    s_waitcnt lgkmcnt(3)
    v_mfma_f32_32x32x16_bf16 v[112:127], v[24:27], v[36:39], v[112:127]
    v_mfma_f32_32x32x16_bf16 v[128:143], v[28:31], v[36:39], v[128:143]
    ds_read_b128 v[24:27], v153 offset:32768
    ds_read_b128 v[28:31], v157 offset:32768
    ds_read_b128 v[36:39], v161 offset:16384
    s_waitcnt lgkmcnt(3)
    v_mfma_f32_32x32x16_bf16 v[112:127], v[16:19], v[32:35], v[112:127]
    v_mfma_f32_32x32x16_bf16 v[128:143], v[20:23], v[32:35], v[128:143]
    ds_read_b128 v[16:19], v154 offset:32768
    ds_read_b128 v[20:23], v158 offset:32768
    ds_read_b128 v[32:35], v162 offset:16384
    s_waitcnt lgkmcnt(3)
    v_mfma_f32_32x32x16_bf16 v[112:127], v[24:27], v[36:39], v[112:127]
    v_mfma_f32_32x32x16_bf16 v[128:143], v[28:31], v[36:39], v[128:143]
    ds_read_b128 v[24:27], v155 offset:32768
    ds_read_b128 v[28:31], v159 offset:32768
    ds_read_b128 v[36:39], v163 offset:16384
    s_barrier
    s_waitcnt lgkmcnt(3)
    v_mfma_f32_32x32x16_bf16 v[112:127], v[16:19], v[32:35], v[112:127]
    v_mfma_f32_32x32x16_bf16 v[128:143], v[20:23], v[32:35], v[128:143]
    ds_read_b128 v[16:19], v152 offset:49152
    ds_read_b128 v[20:23], v156 offset:49152
    ds_read_b128 v[32:35], v160 offset:24576
    s_waitcnt lgkmcnt(3)
    v_mfma_f32_32x32x16_bf16 v[112:127], v[24:27], v[36:39], v[112:127]
    v_mfma_f32_32x32x16_bf16 v[128:143], v[28:31], v[36:39], v[128:143]
    ds_read_b128 v[24:27], v153 offset:49152
    ds_read_b128 v[28:31], v157 offset:49152
    ds_read_b128 v[36:39], v161 offset:24576
    s_waitcnt lgkmcnt(3)
    v_mfma_f32_32x32x16_bf16 v[112:127], v[16:19], v[32:35], v[112:127]
    v_mfma_f32_32x32x16_bf16 v[128:143], v[20:23], v[32:35], v[128:143]
    ds_read_b128 v[16:19], v154 offset:49152
    ds_read_b128 v[20:23], v158 offset:49152
    ds_read_b128 v[32:35], v162 offset:24576
    s_waitcnt lgkmcnt(3)
    v_mfma_f32_32x32x16_bf16 v[112:127], v[24:27], v[36:39], v[112:127]
    v_mfma_f32_32x32x16_bf16 v[128:143], v[28:31], v[36:39], v[128:143]
    ds_read_b128 v[24:27], v155 offset:49152
    ds_read_b128 v[28:31], v159 offset:49152
    ds_read_b128 v[36:39], v163 offset:24576
    s_waitcnt lgkmcnt(3)
    v_mfma_f32_32x32x16_bf16 v[112:127], v[16:19], v[32:35], v[112:127]
    v_mfma_f32_32x32x16_bf16 v[128:143], v[20:23], v[32:35], v[128:143]
    s_waitcnt lgkmcnt(0)
    v_mfma_f32_32x32x16_bf16 v[112:127], v[24:27], v[36:39], v[112:127]
    v_mfma_f32_32x32x16_bf16 v[128:143], v[28:31], v[36:39], v[128:143]
    s_nop 10
    v_cvt_pk_bf16_f32 v64, v112, v113
    v_cvt_pk_bf16_f32 v65, v114, v115
    v_cvt_pk_bf16_f32 v66, v116, v117
    v_cvt_pk_bf16_f32 v67, v118, v119
    v_cvt_pk_bf16_f32 v68, v120, v121
    v_cvt_pk_bf16_f32 v69, v122, v123
    v_cvt_pk_bf16_f32 v70, v124, v125
    v_cvt_pk_bf16_f32 v71, v126, v127
    buffer_store_dwordx4 v[64:67], v3, s[28:31], s55 offen offset:0 sc1
    s_add_u32 s56, s55, 4096
    buffer_store_dwordx4 v[68:71], v3, s[28:31], s56 offen offset:0 sc1
    v_cvt_pk_bf16_f32 v72, v128, v129
    v_cvt_pk_bf16_f32 v73, v130, v131
    v_cvt_pk_bf16_f32 v74, v132, v133
    v_cvt_pk_bf16_f32 v75, v134, v135
    v_cvt_pk_bf16_f32 v76, v136, v137
    v_cvt_pk_bf16_f32 v77, v138, v139
    v_cvt_pk_bf16_f32 v78, v140, v141
    v_cvt_pk_bf16_f32 v79, v142, v143
    buffer_store_dwordx4 v[72:75], v3, s[28:31], s55 offen offset:1024 sc1
    buffer_store_dwordx4 v[76:79], v3, s[28:31], s56 offen offset:1024 sc1
    s_barrier
    ds_write_b128 v9, v[48:51] offset:1024
    ds_write_b128 v9, v[52:55] offset:1536
    ds_write_b128 v9, v[56:59] offset:3072
    ds_write_b128 v9, v[60:63] offset:3584
    s_branch P1_join_3
P1_loader_2:
    s_sub_u32 s46, s42, 4
    v_lshrrev_b32 v4, 4, v2
    v_and_b32 v5, 7, v2
    v_xor_b32 v6, v4, v5
    v_xor_b32 v7, 4, v6
    v_lshrrev_b32 v8, 3, v2
    s_lshl_b32 s57, s41, 2
    s_add_u32 s57, s57, s46
    s_lshl_b32 s57, s57, 10
    v_lshlrev_b32 v9, 16, v8
    v_add_u32 v9, s57, v9
    v_lshl_add_u32 v88, v6, 4, v9
    v_lshl_add_u32 v89, v7, 4, v9
    v_add_u32 v89, 0x7fc00, v89
    v_lshl_add_u32 v90, v6, 4, v9
    v_add_u32 v90, 0xff800, v90
    v_lshl_add_u32 v91, v7, 4, v9
    v_add_u32 v91, 0x17f400, v91
    s_lshl_b32 s60, s46, 12
    s_and_b32 s63, s40, 3
    s_lshl_b32 s63, s63, 1
    s_add_u32 s63, s63, s41
    s_and_b32 s63, s63, 7
    s_waitcnt lgkmcnt(0)
    s_mov_b32 s20, s4
    s_and_b32 s21, s5, 0xffff
    s_mov_b32 s22, 0x200000
    s_mov_b32 s23, 0x20000
    s_add_u32 s61, s63, 0
    s_and_b32 s61, s61, 7
    s_lshl_b32 s61, s61, 7
    s_add_u32 m0, s60, 0
    s_nop 0
    buffer_load_dwordx4 v88, s[20:23], s61 offen offset:0 lds
    buffer_load_dwordx4 v89, s[20:23], s61 offen offset:1024 lds
    buffer_load_dwordx4 v90, s[20:23], s61 offen offset:2048 lds
    buffer_load_dwordx4 v91, s[20:23], s61 offen offset:3072 lds
    v_and_b32 v13, 15, v2
    v_lshrrev_b32 v13, 2, v13
    v_and_b32 v14, 3, v2
    s_lshl_b32 s56, s40, 6
    s_lshl_b32 s57, s46, 3
    s_add_u32 s57, s57, 0
    v_add_u32 v10, s57, v4
    v_lshrrev_b32 v11, 1, v10
    v_and_b32 v12, 1, v10
    v_lshl_add_u32 v11, v11, 2, v13
    v_mul_u32_u24 v11, 0xc00, v11
    v_lshl_add_u32 v11, v12, 10, v11
    v_lshl_add_u32 v11, v14, 4, v11
    v_add_u32 v11, s56, v11
    v_add_u32 v11, 1024, v11
    v_mov_b32 v92, v11
    s_lshl_b32 s57, s46, 3
    s_add_u32 s57, s57, 4
    v_add_u32 v10, s57, v4
    v_lshrrev_b32 v11, 1, v10
    v_and_b32 v12, 1, v10
    v_lshl_add_u32 v11, v11, 2, v13
    v_mul_u32_u24 v11, 0xc00, v11
    v_lshl_add_u32 v11, v12, 10, v11
    v_lshl_add_u32 v11, v14, 4, v11
    v_add_u32 v11, s56, v11
    v_mov_b32 v93, v11
    s_mov_b32 s24, s12
    s_and_b32 s25, s13, 0xffff
    s_mov_b32 s26, 0x180000
    s_mov_b32 s27, 0x20000
    s_lshl_b32 s62, s46, 11
    s_add_u32 s61, s63, 0
    s_and_b32 s61, s61, 7
    s_mul_i32 s61, s61, 0x30000
    s_add_u32 m0, s62, 131072
    s_nop 0
    buffer_load_dwordx4 v92, s[24:27], s61 offen offset:0 lds
    buffer_load_dwordx4 v93, s[24:27], s61 offen offset:1024 lds
    s_add_u32 s61, s63, 1
    s_and_b32 s61, s61, 7
    s_lshl_b32 s61, s61, 7
    s_add_u32 m0, s60, 16384
    s_nop 0
    buffer_load_dwordx4 v88, s[20:23], s61 offen offset:0 lds
    buffer_load_dwordx4 v89, s[20:23], s61 offen offset:1024 lds
    buffer_load_dwordx4 v90, s[20:23], s61 offen offset:2048 lds
    buffer_load_dwordx4 v91, s[20:23], s61 offen offset:3072 lds
    s_add_u32 s61, s63, 1
    s_and_b32 s61, s61, 7
    s_mul_i32 s61, s61, 0x30000
    s_add_u32 m0, s62, 139264
    s_nop 0
    buffer_load_dwordx4 v92, s[24:27], s61 offen offset:0 lds
    buffer_load_dwordx4 v93, s[24:27], s61 offen offset:1024 lds
    s_cmp_ge_u32 s46, 2
    s_cbranch_scc1 P1_F_6
    s_lshl_b32 s56, s40, 6
    s_lshl_b32 s57, s46, 3
    s_add_u32 s57, s57, 0
    v_add_u32 v11, s57, v4
    v_lshl_add_u32 v11, v11, 2, v13
    v_mul_u32_u24 v11, 0xc00, v11
    v_lshl_add_u32 v11, v14, 4, v11
    v_add_u32 v11, s56, v11
    v_mov_b32 v94, v11
    s_lshl_b32 s57, s46, 3
    s_add_u32 s57, s57, 4
    v_add_u32 v11, s57, v4
    v_lshl_add_u32 v11, v11, 2, v13
    v_mul_u32_u24 v11, 0xc00, v11
    v_lshl_add_u32 v11, v14, 4, v11
    v_add_u32 v11, s56, v11
    v_subrev_u32 v11, 1024, v11
    v_mov_b32 v95, v11
    s_branch P1_Bd_7
P1_F_6:
    s_lshl_b32 s56, s40, 14
    v_lshlrev_b32 v9, 10, v8
    v_add_u32 v9, s56, v9
    v_lshl_add_u32 v94, v6, 4, v9
    v_lshl_add_u32 v95, v7, 4, v9
    v_add_u32 v95, 7168, v95
P1_Bd_7:
    s_cmp_eq_u32 s46, 2
    s_cselect_b32 s52, s8, s12
    s_cselect_b32 s53, s9, s13
    s_cmp_eq_u32 s46, 3
    s_cselect_b32 s52, s10, s52
    s_cselect_b32 s53, s11, s53
    s_cmp_ge_u32 s46, 2
    s_mov_b32 s49, 0x30000
    s_cselect_b32 s49, 128, s49
    s_mov_b32 s48, 0x180000
    s_cselect_b32 s48, 0x80000, s48
    s_mov_b32 s32, s52
    s_and_b32 s33, s53, 0xffff
    s_mov_b32 s34, s48
    s_mov_b32 s35, 0x20000
    s_add_u32 s56, s18, 0xe00000
    s_addc_u32 s57, s19, 0
    s_load_dword s45, s[56:57], 0
    s_mov_b32 s28, s18
    s_and_b32 s29, s19, 0xffff
    s_mov_b32 s30, 0x1100000
    s_mov_b32 s31, 0x20000
    s_lshl_b32 s73, s40, 19
    s_add_u32 s73, s73, 24576
    s_lshl_b32 s72, s41, 15
    s_add_u32 s72, s72, s73
    s_add_u32 s76, s73, 128
    s_add_u32 s77, s72, 128
    s_lshl_b32 s74, s2, 2
    s_add_u32 s74, s74, 0xe03000
    s_mov_b32 s75, 0xe03000
    v_mov_b32 v106, v2
    v_mov_b32 v16, 0xbf803f80
    v_mov_b32 v17, v16
    v_mov_b32 v18, v16
    v_mov_b32 v19, v16
    v_lshlrev_b32 v3, 4, v2
    v_add_u32 v12, 137216, v3
    s_lshl_b32 s59, s40, 3
    s_or_b32 s59, s59, s42
    s_mov_b64 s[64:65], 0xff
    s_waitcnt vmcnt(6) lgkmcnt(0)
    s_add_u32 s45, s45, 1
    s_barrier
    s_add_u32 s61, s63, 2
    s_and_b32 s61, s61, 7
    s_lshl_b32 s61, s61, 7
    s_add_u32 m0, s60, 32768
    s_nop 0
    buffer_load_dwordx4 v88, s[20:23], s61 offen offset:0 lds
    buffer_load_dwordx4 v89, s[20:23], s61 offen offset:1024 lds
    buffer_load_dwordx4 v90, s[20:23], s61 offen offset:2048 lds
    buffer_load_dwordx4 v91, s[20:23], s61 offen offset:3072 lds
    s_add_u32 s61, s63, 2
    s_and_b32 s61, s61, 7
    s_mul_i32 s61, s61, 0x30000
    s_add_u32 m0, s62, 147456
    s_nop 0
    buffer_load_dwordx4 v92, s[24:27], s61 offen offset:0 lds
    buffer_load_dwordx4 v93, s[24:27], s61 offen offset:1024 lds
    s_add_u32 s61, s63, 3
    s_and_b32 s61, s61, 7
    s_lshl_b32 s61, s61, 7
    s_add_u32 m0, s60, 49152
    s_nop 0
    buffer_load_dwordx4 v88, s[20:23], s61 offen offset:0 lds
    buffer_load_dwordx4 v89, s[20:23], s61 offen offset:1024 lds
    buffer_load_dwordx4 v90, s[20:23], s61 offen offset:2048 lds
    buffer_load_dwordx4 v91, s[20:23], s61 offen offset:3072 lds
    s_waitcnt vmcnt(10)
    s_barrier
    s_add_u32 s61, s63, 3
    s_and_b32 s61, s61, 7
    s_mul_i32 s61, s61, 0x30000
    s_add_u32 m0, s62, 155648
    s_nop 0
    buffer_load_dwordx4 v92, s[24:27], s61 offen offset:0 lds
    buffer_load_dwordx4 v93, s[24:27], s61 offen offset:1024 lds
    s_add_u32 s61, s63, 4
    s_and_b32 s61, s61, 7
    s_lshl_b32 s61, s61, 7
    s_add_u32 m0, s60, 65536
    s_nop 0
    buffer_load_dwordx4 v88, s[20:23], s61 offen offset:0 lds
    buffer_load_dwordx4 v89, s[20:23], s61 offen offset:1024 lds
    buffer_load_dwordx4 v90, s[20:23], s61 offen offset:2048 lds
    buffer_load_dwordx4 v91, s[20:23], s61 offen offset:3072 lds
    s_waitcnt vmcnt(10)
    s_barrier
    s_add_u32 s61, s63, 4
    s_and_b32 s61, s61, 7
    s_mul_i32 s61, s61, 0x30000
    s_add_u32 m0, s62, 131072
    s_nop 0
    buffer_load_dwordx4 v92, s[24:27], s61 offen offset:0 lds
    buffer_load_dwordx4 v93, s[24:27], s61 offen offset:1024 lds
    s_add_u32 s61, s63, 5
    s_and_b32 s61, s61, 7
    s_lshl_b32 s61, s61, 7
    s_add_u32 m0, s60, 81920
    s_nop 0
    buffer_load_dwordx4 v88, s[20:23], s61 offen offset:0 lds
    buffer_load_dwordx4 v89, s[20:23], s61 offen offset:1024 lds
    buffer_load_dwordx4 v90, s[20:23], s61 offen offset:2048 lds
    buffer_load_dwordx4 v91, s[20:23], s61 offen offset:3072 lds
    s_waitcnt vmcnt(10)
    s_barrier
    s_add_u32 s61, s63, 5
    s_and_b32 s61, s61, 7
    s_mul_i32 s61, s61, 0x30000
    s_add_u32 m0, s62, 139264
    s_nop 0
    buffer_load_dwordx4 v92, s[24:27], s61 offen offset:0 lds
    buffer_load_dwordx4 v93, s[24:27], s61 offen offset:1024 lds
    s_add_u32 s61, s63, 6
    s_and_b32 s61, s61, 7
    s_lshl_b32 s61, s61, 7
    s_add_u32 m0, s60, 98304
    s_nop 0
    buffer_load_dwordx4 v88, s[20:23], s61 offen offset:0 lds
    buffer_load_dwordx4 v89, s[20:23], s61 offen offset:1024 lds
    buffer_load_dwordx4 v90, s[20:23], s61 offen offset:2048 lds
    buffer_load_dwordx4 v91, s[20:23], s61 offen offset:3072 lds
    s_waitcnt vmcnt(10)
    s_barrier
    s_add_u32 s61, s63, 6
    s_and_b32 s61, s61, 7
    s_mul_i32 s61, s61, 0x30000
    s_add_u32 m0, s62, 147456
    s_nop 0
    buffer_load_dwordx4 v92, s[24:27], s61 offen offset:0 lds
    buffer_load_dwordx4 v93, s[24:27], s61 offen offset:1024 lds
    s_add_u32 s61, s63, 7
    s_and_b32 s61, s61, 7
    s_lshl_b32 s61, s61, 7
    s_add_u32 m0, s60, 114688
    s_nop 0
    buffer_load_dwordx4 v88, s[20:23], s61 offen offset:0 lds
    buffer_load_dwordx4 v89, s[20:23], s61 offen offset:1024 lds
    buffer_load_dwordx4 v90, s[20:23], s61 offen offset:2048 lds
    buffer_load_dwordx4 v91, s[20:23], s61 offen offset:3072 lds
    s_waitcnt vmcnt(10)
    s_barrier
    s_add_u32 s61, s63, 7
    s_and_b32 s61, s61, 7
    s_mul_i32 s61, s61, 0x30000
    s_add_u32 m0, s62, 155648
    s_nop 0
    buffer_load_dwordx4 v92, s[24:27], s61 offen offset:0 lds
    buffer_load_dwordx4 v93, s[24:27], s61 offen offset:1024 lds
    s_waitcnt vmcnt(6)
    s_barrier
    s_add_u32 s61, s63, 0
    s_and_b32 s61, s61, 7
    s_mul_i32 s61, s61, s49
    s_add_u32 m0, s62, 131072
    s_nop 0
    buffer_load_dwordx4 v94, s[32:35], s61 offen offset:0 lds
    buffer_load_dwordx4 v95, s[32:35], s61 offen offset:1024 lds
    s_waitcnt vmcnt(2)
    s_barrier
    s_add_u32 s61, s63, 1
    s_and_b32 s61, s61, 7
    s_mul_i32 s61, s61, s49
    s_add_u32 m0, s62, 139264
    s_nop 0
    buffer_load_dwordx4 v94, s[32:35], s61 offen offset:0 lds
    buffer_load_dwordx4 v95, s[32:35], s61 offen offset:1024 lds
    s_waitcnt vmcnt(2)
    s_cmp_lg_u32 s59, 7
    s_cbranch_scc1 P1_nofix_8
    s_mov_b64 exec, s[64:65]
    ds_write_b128 v12, v[16:19] offset:0
    s_mov_b64 exec, -1
    s_waitcnt lgkmcnt(0)
P1_nofix_8:
    s_barrier
    s_add_u32 s61, s63, 2
    s_and_b32 s61, s61, 7
    s_mul_i32 s61, s61, s49
    s_add_u32 m0, s62, 147456
    s_nop 0
    buffer_load_dwordx4 v94, s[32:35], s61 offen offset:0 lds
    buffer_load_dwordx4 v95, s[32:35], s61 offen offset:1024 lds
    s_waitcnt vmcnt(2)
    s_cmp_lg_u32 s59, 7
    s_cbranch_scc1 P1_nofix_9
    s_mov_b64 exec, s[64:65]
    ds_write_b128 v12, v[16:19] offset:8192
    s_mov_b64 exec, -1
    s_waitcnt lgkmcnt(0)
P1_nofix_9:
    s_barrier
    s_add_u32 s61, s63, 3
    s_and_b32 s61, s61, 7
    s_mul_i32 s61, s61, s49
    s_add_u32 m0, s62, 155648
    s_nop 0
    buffer_load_dwordx4 v94, s[32:35], s61 offen offset:0 lds
    buffer_load_dwordx4 v95, s[32:35], s61 offen offset:1024 lds
    s_waitcnt vmcnt(2)
    s_cmp_lg_u32 s59, 7
    s_cbranch_scc1 P1_nofix_10
    s_mov_b64 exec, s[64:65]
    ds_write_b128 v12, v[16:19] offset:16384
    s_mov_b64 exec, -1
    s_waitcnt lgkmcnt(0)
P1_nofix_10:
    s_barrier
    s_add_u32 s61, s63, 4
    s_and_b32 s61, s61, 7
    s_mul_i32 s61, s61, s49
    s_add_u32 m0, s62, 131072
    s_nop 0
    buffer_load_dwordx4 v94, s[32:35], s61 offen offset:0 lds
    buffer_load_dwordx4 v95, s[32:35], s61 offen offset:1024 lds
    s_waitcnt vmcnt(2)
    s_cmp_lg_u32 s59, 7
    s_cbranch_scc1 P1_nofix_11
    s_mov_b64 exec, s[64:65]
    ds_write_b128 v12, v[16:19] offset:24576
    s_mov_b64 exec, -1
    s_waitcnt lgkmcnt(0)
P1_nofix_11:
    s_barrier
    s_add_u32 s61, s63, 5
    s_and_b32 s61, s61, 7
    s_mul_i32 s61, s61, s49
    s_add_u32 m0, s62, 139264
    s_nop 0
    buffer_load_dwordx4 v94, s[32:35], s61 offen offset:0 lds
    buffer_load_dwordx4 v95, s[32:35], s61 offen offset:1024 lds
    s_waitcnt vmcnt(2)
    s_cmp_lg_u32 s59, 7
    s_cbranch_scc1 P1_nofix_12
    s_mov_b64 exec, s[64:65]
    ds_write_b128 v12, v[16:19] offset:0
    s_mov_b64 exec, -1
    s_waitcnt lgkmcnt(0)
P1_nofix_12:
    s_barrier
    s_add_u32 s61, s63, 6
    s_and_b32 s61, s61, 7
    s_mul_i32 s61, s61, s49
    s_add_u32 m0, s62, 147456
    s_nop 0
    buffer_load_dwordx4 v94, s[32:35], s61 offen offset:0 lds
    buffer_load_dwordx4 v95, s[32:35], s61 offen offset:1024 lds
    s_waitcnt vmcnt(2)
    s_cmp_lg_u32 s59, 7
    s_cbranch_scc1 P1_nofix_13
    s_mov_b64 exec, s[64:65]
    ds_write_b128 v12, v[16:19] offset:8192
    s_mov_b64 exec, -1
    s_waitcnt lgkmcnt(0)
P1_nofix_13:
    s_barrier
    s_add_u32 s61, s63, 7
    s_and_b32 s61, s61, 7
    s_mul_i32 s61, s61, s49
    s_add_u32 m0, s62, 155648
    s_nop 0
    buffer_load_dwordx4 v94, s[32:35], s61 offen offset:0 lds
    buffer_load_dwordx4 v95, s[32:35], s61 offen offset:1024 lds
    s_waitcnt vmcnt(2)
    s_cmp_lg_u32 s59, 7
    s_cbranch_scc1 P1_nofix_14
    s_mov_b64 exec, s[64:65]
    ds_write_b128 v12, v[16:19] offset:16384
    s_mov_b64 exec, -1
    s_waitcnt lgkmcnt(0)
P1_nofix_14:
    s_barrier
    s_cmp_lg_u32 s42, 7
    s_cbranch_scc1 nopub1_15
    v_mov_b32 v120, s45
    v_mov_b32 v121, 0
    s_mov_b64 exec, 1
    buffer_store_dword v120, v121, s[28:31], s72 offen sc1
    s_mov_b64 exec, -1
nopub1_15:
    s_cmp_eq_u32 s42, 7
    s_cbranch_scc1 w7a_16
    s_waitcnt vmcnt(0)
    s_branch w7b_17
w7a_16:
    s_waitcnt vmcnt(1)
w7b_17:
    s_cmp_lg_u32 s59, 7
    s_cbranch_scc1 P1_nofix_18
    s_mov_b64 exec, s[64:65]
    ds_write_b128 v12, v[16:19] offset:24576
    s_mov_b64 exec, -1
    s_waitcnt lgkmcnt(0)
P1_nofix_18:
    s_barrier
    v_and_b32 v5, 31, v2
    v_cmp_eq_u32 vcc, 0, v5
    v_mov_b32 v6, 0x3f803f80
    s_nop 0
    v_cndmask_b32 v16, 0, v6, vcc
    v_mov_b32 v17, v16
    v_mov_b32 v18, v16
    v_mov_b32 v19, v16
    s_lshl_b32 s56, s46, 11
    s_add_u32 s56, s56, 131072
    v_add_u32 v4, s56, v3
    s_barrier
    ds_write_b128 v4, v[16:19]
    ds_write_b128 v4, v[16:19] offset:1024
    s_branch P1_join_3
P1_helper_4:
    s_waitcnt lgkmcnt(0)
    s_mov_b32 s28, s18
    s_and_b32 s29, s19, 0xffff
    s_mov_b32 s30, 0x1100000
    s_mov_b32 s31, 0x20000
    s_add_u32 s56, s18, 0xe00000
    s_addc_u32 s57, s19, 0
    s_load_dword s45, s[56:57], 0
    s_lshl_b32 s73, s40, 19
    s_add_u32 s73, s73, 24576
    s_lshl_b32 s72, s41, 15
    s_add_u32 s72, s72, s73
    s_add_u32 s76, s73, 128
    s_add_u32 s77, s72, 128
    s_lshl_b32 s74, s2, 2
    s_add_u32 s74, s74, 0xe03000
    s_mov_b32 s75, 0xe03000
    s_waitcnt lgkmcnt(0)
    s_add_u32 s45, s45, 1
    s_barrier
    s_barrier
    s_barrier
    s_barrier
    s_barrier
    s_barrier
    s_barrier
    s_barrier
    s_barrier
    s_barrier
    s_barrier
    s_barrier
    s_barrier
    s_barrier
    s_barrier
    s_barrier
    s_barrier
P1_join_3:
    s_cmp_ge_u32 s42, 8
    s_cbranch_scc1 helper_19
    v_mov_b32 v106, v2
    v_lshlrev_b32 v107, 4, v106
    s_lshl_b32 s56, s51, 5
    s_lshl_b32 s57, s40, 1
    s_add_u32 s56, s56, s57
    s_add_u32 s56, s56, s44
    s_lshl_b32 s52, s56, 10
    s_add_u32 s52, s52, 0x800000
    s_lshl_b32 s56, s40, 19
    s_add_u32 s56, s56, s18
    s_addc_u32 s57, s19, 0
    s_mov_b32 s32, s56
    s_and_b32 s33, s57, 0xffff
    s_mov_b32 s34, 0x80000
    s_mov_b32 s35, 0x20000
    s_lshl_b32 s56, s44, 13
    v_add_u32 v100, s56, v107
    v_add_u32 v101, 0x10000, v100
    v_and_b32 v108, 15, v106
    v_lshrrev_b32 v1, 5, v106
    v_lshl_add_u32 v108, v1, 4, v108
    v_lshlrev_b32 v108, 4, v108
    v_add_u32 v104, s56, v108
    v_and_b32 v1, 31, v106
    v_cmp_eq_u32 vcc, 16, v1
    v_mov_b32 v4, 0
    v_mov_b32 v5, 16
    v_cndmask_b32 v3, v5, v4, vcc
    v_subrev_u32 v4, 20, v1
    v_cmp_gt_u32 vcc, 8, v4
    v_mov_b32 v5, 64
    s_nop 0
    v_cndmask_b32 v3, v3, v5, vcc
    v_add_u32 v3, 130048, v3
    v_and_b32 v4, 16, v106
    v_cmp_eq_u32 vcc, 0, v4
    s_nop 1
    v_cndmask_b32 v104, v3, v104, vcc
    v_mov_b32 v5, 0x4000
    v_cndmask_b32 v105, 0, v5, vcc
    v_mov_b32 v102, v104
    v_mov_b32 v96, 0
    v_mov_b32 v97, 0
    v_mov_b32 v98, 0
    v_mov_b32 v126, 0
    v_mov_b32 v127, 0
    v_mov_b32 v48, 0
    v_mov_b32 v49, 0
    v_mov_b32 v50, 0
    v_mov_b32 v51, 0
    v_mov_b32 v52, 0
    v_mov_b32 v53, 0
    v_mov_b32 v54, 0
    v_mov_b32 v55, 0
    v_mov_b32 v56, 0
    v_mov_b32 v57, 0
    v_mov_b32 v58, 0
    v_mov_b32 v59, 0
    v_mov_b32 v60, 0
    v_mov_b32 v61, 0
    v_mov_b32 v62, 0
    v_mov_b32 v63, 0
    v_mov_b32 v88, 0
    v_mov_b32 v89, 0
    v_mov_b32 v90, 0
    v_mov_b32 v91, 0
    s_lshl_b32 s56, s43, 1
    s_add_u32 s56, s56, s44
    s_lshl_b32 s56, s56, 10
    s_add_u32 s56, s56, 155648
    v_add_u32 v1, s56, v107
    s_waitcnt lgkmcnt(0)
    s_barrier
    ds_read_b128 v[64:67], v1
    ds_read_b128 v[68:71], v100 offset:0
    ds_read_b128 v[72:75], v100 offset:2048
    ds_read_b128 v[76:79], v102 offset:1024
    ds_read_b128 v[80:83], v102 offset:1536
    s_waitcnt lgkmcnt(0)
    v_mfma_f32_32x32x16_bf16 v[0:15], v[68:71], v[64:67], 0
    s_nop 11
    v_max_f32 v108, v0, v1
    v_max3_f32 v108, v108, v2, v3
    v_max3_f32 v108, v108, v4, v5
    v_max3_f32 v108, v108, v6, v7
    v_max3_f32 v108, v108, v8, v9
    v_max3_f32 v108, v108, v10, v11
    v_max3_f32 v108, v108, v12, v13
    v_max3_f32 v108, v108, v14, v15
    v_mov_b32 v112, v108
    s_nop 1
    v_permlane32_swap_b32 v108, v112
    v_max_f32 v108, v108, v112
    v_sub_f32 v32, 0, v108
    v_sub_f32 v33, 0, v108
    v_sub_f32 v34, 0, v108
    v_sub_f32 v35, 0, v108
    v_sub_f32 v36, 0, v108
    v_sub_f32 v37, 0, v108
    v_sub_f32 v38, 0, v108
    v_sub_f32 v39, 0, v108
    v_sub_f32 v40, 0, v108
    v_sub_f32 v41, 0, v108
    v_sub_f32 v42, 0, v108
    v_sub_f32 v43, 0, v108
    v_sub_f32 v44, 0, v108
    v_sub_f32 v45, 0, v108
    v_sub_f32 v46, 0, v108
    v_sub_f32 v47, 0, v108
    s_nop 1
    v_mfma_f32_32x32x16_bf16 v[0:15], v[68:71], v[64:67], v[32:47]
    s_cmp_ge_u32 s42, 4
    s_cbranch_scc1 P2_B_21
    s_setprio 1
    s_waitcnt lgkmcnt(0)
    v_mfma_f32_32x32x16_bf16 v[16:31], v[72:75], v[64:67], v[32:47]
    s_nop 6
    v_exp_f32 v112, v0
    v_exp_f32 v113, v1
    v_cvt_pk_bf16_f32 v99, v126, v127
    v_exp_f32 v114, v2
    v_exp_f32 v115, v3
    v_cvt_pk_bf16_f32 v92, v112, v113
    v_exp_f32 v116, v4
    v_exp_f32 v117, v5
    v_mfma_f32_32x32x16_bf16 v[48:63], v[88:91], v[96:99], v[48:63]
    ds_read_b128 v[84:87], v102 offset:3072
    ds_read_b128 v[88:91], v102 offset:3584
    ds_read_b128 v[68:71], v100 offset:4096
    v_cvt_pk_bf16_f32 v93, v114, v115
    v_exp_f32 v118, v6
    v_exp_f32 v119, v7
    v_cvt_pk_bf16_f32 v94, v116, v117
    v_exp_f32 v120, v8
    v_exp_f32 v121, v9
    v_cvt_pk_bf16_f32 v95, v118, v119
    v_exp_f32 v122, v10
    v_exp_f32 v123, v11
    v_mfma_f32_32x32x16_bf16 v[48:63], v[76:79], v[92:95], v[48:63]
    v_cvt_pk_bf16_f32 v96, v120, v121
    v_exp_f32 v124, v12
    v_exp_f32 v125, v13
    v_cvt_pk_bf16_f32 v97, v122, v123
    v_exp_f32 v126, v14
    v_exp_f32 v127, v15
    v_cvt_pk_bf16_f32 v98, v124, v125
    s_waitcnt lgkmcnt(0)
    v_mfma_f32_32x32x16_bf16 v[0:15], v[68:71], v[64:67], v[32:47]
    v_exp_f32 v112, v16
    v_exp_f32 v113, v17
    v_cvt_pk_bf16_f32 v99, v126, v127
    v_exp_f32 v114, v18
    v_exp_f32 v115, v19
    v_cvt_pk_bf16_f32 v92, v112, v113
    v_exp_f32 v116, v20
    v_exp_f32 v117, v21
    v_mfma_f32_32x32x16_bf16 v[48:63], v[80:83], v[96:99], v[48:63]
    ds_read_b128 v[76:79], v102 offset:5120
    ds_read_b128 v[80:83], v102 offset:5632
    ds_read_b128 v[72:75], v100 offset:6144
    v_cvt_pk_bf16_f32 v93, v114, v115
    v_exp_f32 v118, v22
    v_exp_f32 v119, v23
    v_cvt_pk_bf16_f32 v94, v116, v117
    v_exp_f32 v120, v24
    v_exp_f32 v121, v25
    v_cvt_pk_bf16_f32 v95, v118, v119
    v_exp_f32 v122, v26
    v_exp_f32 v123, v27
    v_mfma_f32_32x32x16_bf16 v[48:63], v[84:87], v[92:95], v[48:63]
    v_cvt_pk_bf16_f32 v96, v120, v121
    v_exp_f32 v124, v28
    v_exp_f32 v125, v29
    v_cvt_pk_bf16_f32 v97, v122, v123
    v_exp_f32 v126, v30
    v_exp_f32 v127, v31
    v_cvt_pk_bf16_f32 v98, v124, v125
    s_waitcnt lgkmcnt(0)
    v_mfma_f32_32x32x16_bf16 v[16:31], v[72:75], v[64:67], v[32:47]
    v_exp_f32 v112, v0
    v_exp_f32 v113, v1
    v_cvt_pk_bf16_f32 v99, v126, v127
    v_exp_f32 v114, v2
    v_exp_f32 v115, v3
    v_cvt_pk_bf16_f32 v92, v112, v113
    v_exp_f32 v116, v4
    v_exp_f32 v117, v5
    v_mfma_f32_32x32x16_bf16 v[48:63], v[88:91], v[96:99], v[48:63]
    ds_read_b128 v[84:87], v102 offset:7168
    ds_read_b128 v[88:91], v102 offset:7680
    v_cvt_pk_bf16_f32 v93, v114, v115
    v_exp_f32 v118, v6
    v_exp_f32 v119, v7
    v_cvt_pk_bf16_f32 v94, v116, v117
    v_exp_f32 v120, v8
    v_exp_f32 v121, v9
    v_cvt_pk_bf16_f32 v95, v118, v119
    v_exp_f32 v122, v10
    v_exp_f32 v123, v11
    v_mfma_f32_32x32x16_bf16 v[48:63], v[76:79], v[92:95], v[48:63]
    v_cvt_pk_bf16_f32 v96, v120, v121
    v_exp_f32 v124, v12
    v_exp_f32 v125, v13
    v_cvt_pk_bf16_f32 v97, v122, v123
    v_exp_f32 v126, v14
    v_exp_f32 v127, v15
    v_cvt_pk_bf16_f32 v98, v124, v125
    s_waitcnt vmcnt(0)
    s_barrier
    ds_read_b128 v[68:71], v100 offset:16384
    s_waitcnt lgkmcnt(0)
    v_mfma_f32_32x32x16_bf16 v[0:15], v[68:71], v[64:67], v[32:47]
    v_exp_f32 v112, v16
    v_exp_f32 v113, v17
    v_cvt_pk_bf16_f32 v99, v126, v127
    v_exp_f32 v114, v18
    v_exp_f32 v115, v19
    v_cvt_pk_bf16_f32 v92, v112, v113
    v_exp_f32 v116, v20
    v_exp_f32 v117, v21
    v_mfma_f32_32x32x16_bf16 v[48:63], v[80:83], v[96:99], v[48:63]
    v_add_u32 v103, v102, v105
    ds_read_b128 v[76:79], v103 offset:1024
    ds_read_b128 v[80:83], v103 offset:1536
    ds_read_b128 v[72:75], v100 offset:18432
    v_cvt_pk_bf16_f32 v93, v114, v115
    v_exp_f32 v118, v22
    v_exp_f32 v119, v23
    v_cvt_pk_bf16_f32 v94, v116, v117
    v_exp_f32 v120, v24
    v_exp_f32 v121, v25
    v_cvt_pk_bf16_f32 v95, v118, v119
    v_exp_f32 v122, v26
    v_exp_f32 v123, v27
    v_mfma_f32_32x32x16_bf16 v[48:63], v[84:87], v[92:95], v[48:63]
    v_cvt_pk_bf16_f32 v96, v120, v121
    v_exp_f32 v124, v28
    v_exp_f32 v125, v29
    v_cvt_pk_bf16_f32 v97, v122, v123
    v_exp_f32 v126, v30
    v_exp_f32 v127, v31
    v_cvt_pk_bf16_f32 v98, v124, v125
    s_waitcnt lgkmcnt(0)
    v_mfma_f32_32x32x16_bf16 v[16:31], v[72:75], v[64:67], v[32:47]
    v_exp_f32 v112, v0
    v_exp_f32 v113, v1
    v_cvt_pk_bf16_f32 v99, v126, v127
    v_exp_f32 v114, v2
    v_exp_f32 v115, v3
    v_cvt_pk_bf16_f32 v92, v112, v113
    v_exp_f32 v116, v4
    v_exp_f32 v117, v5
    v_mfma_f32_32x32x16_bf16 v[48:63], v[88:91], v[96:99], v[48:63]
    ds_read_b128 v[84:87], v103 offset:3072
    ds_read_b128 v[88:91], v103 offset:3584
    ds_read_b128 v[68:71], v100 offset:20480
    v_cvt_pk_bf16_f32 v93, v114, v115
    v_exp_f32 v118, v6
    v_exp_f32 v119, v7
    v_cvt_pk_bf16_f32 v94, v116, v117
    v_exp_f32 v120, v8
    v_exp_f32 v121, v9
    v_cvt_pk_bf16_f32 v95, v118, v119
    v_exp_f32 v122, v10
    v_exp_f32 v123, v11
    v_mfma_f32_32x32x16_bf16 v[48:63], v[76:79], v[92:95], v[48:63]
    v_cvt_pk_bf16_f32 v96, v120, v121
    v_exp_f32 v124, v12
    v_exp_f32 v125, v13
    v_cvt_pk_bf16_f32 v97, v122, v123
    v_exp_f32 v126, v14
    v_exp_f32 v127, v15
    v_cvt_pk_bf16_f32 v98, v124, v125
    s_waitcnt lgkmcnt(0)
    v_mfma_f32_32x32x16_bf16 v[0:15], v[68:71], v[64:67], v[32:47]
    v_exp_f32 v112, v16
    v_exp_f32 v113, v17
    v_cvt_pk_bf16_f32 v99, v126, v127
    v_exp_f32 v114, v18
    v_exp_f32 v115, v19
    v_cvt_pk_bf16_f32 v92, v112, v113
    v_exp_f32 v116, v20
    v_exp_f32 v117, v21
    v_mfma_f32_32x32x16_bf16 v[48:63], v[80:83], v[96:99], v[48:63]
    ds_read_b128 v[76:79], v103 offset:5120
    ds_read_b128 v[80:83], v103 offset:5632
    ds_read_b128 v[72:75], v100 offset:22528
    v_cvt_pk_bf16_f32 v93, v114, v115
    v_exp_f32 v118, v22
    v_exp_f32 v119, v23
    v_cvt_pk_bf16_f32 v94, v116, v117
    v_exp_f32 v120, v24
    v_exp_f32 v121, v25
    v_cvt_pk_bf16_f32 v95, v118, v119
    v_exp_f32 v122, v26
    v_exp_f32 v123, v27
    v_mfma_f32_32x32x16_bf16 v[48:63], v[84:87], v[92:95], v[48:63]
    v_cvt_pk_bf16_f32 v96, v120, v121
    v_exp_f32 v124, v28
    v_exp_f32 v125, v29
    v_cvt_pk_bf16_f32 v97, v122, v123
    v_exp_f32 v126, v30
    v_exp_f32 v127, v31
    v_cvt_pk_bf16_f32 v98, v124, v125
    s_waitcnt lgkmcnt(0)
    v_mfma_f32_32x32x16_bf16 v[16:31], v[72:75], v[64:67], v[32:47]
    v_exp_f32 v112, v0
    v_exp_f32 v113, v1
    v_cvt_pk_bf16_f32 v99, v126, v127
    v_exp_f32 v114, v2
    v_exp_f32 v115, v3
    v_cvt_pk_bf16_f32 v92, v112, v113
    v_exp_f32 v116, v4
    v_exp_f32 v117, v5
    v_mfma_f32_32x32x16_bf16 v[48:63], v[88:91], v[96:99], v[48:63]
    ds_read_b128 v[84:87], v103 offset:7168
    ds_read_b128 v[88:91], v103 offset:7680
    ds_read_b128 v[68:71], v100 offset:32768
    v_cvt_pk_bf16_f32 v93, v114, v115
    v_exp_f32 v118, v6
    v_exp_f32 v119, v7
    v_cvt_pk_bf16_f32 v94, v116, v117
    v_exp_f32 v120, v8
    v_exp_f32 v121, v9
    v_cvt_pk_bf16_f32 v95, v118, v119
    v_exp_f32 v122, v10
    v_exp_f32 v123, v11
    v_mfma_f32_32x32x16_bf16 v[48:63], v[76:79], v[92:95], v[48:63]
    v_cvt_pk_bf16_f32 v96, v120, v121
    v_exp_f32 v124, v12
    v_exp_f32 v125, v13
    v_cvt_pk_bf16_f32 v97, v122, v123
    v_exp_f32 v126, v14
    v_exp_f32 v127, v15
    v_cvt_pk_bf16_f32 v98, v124, v125
    s_waitcnt lgkmcnt(0)
    v_mfma_f32_32x32x16_bf16 v[0:15], v[68:71], v[64:67], v[32:47]
    v_exp_f32 v112, v16
    v_exp_f32 v113, v17
    v_cvt_pk_bf16_f32 v99, v126, v127
    v_exp_f32 v114, v18
    v_exp_f32 v115, v19
    v_cvt_pk_bf16_f32 v92, v112, v113
    v_exp_f32 v116, v20
    v_exp_f32 v117, v21
    v_mfma_f32_32x32x16_bf16 v[48:63], v[80:83], v[96:99], v[48:63]
    v_add_u32 v102, v103, v105
    ds_read_b128 v[76:79], v102 offset:1024
    ds_read_b128 v[80:83], v102 offset:1536
    ds_read_b128 v[72:75], v100 offset:34816
    v_cvt_pk_bf16_f32 v93, v114, v115
    v_exp_f32 v118, v22
    v_exp_f32 v119, v23
    v_cvt_pk_bf16_f32 v94, v116, v117
    v_exp_f32 v120, v24
    v_exp_f32 v121, v25
    v_cvt_pk_bf16_f32 v95, v118, v119
    v_exp_f32 v122, v26
    v_exp_f32 v123, v27
    v_mfma_f32_32x32x16_bf16 v[48:63], v[84:87], v[92:95], v[48:63]
    v_cvt_pk_bf16_f32 v96, v120, v121
    v_exp_f32 v124, v28
    v_exp_f32 v125, v29
    v_cvt_pk_bf16_f32 v97, v122, v123
    v_exp_f32 v126, v30
    v_exp_f32 v127, v31
    v_cvt_pk_bf16_f32 v98, v124, v125
    s_barrier
    s_waitcnt lgkmcnt(0)
    v_mfma_f32_32x32x16_bf16 v[16:31], v[72:75], v[64:67], v[32:47]
    v_exp_f32 v112, v0
    v_exp_f32 v113, v1
    v_cvt_pk_bf16_f32 v99, v126, v127
    v_exp_f32 v114, v2
    v_exp_f32 v115, v3
    v_cvt_pk_bf16_f32 v92, v112, v113
    v_exp_f32 v116, v4
    v_exp_f32 v117, v5
    v_mfma_f32_32x32x16_bf16 v[48:63], v[88:91], v[96:99], v[48:63]
    ds_read_b128 v[84:87], v102 offset:3072
    ds_read_b128 v[88:91], v102 offset:3584
    ds_read_b128 v[68:71], v100 offset:36864
    v_cvt_pk_bf16_f32 v93, v114, v115
    v_exp_f32 v118, v6
    v_exp_f32 v119, v7
    v_cvt_pk_bf16_f32 v94, v116, v117
    v_exp_f32 v120, v8
    v_exp_f32 v121, v9
    v_cvt_pk_bf16_f32 v95, v118, v119
    v_exp_f32 v122, v10
    v_exp_f32 v123, v11
    v_mfma_f32_32x32x16_bf16 v[48:63], v[76:79], v[92:95], v[48:63]
    v_cvt_pk_bf16_f32 v96, v120, v121
    v_exp_f32 v124, v12
    v_exp_f32 v125, v13
    v_cvt_pk_bf16_f32 v97, v122, v123
    v_exp_f32 v126, v14
    v_exp_f32 v127, v15
    v_cvt_pk_bf16_f32 v98, v124, v125
    s_waitcnt lgkmcnt(0)
    v_mfma_f32_32x32x16_bf16 v[0:15], v[68:71], v[64:67], v[32:47]
    v_exp_f32 v112, v16
    v_exp_f32 v113, v17
    v_cvt_pk_bf16_f32 v99, v126, v127
    v_exp_f32 v114, v18
    v_exp_f32 v115, v19
    v_cvt_pk_bf16_f32 v92, v112, v113
    v_exp_f32 v116, v20
    v_exp_f32 v117, v21
    v_mfma_f32_32x32x16_bf16 v[48:63], v[80:83], v[96:99], v[48:63]
    ds_read_b128 v[76:79], v102 offset:5120
    ds_read_b128 v[80:83], v102 offset:5632
    ds_read_b128 v[72:75], v100 offset:38912
    v_cvt_pk_bf16_f32 v93, v114, v115
    v_exp_f32 v118, v22
    v_exp_f32 v119, v23
    v_cvt_pk_bf16_f32 v94, v116, v117
    v_exp_f32 v120, v24
    v_exp_f32 v121, v25
    v_cvt_pk_bf16_f32 v95, v118, v119
    v_exp_f32 v122, v26
    v_exp_f32 v123, v27
    v_mfma_f32_32x32x16_bf16 v[48:63], v[84:87], v[92:95], v[48:63]
    v_cvt_pk_bf16_f32 v96, v120, v121
    v_exp_f32 v124, v28
    v_exp_f32 v125, v29
    v_cvt_pk_bf16_f32 v97, v122, v123
    v_exp_f32 v126, v30
    v_exp_f32 v127, v31
    v_cvt_pk_bf16_f32 v98, v124, v125
    s_waitcnt lgkmcnt(0)
    v_mfma_f32_32x32x16_bf16 v[16:31], v[72:75], v[64:67], v[32:47]
    v_exp_f32 v112, v0
    v_exp_f32 v113, v1
    v_cvt_pk_bf16_f32 v99, v126, v127
    v_exp_f32 v114, v2
    v_exp_f32 v115, v3
    v_cvt_pk_bf16_f32 v92, v112, v113
    v_exp_f32 v116, v4
    v_exp_f32 v117, v5
    v_mfma_f32_32x32x16_bf16 v[48:63], v[88:91], v[96:99], v[48:63]
    ds_read_b128 v[84:87], v102 offset:7168
    ds_read_b128 v[88:91], v102 offset:7680
    ds_read_b128 v[68:71], v100 offset:49152
    v_cvt_pk_bf16_f32 v93, v114, v115
    v_exp_f32 v118, v6
    v_exp_f32 v119, v7
    v_cvt_pk_bf16_f32 v94, v116, v117
    v_exp_f32 v120, v8
    v_exp_f32 v121, v9
    v_cvt_pk_bf16_f32 v95, v118, v119
    v_exp_f32 v122, v10
    v_exp_f32 v123, v11
    v_mfma_f32_32x32x16_bf16 v[48:63], v[76:79], v[92:95], v[48:63]
    v_cvt_pk_bf16_f32 v96, v120, v121
    v_exp_f32 v124, v12
    v_exp_f32 v125, v13
    v_cvt_pk_bf16_f32 v97, v122, v123
    v_exp_f32 v126, v14
    v_exp_f32 v127, v15
    v_cvt_pk_bf16_f32 v98, v124, v125
    s_waitcnt lgkmcnt(0)
    v_mfma_f32_32x32x16_bf16 v[0:15], v[68:71], v[64:67], v[32:47]
    v_exp_f32 v112, v16
    v_exp_f32 v113, v17
    v_cvt_pk_bf16_f32 v99, v126, v127
    v_exp_f32 v114, v18
    v_exp_f32 v115, v19
    v_cvt_pk_bf16_f32 v92, v112, v113
    v_exp_f32 v116, v20
    v_exp_f32 v117, v21
    v_mfma_f32_32x32x16_bf16 v[48:63], v[80:83], v[96:99], v[48:63]
    v_add_u32 v103, v102, v105
    ds_read_b128 v[76:79], v103 offset:1024
    ds_read_b128 v[80:83], v103 offset:1536
    ds_read_b128 v[72:75], v100 offset:51200
    v_cvt_pk_bf16_f32 v93, v114, v115
    v_exp_f32 v118, v22
    v_exp_f32 v119, v23
    v_cvt_pk_bf16_f32 v94, v116, v117
    v_exp_f32 v120, v24
    v_exp_f32 v121, v25
    v_cvt_pk_bf16_f32 v95, v118, v119
    v_exp_f32 v122, v26
    v_exp_f32 v123, v27
    v_mfma_f32_32x32x16_bf16 v[48:63], v[84:87], v[92:95], v[48:63]
    v_cvt_pk_bf16_f32 v96, v120, v121
    v_exp_f32 v124, v28
    v_exp_f32 v125, v29
    v_cvt_pk_bf16_f32 v97, v122, v123
    v_exp_f32 v126, v30
    v_exp_f32 v127, v31
    v_cvt_pk_bf16_f32 v98, v124, v125
    s_waitcnt lgkmcnt(0)
    v_mfma_f32_32x32x16_bf16 v[16:31], v[72:75], v[64:67], v[32:47]
    v_exp_f32 v112, v0
    v_exp_f32 v113, v1
    v_cvt_pk_bf16_f32 v99, v126, v127
    v_exp_f32 v114, v2
    v_exp_f32 v115, v3
    v_cvt_pk_bf16_f32 v92, v112, v113
    v_exp_f32 v116, v4
    v_exp_f32 v117, v5
    v_mfma_f32_32x32x16_bf16 v[48:63], v[88:91], v[96:99], v[48:63]
    ds_read_b128 v[84:87], v103 offset:3072
    ds_read_b128 v[88:91], v103 offset:3584
    ds_read_b128 v[68:71], v100 offset:53248
    v_cvt_pk_bf16_f32 v93, v114, v115
    v_exp_f32 v118, v6
    v_exp_f32 v119, v7
    v_cvt_pk_bf16_f32 v94, v116, v117
    v_exp_f32 v120, v8
    v_exp_f32 v121, v9
    v_cvt_pk_bf16_f32 v95, v118, v119
    v_exp_f32 v122, v10
    v_exp_f32 v123, v11
    v_mfma_f32_32x32x16_bf16 v[48:63], v[76:79], v[92:95], v[48:63]
    v_cvt_pk_bf16_f32 v96, v120, v121
    v_exp_f32 v124, v12
    v_exp_f32 v125, v13
    v_cvt_pk_bf16_f32 v97, v122, v123
    v_exp_f32 v126, v14
    v_exp_f32 v127, v15
    v_cvt_pk_bf16_f32 v98, v124, v125
    s_waitcnt lgkmcnt(0)
    v_mfma_f32_32x32x16_bf16 v[0:15], v[68:71], v[64:67], v[32:47]
    v_exp_f32 v112, v16
    v_exp_f32 v113, v17
    v_cvt_pk_bf16_f32 v99, v126, v127
    v_exp_f32 v114, v18
    v_exp_f32 v115, v19
    v_cvt_pk_bf16_f32 v92, v112, v113
    v_exp_f32 v116, v20
    v_exp_f32 v117, v21
    v_mfma_f32_32x32x16_bf16 v[48:63], v[80:83], v[96:99], v[48:63]
    ds_read_b128 v[76:79], v103 offset:5120
    ds_read_b128 v[80:83], v103 offset:5632
    ds_read_b128 v[72:75], v100 offset:55296
    v_cvt_pk_bf16_f32 v93, v114, v115
    v_exp_f32 v118, v22
    v_exp_f32 v119, v23
    v_cvt_pk_bf16_f32 v94, v116, v117
    v_exp_f32 v120, v24
    v_exp_f32 v121, v25
    v_cvt_pk_bf16_f32 v95, v118, v119
    v_exp_f32 v122, v26
    v_exp_f32 v123, v27
    v_mfma_f32_32x32x16_bf16 v[48:63], v[84:87], v[92:95], v[48:63]
    v_cvt_pk_bf16_f32 v96, v120, v121
    v_exp_f32 v124, v28
    v_exp_f32 v125, v29
    v_cvt_pk_bf16_f32 v97, v122, v123
    v_exp_f32 v126, v30
    v_exp_f32 v127, v31
    v_cvt_pk_bf16_f32 v98, v124, v125
    s_waitcnt lgkmcnt(0)
    v_mfma_f32_32x32x16_bf16 v[16:31], v[72:75], v[64:67], v[32:47]
    v_exp_f32 v112, v0
    v_exp_f32 v113, v1
    v_cvt_pk_bf16_f32 v99, v126, v127
    v_exp_f32 v114, v2
    v_exp_f32 v115, v3
    v_cvt_pk_bf16_f32 v92, v112, v113
    v_exp_f32 v116, v4
    v_exp_f32 v117, v5
    v_mfma_f32_32x32x16_bf16 v[48:63], v[88:91], v[96:99], v[48:63]
    ds_read_b128 v[84:87], v103 offset:7168
    ds_read_b128 v[88:91], v103 offset:7680
    ds_read_b128 v[68:71], v101 offset:0
    v_cvt_pk_bf16_f32 v93, v114, v115
    v_exp_f32 v118, v6
    v_exp_f32 v119, v7
    v_cvt_pk_bf16_f32 v94, v116, v117
    v_exp_f32 v120, v8
    v_exp_f32 v121, v9
    v_cvt_pk_bf16_f32 v95, v118, v119
    v_exp_f32 v122, v10
    v_exp_f32 v123, v11
    v_mfma_f32_32x32x16_bf16 v[48:63], v[76:79], v[92:95], v[48:63]
    v_cvt_pk_bf16_f32 v96, v120, v121
    v_exp_f32 v124, v12
    v_exp_f32 v125, v13
    v_cvt_pk_bf16_f32 v97, v122, v123
    v_exp_f32 v126, v14
    v_exp_f32 v127, v15
    v_cvt_pk_bf16_f32 v98, v124, v125
    s_waitcnt lgkmcnt(0)
    v_mfma_f32_32x32x16_bf16 v[0:15], v[68:71], v[64:67], v[32:47]
    v_exp_f32 v112, v16
    v_exp_f32 v113, v17
    v_cvt_pk_bf16_f32 v99, v126, v127
    v_exp_f32 v114, v18
    v_exp_f32 v115, v19
    v_cvt_pk_bf16_f32 v92, v112, v113
    v_exp_f32 v116, v20
    v_exp_f32 v117, v21
    v_mfma_f32_32x32x16_bf16 v[48:63], v[80:83], v[96:99], v[48:63]
    v_add_u32 v102, v103, v105
    ds_read_b128 v[76:79], v102 offset:1024
    ds_read_b128 v[80:83], v102 offset:1536
    ds_read_b128 v[72:75], v101 offset:2048
    v_cvt_pk_bf16_f32 v93, v114, v115
    v_exp_f32 v118, v22
    v_exp_f32 v119, v23
    v_cvt_pk_bf16_f32 v94, v116, v117
    v_exp_f32 v120, v24
    v_exp_f32 v121, v25
    v_cvt_pk_bf16_f32 v95, v118, v119
    v_exp_f32 v122, v26
    v_exp_f32 v123, v27
    v_mfma_f32_32x32x16_bf16 v[48:63], v[84:87], v[92:95], v[48:63]
    v_cvt_pk_bf16_f32 v96, v120, v121
    v_exp_f32 v124, v28
    v_exp_f32 v125, v29
    v_cvt_pk_bf16_f32 v97, v122, v123
    v_exp_f32 v126, v30
    v_exp_f32 v127, v31
    v_cvt_pk_bf16_f32 v98, v124, v125
    s_barrier
    s_waitcnt lgkmcnt(0)
    v_mfma_f32_32x32x16_bf16 v[16:31], v[72:75], v[64:67], v[32:47]
    v_exp_f32 v112, v0
    v_exp_f32 v113, v1
    v_cvt_pk_bf16_f32 v99, v126, v127
    v_exp_f32 v114, v2
    v_exp_f32 v115, v3
    v_cvt_pk_bf16_f32 v92, v112, v113
    v_exp_f32 v116, v4
    v_exp_f32 v117, v5
    v_mfma_f32_32x32x16_bf16 v[48:63], v[88:91], v[96:99], v[48:63]
    ds_read_b128 v[84:87], v102 offset:3072
    ds_read_b128 v[88:91], v102 offset:3584
    ds_read_b128 v[68:71], v101 offset:4096
    v_cvt_pk_bf16_f32 v93, v114, v115
    v_exp_f32 v118, v6
    v_exp_f32 v119, v7
    v_cvt_pk_bf16_f32 v94, v116, v117
    v_exp_f32 v120, v8
    v_exp_f32 v121, v9
    v_cvt_pk_bf16_f32 v95, v118, v119
    v_exp_f32 v122, v10
    v_exp_f32 v123, v11
    v_mfma_f32_32x32x16_bf16 v[48:63], v[76:79], v[92:95], v[48:63]
    v_cvt_pk_bf16_f32 v96, v120, v121
    v_exp_f32 v124, v12
    v_exp_f32 v125, v13
    v_cvt_pk_bf16_f32 v97, v122, v123
    v_exp_f32 v126, v14
    v_exp_f32 v127, v15
    v_cvt_pk_bf16_f32 v98, v124, v125
    s_waitcnt lgkmcnt(0)
    v_mfma_f32_32x32x16_bf16 v[0:15], v[68:71], v[64:67], v[32:47]
    v_exp_f32 v112, v16
    v_exp_f32 v113, v17
    v_cvt_pk_bf16_f32 v99, v126, v127
    v_exp_f32 v114, v18
    v_exp_f32 v115, v19
    v_cvt_pk_bf16_f32 v92, v112, v113
    v_exp_f32 v116, v20
    v_exp_f32 v117, v21
    v_mfma_f32_32x32x16_bf16 v[48:63], v[80:83], v[96:99], v[48:63]
    ds_read_b128 v[76:79], v102 offset:5120
    ds_read_b128 v[80:83], v102 offset:5632
    ds_read_b128 v[72:75], v101 offset:6144
    v_cvt_pk_bf16_f32 v93, v114, v115
    v_exp_f32 v118, v22
    v_exp_f32 v119, v23
    v_cvt_pk_bf16_f32 v94, v116, v117
    v_exp_f32 v120, v24
    v_exp_f32 v121, v25
    v_cvt_pk_bf16_f32 v95, v118, v119
    v_exp_f32 v122, v26
    v_exp_f32 v123, v27
    v_mfma_f32_32x32x16_bf16 v[48:63], v[84:87], v[92:95], v[48:63]
    v_cvt_pk_bf16_f32 v96, v120, v121
    v_exp_f32 v124, v28
    v_exp_f32 v125, v29
    v_cvt_pk_bf16_f32 v97, v122, v123
    v_exp_f32 v126, v30
    v_exp_f32 v127, v31
    v_cvt_pk_bf16_f32 v98, v124, v125
    s_waitcnt lgkmcnt(0)
    v_mfma_f32_32x32x16_bf16 v[16:31], v[72:75], v[64:67], v[32:47]
    v_exp_f32 v112, v0
    v_exp_f32 v113, v1
    v_cvt_pk_bf16_f32 v99, v126, v127
    v_exp_f32 v114, v2
    v_exp_f32 v115, v3
    v_cvt_pk_bf16_f32 v92, v112, v113
    v_exp_f32 v116, v4
    v_exp_f32 v117, v5
    v_mfma_f32_32x32x16_bf16 v[48:63], v[88:91], v[96:99], v[48:63]
    ds_read_b128 v[84:87], v102 offset:7168
    ds_read_b128 v[88:91], v102 offset:7680
    ds_read_b128 v[68:71], v101 offset:16384
    v_cvt_pk_bf16_f32 v93, v114, v115
    v_exp_f32 v118, v6
    v_exp_f32 v119, v7
    v_cvt_pk_bf16_f32 v94, v116, v117
    v_exp_f32 v120, v8
    v_exp_f32 v121, v9
    v_cvt_pk_bf16_f32 v95, v118, v119
    v_exp_f32 v122, v10
    v_exp_f32 v123, v11
    v_mfma_f32_32x32x16_bf16 v[48:63], v[76:79], v[92:95], v[48:63]
    v_cvt_pk_bf16_f32 v96, v120, v121
    v_exp_f32 v124, v12
    v_exp_f32 v125, v13
    v_cvt_pk_bf16_f32 v97, v122, v123
    v_exp_f32 v126, v14
    v_exp_f32 v127, v15
    v_cvt_pk_bf16_f32 v98, v124, v125
    s_waitcnt lgkmcnt(0)
    v_mfma_f32_32x32x16_bf16 v[0:15], v[68:71], v[64:67], v[32:47]
    v_exp_f32 v112, v16
    v_exp_f32 v113, v17
    v_cvt_pk_bf16_f32 v99, v126, v127
    v_exp_f32 v114, v18
    v_exp_f32 v115, v19
    v_cvt_pk_bf16_f32 v92, v112, v113
    v_exp_f32 v116, v20
    v_exp_f32 v117, v21
    v_mfma_f32_32x32x16_bf16 v[48:63], v[80:83], v[96:99], v[48:63]
    v_add_u32 v103, v102, v105
    ds_read_b128 v[76:79], v103 offset:1024
    ds_read_b128 v[80:83], v103 offset:1536
    ds_read_b128 v[72:75], v101 offset:18432
    v_cvt_pk_bf16_f32 v93, v114, v115
    v_exp_f32 v118, v22
    v_exp_f32 v119, v23
    v_cvt_pk_bf16_f32 v94, v116, v117
    v_exp_f32 v120, v24
    v_exp_f32 v121, v25
    v_cvt_pk_bf16_f32 v95, v118, v119
    v_exp_f32 v122, v26
    v_exp_f32 v123, v27
    v_mfma_f32_32x32x16_bf16 v[48:63], v[84:87], v[92:95], v[48:63]
    v_cvt_pk_bf16_f32 v96, v120, v121
    v_exp_f32 v124, v28
    v_exp_f32 v125, v29
    v_cvt_pk_bf16_f32 v97, v122, v123
    v_exp_f32 v126, v30
    v_exp_f32 v127, v31
    v_cvt_pk_bf16_f32 v98, v124, v125
    s_waitcnt lgkmcnt(0)
    v_mfma_f32_32x32x16_bf16 v[16:31], v[72:75], v[64:67], v[32:47]
    v_exp_f32 v112, v0
    v_exp_f32 v113, v1
    v_cvt_pk_bf16_f32 v99, v126, v127
    v_exp_f32 v114, v2
    v_exp_f32 v115, v3
    v_cvt_pk_bf16_f32 v92, v112, v113
    v_exp_f32 v116, v4
    v_exp_f32 v117, v5
    v_mfma_f32_32x32x16_bf16 v[48:63], v[88:91], v[96:99], v[48:63]
    ds_read_b128 v[84:87], v103 offset:3072
    ds_read_b128 v[88:91], v103 offset:3584
    ds_read_b128 v[68:71], v101 offset:20480
    v_cvt_pk_bf16_f32 v93, v114, v115
    v_exp_f32 v118, v6
    v_exp_f32 v119, v7
    v_cvt_pk_bf16_f32 v94, v116, v117
    v_exp_f32 v120, v8
    v_exp_f32 v121, v9
    v_cvt_pk_bf16_f32 v95, v118, v119
    v_exp_f32 v122, v10
    v_exp_f32 v123, v11
    v_mfma_f32_32x32x16_bf16 v[48:63], v[76:79], v[92:95], v[48:63]
    v_cvt_pk_bf16_f32 v96, v120, v121
    v_exp_f32 v124, v12
    v_exp_f32 v125, v13
    v_cvt_pk_bf16_f32 v97, v122, v123
    v_exp_f32 v126, v14
    v_exp_f32 v127, v15
    v_cvt_pk_bf16_f32 v98, v124, v125
    s_waitcnt lgkmcnt(0)
    v_mfma_f32_32x32x16_bf16 v[0:15], v[68:71], v[64:67], v[32:47]
    v_exp_f32 v112, v16
    v_exp_f32 v113, v17
    v_cvt_pk_bf16_f32 v99, v126, v127
    v_exp_f32 v114, v18
    v_exp_f32 v115, v19
    v_cvt_pk_bf16_f32 v92, v112, v113
    v_exp_f32 v116, v20
    v_exp_f32 v117, v21
    v_mfma_f32_32x32x16_bf16 v[48:63], v[80:83], v[96:99], v[48:63]
    ds_read_b128 v[76:79], v103 offset:5120
    ds_read_b128 v[80:83], v103 offset:5632
    ds_read_b128 v[72:75], v101 offset:22528
    v_cvt_pk_bf16_f32 v93, v114, v115
    v_exp_f32 v118, v22
    v_exp_f32 v119, v23
    v_cvt_pk_bf16_f32 v94, v116, v117
    v_exp_f32 v120, v24
    v_exp_f32 v121, v25
    v_cvt_pk_bf16_f32 v95, v118, v119
    v_exp_f32 v122, v26
    v_exp_f32 v123, v27
    v_mfma_f32_32x32x16_bf16 v[48:63], v[84:87], v[92:95], v[48:63]
    v_cvt_pk_bf16_f32 v96, v120, v121
    v_exp_f32 v124, v28
    v_exp_f32 v125, v29
    v_cvt_pk_bf16_f32 v97, v122, v123
    v_exp_f32 v126, v30
    v_exp_f32 v127, v31
    v_cvt_pk_bf16_f32 v98, v124, v125
    s_waitcnt lgkmcnt(0)
    v_mfma_f32_32x32x16_bf16 v[16:31], v[72:75], v[64:67], v[32:47]
    v_exp_f32 v112, v0
    v_exp_f32 v113, v1
    v_cvt_pk_bf16_f32 v99, v126, v127
    v_exp_f32 v114, v2
    v_exp_f32 v115, v3
    v_cvt_pk_bf16_f32 v92, v112, v113
    v_exp_f32 v116, v4
    v_exp_f32 v117, v5
    v_mfma_f32_32x32x16_bf16 v[48:63], v[88:91], v[96:99], v[48:63]
    ds_read_b128 v[84:87], v103 offset:7168
    ds_read_b128 v[88:91], v103 offset:7680
    ds_read_b128 v[68:71], v101 offset:32768
    v_cvt_pk_bf16_f32 v93, v114, v115
    v_exp_f32 v118, v6
    v_exp_f32 v119, v7
    v_cvt_pk_bf16_f32 v94, v116, v117
    v_exp_f32 v120, v8
    v_exp_f32 v121, v9
    v_cvt_pk_bf16_f32 v95, v118, v119
    v_exp_f32 v122, v10
    v_exp_f32 v123, v11
    v_mfma_f32_32x32x16_bf16 v[48:63], v[76:79], v[92:95], v[48:63]
    v_cvt_pk_bf16_f32 v96, v120, v121
    v_exp_f32 v124, v12
    v_exp_f32 v125, v13
    v_cvt_pk_bf16_f32 v97, v122, v123
    v_exp_f32 v126, v14
    v_exp_f32 v127, v15
    v_cvt_pk_bf16_f32 v98, v124, v125
    s_waitcnt lgkmcnt(0)
    v_mfma_f32_32x32x16_bf16 v[0:15], v[68:71], v[64:67], v[32:47]
    v_exp_f32 v112, v16
    v_exp_f32 v113, v17
    v_cvt_pk_bf16_f32 v99, v126, v127
    v_exp_f32 v114, v18
    v_exp_f32 v115, v19
    v_cvt_pk_bf16_f32 v92, v112, v113
    v_exp_f32 v116, v20
    v_exp_f32 v117, v21
    v_mfma_f32_32x32x16_bf16 v[48:63], v[80:83], v[96:99], v[48:63]
    v_add_u32 v102, v103, v105
    ds_read_b128 v[76:79], v102 offset:1024
    ds_read_b128 v[80:83], v102 offset:1536
    ds_read_b128 v[72:75], v101 offset:34816
    v_cvt_pk_bf16_f32 v93, v114, v115
    v_exp_f32 v118, v22
    v_exp_f32 v119, v23
    v_cvt_pk_bf16_f32 v94, v116, v117
    v_exp_f32 v120, v24
    v_exp_f32 v121, v25
    v_cvt_pk_bf16_f32 v95, v118, v119
    v_exp_f32 v122, v26
    v_exp_f32 v123, v27
    v_mfma_f32_32x32x16_bf16 v[48:63], v[84:87], v[92:95], v[48:63]
    v_cvt_pk_bf16_f32 v96, v120, v121
    v_exp_f32 v124, v28
    v_exp_f32 v125, v29
    v_cvt_pk_bf16_f32 v97, v122, v123
    v_exp_f32 v126, v30
    v_exp_f32 v127, v31
    v_cvt_pk_bf16_f32 v98, v124, v125
    s_barrier
    s_waitcnt lgkmcnt(0)
    v_mfma_f32_32x32x16_bf16 v[16:31], v[72:75], v[64:67], v[32:47]
    v_exp_f32 v112, v0
    v_exp_f32 v113, v1
    v_cvt_pk_bf16_f32 v99, v126, v127
    v_exp_f32 v114, v2
    v_exp_f32 v115, v3
    v_cvt_pk_bf16_f32 v92, v112, v113
    v_exp_f32 v116, v4
    v_exp_f32 v117, v5
    v_mfma_f32_32x32x16_bf16 v[48:63], v[88:91], v[96:99], v[48:63]
    ds_read_b128 v[84:87], v102 offset:3072
    ds_read_b128 v[88:91], v102 offset:3584
    ds_read_b128 v[68:71], v101 offset:36864
    v_cvt_pk_bf16_f32 v93, v114, v115
    v_exp_f32 v118, v6
    v_exp_f32 v119, v7
    v_cvt_pk_bf16_f32 v94, v116, v117
    v_exp_f32 v120, v8
    v_exp_f32 v121, v9
    v_cvt_pk_bf16_f32 v95, v118, v119
    v_exp_f32 v122, v10
    v_exp_f32 v123, v11
    v_mfma_f32_32x32x16_bf16 v[48:63], v[76:79], v[92:95], v[48:63]
    v_cvt_pk_bf16_f32 v96, v120, v121
    v_exp_f32 v124, v12
    v_exp_f32 v125, v13
    v_cvt_pk_bf16_f32 v97, v122, v123
    v_exp_f32 v126, v14
    v_exp_f32 v127, v15
    v_cvt_pk_bf16_f32 v98, v124, v125
    s_waitcnt lgkmcnt(0)
    v_mfma_f32_32x32x16_bf16 v[0:15], v[68:71], v[64:67], v[32:47]
    v_exp_f32 v112, v16
    v_exp_f32 v113, v17
    v_cvt_pk_bf16_f32 v99, v126, v127
    v_exp_f32 v114, v18
    v_exp_f32 v115, v19
    v_cvt_pk_bf16_f32 v92, v112, v113
    v_exp_f32 v116, v20
    v_exp_f32 v117, v21
    v_mfma_f32_32x32x16_bf16 v[48:63], v[80:83], v[96:99], v[48:63]
    ds_read_b128 v[76:79], v102 offset:5120
    ds_read_b128 v[80:83], v102 offset:5632
    ds_read_b128 v[72:75], v101 offset:38912
    v_cvt_pk_bf16_f32 v93, v114, v115
    v_exp_f32 v118, v22
    v_exp_f32 v119, v23
    v_cvt_pk_bf16_f32 v94, v116, v117
    v_exp_f32 v120, v24
    v_exp_f32 v121, v25
    v_cvt_pk_bf16_f32 v95, v118, v119
    v_exp_f32 v122, v26
    v_exp_f32 v123, v27
    v_mfma_f32_32x32x16_bf16 v[48:63], v[84:87], v[92:95], v[48:63]
    v_cvt_pk_bf16_f32 v96, v120, v121
    v_exp_f32 v124, v28
    v_exp_f32 v125, v29
    v_cvt_pk_bf16_f32 v97, v122, v123
    v_exp_f32 v126, v30
    v_exp_f32 v127, v31
    v_cvt_pk_bf16_f32 v98, v124, v125
    s_waitcnt lgkmcnt(0)
    v_mfma_f32_32x32x16_bf16 v[16:31], v[72:75], v[64:67], v[32:47]
    v_exp_f32 v112, v0
    v_exp_f32 v113, v1
    v_cvt_pk_bf16_f32 v99, v126, v127
    v_exp_f32 v114, v2
    v_exp_f32 v115, v3
    v_cvt_pk_bf16_f32 v92, v112, v113
    v_exp_f32 v116, v4
    v_exp_f32 v117, v5
    v_mfma_f32_32x32x16_bf16 v[48:63], v[88:91], v[96:99], v[48:63]
    ds_read_b128 v[84:87], v102 offset:7168
    ds_read_b128 v[88:91], v102 offset:7680
    ds_read_b128 v[68:71], v101 offset:49152
    v_cvt_pk_bf16_f32 v93, v114, v115
    v_exp_f32 v118, v6
    v_exp_f32 v119, v7
    v_cvt_pk_bf16_f32 v94, v116, v117
    v_exp_f32 v120, v8
    v_exp_f32 v121, v9
    v_cvt_pk_bf16_f32 v95, v118, v119
    v_exp_f32 v122, v10
    v_exp_f32 v123, v11
    v_mfma_f32_32x32x16_bf16 v[48:63], v[76:79], v[92:95], v[48:63]
    v_cvt_pk_bf16_f32 v96, v120, v121
    v_exp_f32 v124, v12
    v_exp_f32 v125, v13
    v_cvt_pk_bf16_f32 v97, v122, v123
    v_exp_f32 v126, v14
    v_exp_f32 v127, v15
    v_cvt_pk_bf16_f32 v98, v124, v125
    s_waitcnt lgkmcnt(0)
    v_mfma_f32_32x32x16_bf16 v[0:15], v[68:71], v[64:67], v[32:47]
    v_exp_f32 v112, v16
    v_exp_f32 v113, v17
    v_cvt_pk_bf16_f32 v99, v126, v127
    v_exp_f32 v114, v18
    v_exp_f32 v115, v19
    v_cvt_pk_bf16_f32 v92, v112, v113
    v_exp_f32 v116, v20
    v_exp_f32 v117, v21
    v_mfma_f32_32x32x16_bf16 v[48:63], v[80:83], v[96:99], v[48:63]
    v_add_u32 v103, v102, v105
    ds_read_b128 v[76:79], v103 offset:1024
    ds_read_b128 v[80:83], v103 offset:1536
    ds_read_b128 v[72:75], v101 offset:51200
    v_cvt_pk_bf16_f32 v93, v114, v115
    v_exp_f32 v118, v22
    v_exp_f32 v119, v23
    v_cvt_pk_bf16_f32 v94, v116, v117
    v_exp_f32 v120, v24
    v_exp_f32 v121, v25
    v_cvt_pk_bf16_f32 v95, v118, v119
    v_exp_f32 v122, v26
    v_exp_f32 v123, v27
    v_mfma_f32_32x32x16_bf16 v[48:63], v[84:87], v[92:95], v[48:63]
    v_cvt_pk_bf16_f32 v96, v120, v121
    v_exp_f32 v124, v28
    v_exp_f32 v125, v29
    v_cvt_pk_bf16_f32 v97, v122, v123
    v_exp_f32 v126, v30
    v_exp_f32 v127, v31
    v_cvt_pk_bf16_f32 v98, v124, v125
    s_waitcnt lgkmcnt(0)
    v_mfma_f32_32x32x16_bf16 v[16:31], v[72:75], v[64:67], v[32:47]
    v_exp_f32 v112, v0
    v_exp_f32 v113, v1
    v_cvt_pk_bf16_f32 v99, v126, v127
    v_exp_f32 v114, v2
    v_exp_f32 v115, v3
    v_cvt_pk_bf16_f32 v92, v112, v113
    v_exp_f32 v116, v4
    v_exp_f32 v117, v5
    v_mfma_f32_32x32x16_bf16 v[48:63], v[88:91], v[96:99], v[48:63]
    ds_read_b128 v[84:87], v103 offset:3072
    ds_read_b128 v[88:91], v103 offset:3584
    ds_read_b128 v[68:71], v101 offset:53248
    v_cvt_pk_bf16_f32 v93, v114, v115
    v_exp_f32 v118, v6
    v_exp_f32 v119, v7
    v_cvt_pk_bf16_f32 v94, v116, v117
    v_exp_f32 v120, v8
    v_exp_f32 v121, v9
    v_cvt_pk_bf16_f32 v95, v118, v119
    v_exp_f32 v122, v10
    v_exp_f32 v123, v11
    v_mfma_f32_32x32x16_bf16 v[48:63], v[76:79], v[92:95], v[48:63]
    v_cvt_pk_bf16_f32 v96, v120, v121
    v_exp_f32 v124, v12
    v_exp_f32 v125, v13
    v_cvt_pk_bf16_f32 v97, v122, v123
    v_exp_f32 v126, v14
    v_exp_f32 v127, v15
    v_cvt_pk_bf16_f32 v98, v124, v125
    s_waitcnt lgkmcnt(0)
    v_mfma_f32_32x32x16_bf16 v[0:15], v[68:71], v[64:67], v[32:47]
    v_exp_f32 v112, v16
    v_exp_f32 v113, v17
    v_cvt_pk_bf16_f32 v99, v126, v127
    v_exp_f32 v114, v18
    v_exp_f32 v115, v19
    v_cvt_pk_bf16_f32 v92, v112, v113
    v_exp_f32 v116, v20
    v_exp_f32 v117, v21
    v_mfma_f32_32x32x16_bf16 v[48:63], v[80:83], v[96:99], v[48:63]
    ds_read_b128 v[76:79], v103 offset:5120
    ds_read_b128 v[80:83], v103 offset:5632
    ds_read_b128 v[72:75], v101 offset:55296
    v_cvt_pk_bf16_f32 v93, v114, v115
    v_exp_f32 v118, v22
    v_exp_f32 v119, v23
    v_cvt_pk_bf16_f32 v94, v116, v117
    v_exp_f32 v120, v24
    v_exp_f32 v121, v25
    v_cvt_pk_bf16_f32 v95, v118, v119
    v_exp_f32 v122, v26
    v_exp_f32 v123, v27
    v_mfma_f32_32x32x16_bf16 v[48:63], v[84:87], v[92:95], v[48:63]
    v_cvt_pk_bf16_f32 v96, v120, v121
    v_exp_f32 v124, v28
    v_exp_f32 v125, v29
    v_cvt_pk_bf16_f32 v97, v122, v123
    v_exp_f32 v126, v30
    v_exp_f32 v127, v31
    v_cvt_pk_bf16_f32 v98, v124, v125
    s_waitcnt lgkmcnt(0)
    v_mfma_f32_32x32x16_bf16 v[16:31], v[72:75], v[64:67], v[32:47]
    v_exp_f32 v112, v0
    v_exp_f32 v113, v1
    v_cvt_pk_bf16_f32 v99, v126, v127
    v_exp_f32 v114, v2
    v_exp_f32 v115, v3
    v_cvt_pk_bf16_f32 v92, v112, v113
    v_exp_f32 v116, v4
    v_exp_f32 v117, v5
    v_mfma_f32_32x32x16_bf16 v[48:63], v[88:91], v[96:99], v[48:63]
    ds_read_b128 v[84:87], v103 offset:7168
    ds_read_b128 v[88:91], v103 offset:7680
    ds_read_b128 v[68:71], v100 offset:0
    v_cvt_pk_bf16_f32 v93, v114, v115
    v_exp_f32 v118, v6
    v_exp_f32 v119, v7
    v_cvt_pk_bf16_f32 v94, v116, v117
    v_exp_f32 v120, v8
    v_exp_f32 v121, v9
    v_cvt_pk_bf16_f32 v95, v118, v119
    v_exp_f32 v122, v10
    v_exp_f32 v123, v11
    v_mfma_f32_32x32x16_bf16 v[48:63], v[76:79], v[92:95], v[48:63]
    v_cvt_pk_bf16_f32 v96, v120, v121
    v_exp_f32 v124, v12
    v_exp_f32 v125, v13
    v_cvt_pk_bf16_f32 v97, v122, v123
    v_exp_f32 v126, v14
    v_exp_f32 v127, v15
    v_cvt_pk_bf16_f32 v98, v124, v125
    s_waitcnt lgkmcnt(0)
    v_mfma_f32_32x32x16_bf16 v[0:15], v[68:71], v[64:67], v[32:47]
    v_exp_f32 v112, v16
    v_exp_f32 v113, v17
    v_cvt_pk_bf16_f32 v99, v126, v127
    v_exp_f32 v114, v18
    v_exp_f32 v115, v19
    v_cvt_pk_bf16_f32 v92, v112, v113
    v_exp_f32 v116, v20
    v_exp_f32 v117, v21
    v_mfma_f32_32x32x16_bf16 v[48:63], v[80:83], v[96:99], v[48:63]
    v_mov_b32 v102, v104
    ds_read_b128 v[76:79], v102 offset:1024
    ds_read_b128 v[80:83], v102 offset:1536
    ds_read_b128 v[72:75], v100 offset:2048
    v_cvt_pk_bf16_f32 v93, v114, v115
    v_exp_f32 v118, v22
    v_exp_f32 v119, v23
    v_cvt_pk_bf16_f32 v94, v116, v117
    v_exp_f32 v120, v24
    v_exp_f32 v121, v25
    v_cvt_pk_bf16_f32 v95, v118, v119
    v_exp_f32 v122, v26
    v_exp_f32 v123, v27
    v_mfma_f32_32x32x16_bf16 v[48:63], v[84:87], v[92:95], v[48:63]
    v_cvt_pk_bf16_f32 v96, v120, v121
    v_exp_f32 v124, v28
    v_exp_f32 v125, v29
    v_cvt_pk_bf16_f32 v97, v122, v123
    v_exp_f32 v126, v30
    v_exp_f32 v127, v31
    v_cvt_pk_bf16_f32 v98, v124, v125
    s_barrier
    s_waitcnt lgkmcnt(0)
    v_mfma_f32_32x32x16_bf16 v[16:31], v[72:75], v[64:67], v[32:47]
    v_exp_f32 v112, v0
    v_exp_f32 v113, v1
    v_cvt_pk_bf16_f32 v99, v126, v127
    v_exp_f32 v114, v2
    v_exp_f32 v115, v3
    v_cvt_pk_bf16_f32 v92, v112, v113
    v_exp_f32 v116, v4
    v_exp_f32 v117, v5
    v_mfma_f32_32x32x16_bf16 v[48:63], v[88:91], v[96:99], v[48:63]
    ds_read_b128 v[84:87], v102 offset:3072
    ds_read_b128 v[88:91], v102 offset:3584
    ds_read_b128 v[68:71], v100 offset:4096
    v_cvt_pk_bf16_f32 v93, v114, v115
    v_exp_f32 v118, v6
    v_exp_f32 v119, v7
    v_cvt_pk_bf16_f32 v94, v116, v117
    v_exp_f32 v120, v8
    v_exp_f32 v121, v9
    v_cvt_pk_bf16_f32 v95, v118, v119
    v_exp_f32 v122, v10
    v_exp_f32 v123, v11
    v_mfma_f32_32x32x16_bf16 v[48:63], v[76:79], v[92:95], v[48:63]
    v_cvt_pk_bf16_f32 v96, v120, v121
    v_exp_f32 v124, v12
    v_exp_f32 v125, v13
    v_cvt_pk_bf16_f32 v97, v122, v123
    v_exp_f32 v126, v14
    v_exp_f32 v127, v15
    v_cvt_pk_bf16_f32 v98, v124, v125
    s_waitcnt lgkmcnt(0)
    v_mfma_f32_32x32x16_bf16 v[0:15], v[68:71], v[64:67], v[32:47]
    v_exp_f32 v112, v16
    v_exp_f32 v113, v17
    v_cvt_pk_bf16_f32 v99, v126, v127
    v_exp_f32 v114, v18
    v_exp_f32 v115, v19
    v_cvt_pk_bf16_f32 v92, v112, v113
    v_exp_f32 v116, v20
    v_exp_f32 v117, v21
    v_mfma_f32_32x32x16_bf16 v[48:63], v[80:83], v[96:99], v[48:63]
    ds_read_b128 v[76:79], v102 offset:5120
    ds_read_b128 v[80:83], v102 offset:5632
    ds_read_b128 v[72:75], v100 offset:6144
    v_cvt_pk_bf16_f32 v93, v114, v115
    v_exp_f32 v118, v22
    v_exp_f32 v119, v23
    v_cvt_pk_bf16_f32 v94, v116, v117
    v_exp_f32 v120, v24
    v_exp_f32 v121, v25
    v_cvt_pk_bf16_f32 v95, v118, v119
    v_exp_f32 v122, v26
    v_exp_f32 v123, v27
    v_mfma_f32_32x32x16_bf16 v[48:63], v[84:87], v[92:95], v[48:63]
    v_cvt_pk_bf16_f32 v96, v120, v121
    v_exp_f32 v124, v28
    v_exp_f32 v125, v29
    v_cvt_pk_bf16_f32 v97, v122, v123
    v_exp_f32 v126, v30
    v_exp_f32 v127, v31
    v_cvt_pk_bf16_f32 v98, v124, v125
    s_waitcnt lgkmcnt(0)
    v_mfma_f32_32x32x16_bf16 v[16:31], v[72:75], v[64:67], v[32:47]
    v_exp_f32 v112, v0
    v_exp_f32 v113, v1
    v_cvt_pk_bf16_f32 v99, v126, v127
    v_exp_f32 v114, v2
    v_exp_f32 v115, v3
    v_cvt_pk_bf16_f32 v92, v112, v113
    v_exp_f32 v116, v4
    v_exp_f32 v117, v5
    v_mfma_f32_32x32x16_bf16 v[48:63], v[88:91], v[96:99], v[48:63]
    ds_read_b128 v[84:87], v102 offset:7168
    ds_read_b128 v[88:91], v102 offset:7680
    ds_read_b128 v[68:71], v100 offset:16384
    v_cvt_pk_bf16_f32 v93, v114, v115
    v_exp_f32 v118, v6
    v_exp_f32 v119, v7
    v_cvt_pk_bf16_f32 v94, v116, v117
    v_exp_f32 v120, v8
    v_exp_f32 v121, v9
    v_cvt_pk_bf16_f32 v95, v118, v119
    v_exp_f32 v122, v10
    v_exp_f32 v123, v11
    v_mfma_f32_32x32x16_bf16 v[48:63], v[76:79], v[92:95], v[48:63]
    v_cvt_pk_bf16_f32 v96, v120, v121
    v_exp_f32 v124, v12
    v_exp_f32 v125, v13
    v_cvt_pk_bf16_f32 v97, v122, v123
    v_exp_f32 v126, v14
    v_exp_f32 v127, v15
    v_cvt_pk_bf16_f32 v98, v124, v125
    s_waitcnt lgkmcnt(0)
    v_mfma_f32_32x32x16_bf16 v[0:15], v[68:71], v[64:67], v[32:47]
    v_exp_f32 v112, v16
    v_exp_f32 v113, v17
    v_cvt_pk_bf16_f32 v99, v126, v127
    v_exp_f32 v114, v18
    v_exp_f32 v115, v19
    v_cvt_pk_bf16_f32 v92, v112, v113
    v_exp_f32 v116, v20
    v_exp_f32 v117, v21
    v_mfma_f32_32x32x16_bf16 v[48:63], v[80:83], v[96:99], v[48:63]
    v_add_u32 v103, v102, v105
    ds_read_b128 v[76:79], v103 offset:1024
    ds_read_b128 v[80:83], v103 offset:1536
    ds_read_b128 v[72:75], v100 offset:18432
    v_cvt_pk_bf16_f32 v93, v114, v115
    v_exp_f32 v118, v22
    v_exp_f32 v119, v23
    v_cvt_pk_bf16_f32 v94, v116, v117
    v_exp_f32 v120, v24
    v_exp_f32 v121, v25
    v_cvt_pk_bf16_f32 v95, v118, v119
    v_exp_f32 v122, v26
    v_exp_f32 v123, v27
    v_mfma_f32_32x32x16_bf16 v[48:63], v[84:87], v[92:95], v[48:63]
    v_cvt_pk_bf16_f32 v96, v120, v121
    v_exp_f32 v124, v28
    v_exp_f32 v125, v29
    v_cvt_pk_bf16_f32 v97, v122, v123
    v_exp_f32 v126, v30
    v_exp_f32 v127, v31
    v_cvt_pk_bf16_f32 v98, v124, v125
    s_waitcnt lgkmcnt(0)
    v_mfma_f32_32x32x16_bf16 v[16:31], v[72:75], v[64:67], v[32:47]
    v_exp_f32 v112, v0
    v_exp_f32 v113, v1
    v_cvt_pk_bf16_f32 v99, v126, v127
    v_exp_f32 v114, v2
    v_exp_f32 v115, v3
    v_cvt_pk_bf16_f32 v92, v112, v113
    v_exp_f32 v116, v4
    v_exp_f32 v117, v5
    v_mfma_f32_32x32x16_bf16 v[48:63], v[88:91], v[96:99], v[48:63]
    ds_read_b128 v[84:87], v103 offset:3072
    ds_read_b128 v[88:91], v103 offset:3584
    ds_read_b128 v[68:71], v100 offset:20480
    v_cvt_pk_bf16_f32 v93, v114, v115
    v_exp_f32 v118, v6
    v_exp_f32 v119, v7
    v_cvt_pk_bf16_f32 v94, v116, v117
    v_exp_f32 v120, v8
    v_exp_f32 v121, v9
    v_cvt_pk_bf16_f32 v95, v118, v119
    v_exp_f32 v122, v10
    v_exp_f32 v123, v11
    v_mfma_f32_32x32x16_bf16 v[48:63], v[76:79], v[92:95], v[48:63]
    v_cvt_pk_bf16_f32 v96, v120, v121
    v_exp_f32 v124, v12
    v_exp_f32 v125, v13
    v_cvt_pk_bf16_f32 v97, v122, v123
    v_exp_f32 v126, v14
    v_exp_f32 v127, v15
    v_cvt_pk_bf16_f32 v98, v124, v125
    s_waitcnt lgkmcnt(0)
    v_mfma_f32_32x32x16_bf16 v[0:15], v[68:71], v[64:67], v[32:47]
    v_exp_f32 v112, v16
    v_exp_f32 v113, v17
    v_cvt_pk_bf16_f32 v99, v126, v127
    v_exp_f32 v114, v18
    v_exp_f32 v115, v19
    v_cvt_pk_bf16_f32 v92, v112, v113
    v_exp_f32 v116, v20
    v_exp_f32 v117, v21
    v_mfma_f32_32x32x16_bf16 v[48:63], v[80:83], v[96:99], v[48:63]
    ds_read_b128 v[76:79], v103 offset:5120
    ds_read_b128 v[80:83], v103 offset:5632
    ds_read_b128 v[72:75], v100 offset:22528
    v_cvt_pk_bf16_f32 v93, v114, v115
    v_exp_f32 v118, v22
    v_exp_f32 v119, v23
    v_cvt_pk_bf16_f32 v94, v116, v117
    v_exp_f32 v120, v24
    v_exp_f32 v121, v25
    v_cvt_pk_bf16_f32 v95, v118, v119
    v_exp_f32 v122, v26
    v_exp_f32 v123, v27
    v_mfma_f32_32x32x16_bf16 v[48:63], v[84:87], v[92:95], v[48:63]
    v_cvt_pk_bf16_f32 v96, v120, v121
    v_exp_f32 v124, v28
    v_exp_f32 v125, v29
    v_cvt_pk_bf16_f32 v97, v122, v123
    v_exp_f32 v126, v30
    v_exp_f32 v127, v31
    v_cvt_pk_bf16_f32 v98, v124, v125
    s_waitcnt lgkmcnt(0)
    v_mfma_f32_32x32x16_bf16 v[16:31], v[72:75], v[64:67], v[32:47]
    v_exp_f32 v112, v0
    v_exp_f32 v113, v1
    v_cvt_pk_bf16_f32 v99, v126, v127
    v_exp_f32 v114, v2
    v_exp_f32 v115, v3
    v_cvt_pk_bf16_f32 v92, v112, v113
    v_exp_f32 v116, v4
    v_exp_f32 v117, v5
    v_mfma_f32_32x32x16_bf16 v[48:63], v[88:91], v[96:99], v[48:63]
    ds_read_b128 v[84:87], v103 offset:7168
    ds_read_b128 v[88:91], v103 offset:7680
    ds_read_b128 v[68:71], v100 offset:32768
    v_cvt_pk_bf16_f32 v93, v114, v115
    v_exp_f32 v118, v6
    v_exp_f32 v119, v7
    v_cvt_pk_bf16_f32 v94, v116, v117
    v_exp_f32 v120, v8
    v_exp_f32 v121, v9
    v_cvt_pk_bf16_f32 v95, v118, v119
    v_exp_f32 v122, v10
    v_exp_f32 v123, v11
    v_mfma_f32_32x32x16_bf16 v[48:63], v[76:79], v[92:95], v[48:63]
    v_cvt_pk_bf16_f32 v96, v120, v121
    v_exp_f32 v124, v12
    v_exp_f32 v125, v13
    v_cvt_pk_bf16_f32 v97, v122, v123
    v_exp_f32 v126, v14
    v_exp_f32 v127, v15
    v_cvt_pk_bf16_f32 v98, v124, v125
    s_waitcnt lgkmcnt(0)
    v_mfma_f32_32x32x16_bf16 v[0:15], v[68:71], v[64:67], v[32:47]
    v_exp_f32 v112, v16
    v_exp_f32 v113, v17
    v_cvt_pk_bf16_f32 v99, v126, v127
    v_exp_f32 v114, v18
    v_exp_f32 v115, v19
    v_cvt_pk_bf16_f32 v92, v112, v113
    v_exp_f32 v116, v20
    v_exp_f32 v117, v21
    v_mfma_f32_32x32x16_bf16 v[48:63], v[80:83], v[96:99], v[48:63]
    v_add_u32 v102, v103, v105
    ds_read_b128 v[76:79], v102 offset:1024
    ds_read_b128 v[80:83], v102 offset:1536
    ds_read_b128 v[72:75], v100 offset:34816
    v_cvt_pk_bf16_f32 v93, v114, v115
    v_exp_f32 v118, v22
    v_exp_f32 v119, v23
    v_cvt_pk_bf16_f32 v94, v116, v117
    v_exp_f32 v120, v24
    v_exp_f32 v121, v25
    v_cvt_pk_bf16_f32 v95, v118, v119
    v_exp_f32 v122, v26
    v_exp_f32 v123, v27
    v_mfma_f32_32x32x16_bf16 v[48:63], v[84:87], v[92:95], v[48:63]
    v_cvt_pk_bf16_f32 v96, v120, v121
    v_exp_f32 v124, v28
    v_exp_f32 v125, v29
    v_cvt_pk_bf16_f32 v97, v122, v123
    v_exp_f32 v126, v30
    v_exp_f32 v127, v31
    v_cvt_pk_bf16_f32 v98, v124, v125
    s_barrier
    s_waitcnt lgkmcnt(0)
    v_mfma_f32_32x32x16_bf16 v[16:31], v[72:75], v[64:67], v[32:47]
    v_exp_f32 v112, v0
    v_exp_f32 v113, v1
    v_cvt_pk_bf16_f32 v99, v126, v127
    v_exp_f32 v114, v2
    v_exp_f32 v115, v3
    v_cvt_pk_bf16_f32 v92, v112, v113
    v_exp_f32 v116, v4
    v_exp_f32 v117, v5
    v_mfma_f32_32x32x16_bf16 v[48:63], v[88:91], v[96:99], v[48:63]
    ds_read_b128 v[84:87], v102 offset:3072
    ds_read_b128 v[88:91], v102 offset:3584
    ds_read_b128 v[68:71], v100 offset:36864
    v_cvt_pk_bf16_f32 v93, v114, v115
    v_exp_f32 v118, v6
    v_exp_f32 v119, v7
    v_cvt_pk_bf16_f32 v94, v116, v117
    v_exp_f32 v120, v8
    v_exp_f32 v121, v9
    v_cvt_pk_bf16_f32 v95, v118, v119
    v_exp_f32 v122, v10
    v_exp_f32 v123, v11
    v_mfma_f32_32x32x16_bf16 v[48:63], v[76:79], v[92:95], v[48:63]
    v_cvt_pk_bf16_f32 v96, v120, v121
    v_exp_f32 v124, v12
    v_exp_f32 v125, v13
    v_cvt_pk_bf16_f32 v97, v122, v123
    v_exp_f32 v126, v14
    v_exp_f32 v127, v15
    v_cvt_pk_bf16_f32 v98, v124, v125
    s_waitcnt lgkmcnt(0)
    v_mfma_f32_32x32x16_bf16 v[0:15], v[68:71], v[64:67], v[32:47]
    v_exp_f32 v112, v16
    v_exp_f32 v113, v17
    v_cvt_pk_bf16_f32 v99, v126, v127
    v_exp_f32 v114, v18
    v_exp_f32 v115, v19
    v_cvt_pk_bf16_f32 v92, v112, v113
    v_exp_f32 v116, v20
    v_exp_f32 v117, v21
    v_mfma_f32_32x32x16_bf16 v[48:63], v[80:83], v[96:99], v[48:63]
    ds_read_b128 v[76:79], v102 offset:5120
    ds_read_b128 v[80:83], v102 offset:5632
    ds_read_b128 v[72:75], v100 offset:38912
    v_cvt_pk_bf16_f32 v93, v114, v115
    v_exp_f32 v118, v22
    v_exp_f32 v119, v23
    v_cvt_pk_bf16_f32 v94, v116, v117
    v_exp_f32 v120, v24
    v_exp_f32 v121, v25
    v_cvt_pk_bf16_f32 v95, v118, v119
    v_exp_f32 v122, v26
    v_exp_f32 v123, v27
    v_mfma_f32_32x32x16_bf16 v[48:63], v[84:87], v[92:95], v[48:63]
    v_cvt_pk_bf16_f32 v96, v120, v121
    v_exp_f32 v124, v28
    v_exp_f32 v125, v29
    v_cvt_pk_bf16_f32 v97, v122, v123
    v_exp_f32 v126, v30
    v_exp_f32 v127, v31
    v_cvt_pk_bf16_f32 v98, v124, v125
    s_waitcnt lgkmcnt(0)
    v_mfma_f32_32x32x16_bf16 v[16:31], v[72:75], v[64:67], v[32:47]
    v_exp_f32 v112, v0
    v_exp_f32 v113, v1
    v_cvt_pk_bf16_f32 v99, v126, v127
    v_exp_f32 v114, v2
    v_exp_f32 v115, v3
    v_cvt_pk_bf16_f32 v92, v112, v113
    v_exp_f32 v116, v4
    v_exp_f32 v117, v5
    v_mfma_f32_32x32x16_bf16 v[48:63], v[88:91], v[96:99], v[48:63]
    ds_read_b128 v[84:87], v102 offset:7168
    ds_read_b128 v[88:91], v102 offset:7680
    ds_read_b128 v[68:71], v100 offset:49152
    v_cvt_pk_bf16_f32 v93, v114, v115
    v_exp_f32 v118, v6
    v_exp_f32 v119, v7
    v_cvt_pk_bf16_f32 v94, v116, v117
    v_exp_f32 v120, v8
    v_exp_f32 v121, v9
    v_cvt_pk_bf16_f32 v95, v118, v119
    v_exp_f32 v122, v10
    v_exp_f32 v123, v11
    v_mfma_f32_32x32x16_bf16 v[48:63], v[76:79], v[92:95], v[48:63]
    v_cvt_pk_bf16_f32 v96, v120, v121
    v_exp_f32 v124, v12
    v_exp_f32 v125, v13
    v_cvt_pk_bf16_f32 v97, v122, v123
    v_exp_f32 v126, v14
    v_exp_f32 v127, v15
    v_cvt_pk_bf16_f32 v98, v124, v125
    s_waitcnt lgkmcnt(0)
    v_mfma_f32_32x32x16_bf16 v[0:15], v[68:71], v[64:67], v[32:47]
    v_exp_f32 v112, v16
    v_exp_f32 v113, v17
    v_cvt_pk_bf16_f32 v99, v126, v127
    v_exp_f32 v114, v18
    v_exp_f32 v115, v19
    v_cvt_pk_bf16_f32 v92, v112, v113
    v_exp_f32 v116, v20
    v_exp_f32 v117, v21
    v_mfma_f32_32x32x16_bf16 v[48:63], v[80:83], v[96:99], v[48:63]
    v_add_u32 v103, v102, v105
    ds_read_b128 v[76:79], v103 offset:1024
    ds_read_b128 v[80:83], v103 offset:1536
    ds_read_b128 v[72:75], v100 offset:51200
    v_cvt_pk_bf16_f32 v93, v114, v115
    v_exp_f32 v118, v22
    v_exp_f32 v119, v23
    v_cvt_pk_bf16_f32 v94, v116, v117
    v_exp_f32 v120, v24
    v_exp_f32 v121, v25
    v_cvt_pk_bf16_f32 v95, v118, v119
    v_exp_f32 v122, v26
    v_exp_f32 v123, v27
    v_mfma_f32_32x32x16_bf16 v[48:63], v[84:87], v[92:95], v[48:63]
    v_cvt_pk_bf16_f32 v96, v120, v121
    v_exp_f32 v124, v28
    v_exp_f32 v125, v29
    v_cvt_pk_bf16_f32 v97, v122, v123
    v_exp_f32 v126, v30
    v_exp_f32 v127, v31
    v_cvt_pk_bf16_f32 v98, v124, v125
    s_waitcnt lgkmcnt(0)
    v_mfma_f32_32x32x16_bf16 v[16:31], v[72:75], v[64:67], v[32:47]
    v_exp_f32 v112, v0
    v_exp_f32 v113, v1
    v_cvt_pk_bf16_f32 v99, v126, v127
    v_exp_f32 v114, v2
    v_exp_f32 v115, v3
    v_cvt_pk_bf16_f32 v92, v112, v113
    v_exp_f32 v116, v4
    v_exp_f32 v117, v5
    v_mfma_f32_32x32x16_bf16 v[48:63], v[88:91], v[96:99], v[48:63]
    ds_read_b128 v[84:87], v103 offset:3072
    ds_read_b128 v[88:91], v103 offset:3584
    ds_read_b128 v[68:71], v100 offset:53248
    v_cvt_pk_bf16_f32 v93, v114, v115
    v_exp_f32 v118, v6
    v_exp_f32 v119, v7
    v_cvt_pk_bf16_f32 v94, v116, v117
    v_exp_f32 v120, v8
    v_exp_f32 v121, v9
    v_cvt_pk_bf16_f32 v95, v118, v119
    v_exp_f32 v122, v10
    v_exp_f32 v123, v11
    v_mfma_f32_32x32x16_bf16 v[48:63], v[76:79], v[92:95], v[48:63]
    v_cvt_pk_bf16_f32 v96, v120, v121
    v_exp_f32 v124, v12
    v_exp_f32 v125, v13
    v_cvt_pk_bf16_f32 v97, v122, v123
    v_exp_f32 v126, v14
    v_exp_f32 v127, v15
    v_cvt_pk_bf16_f32 v98, v124, v125
    s_waitcnt lgkmcnt(0)
    v_mfma_f32_32x32x16_bf16 v[0:15], v[68:71], v[64:67], v[32:47]
    v_exp_f32 v112, v16
    v_exp_f32 v113, v17
    v_cvt_pk_bf16_f32 v99, v126, v127
    v_exp_f32 v114, v18
    v_exp_f32 v115, v19
    v_cvt_pk_bf16_f32 v92, v112, v113
    v_exp_f32 v116, v20
    v_exp_f32 v117, v21
    v_mfma_f32_32x32x16_bf16 v[48:63], v[80:83], v[96:99], v[48:63]
    ds_read_b128 v[76:79], v103 offset:5120
    ds_read_b128 v[80:83], v103 offset:5632
    ds_read_b128 v[72:75], v100 offset:55296
    v_cvt_pk_bf16_f32 v93, v114, v115
    v_exp_f32 v118, v22
    v_exp_f32 v119, v23
    v_cvt_pk_bf16_f32 v94, v116, v117
    v_exp_f32 v120, v24
    v_exp_f32 v121, v25
    v_cvt_pk_bf16_f32 v95, v118, v119
    v_exp_f32 v122, v26
    v_exp_f32 v123, v27
    v_mfma_f32_32x32x16_bf16 v[48:63], v[84:87], v[92:95], v[48:63]
    v_cvt_pk_bf16_f32 v96, v120, v121
    v_exp_f32 v124, v28
    v_exp_f32 v125, v29
    v_cvt_pk_bf16_f32 v97, v122, v123
    v_exp_f32 v126, v30
    v_exp_f32 v127, v31
    v_cvt_pk_bf16_f32 v98, v124, v125
    s_waitcnt lgkmcnt(0)
    v_mfma_f32_32x32x16_bf16 v[16:31], v[72:75], v[64:67], v[32:47]
    v_exp_f32 v112, v0
    v_exp_f32 v113, v1
    v_cvt_pk_bf16_f32 v99, v126, v127
    v_exp_f32 v114, v2
    v_exp_f32 v115, v3
    v_cvt_pk_bf16_f32 v92, v112, v113
    v_exp_f32 v116, v4
    v_exp_f32 v117, v5
    v_mfma_f32_32x32x16_bf16 v[48:63], v[88:91], v[96:99], v[48:63]
    ds_read_b128 v[84:87], v103 offset:7168
    ds_read_b128 v[88:91], v103 offset:7680
    ds_read_b128 v[68:71], v101 offset:0
    v_cvt_pk_bf16_f32 v93, v114, v115
    v_exp_f32 v118, v6
    v_exp_f32 v119, v7
    v_cvt_pk_bf16_f32 v94, v116, v117
    v_exp_f32 v120, v8
    v_exp_f32 v121, v9
    v_cvt_pk_bf16_f32 v95, v118, v119
    v_exp_f32 v122, v10
    v_exp_f32 v123, v11
    v_mfma_f32_32x32x16_bf16 v[48:63], v[76:79], v[92:95], v[48:63]
    v_cvt_pk_bf16_f32 v96, v120, v121
    v_exp_f32 v124, v12
    v_exp_f32 v125, v13
    v_cvt_pk_bf16_f32 v97, v122, v123
    v_exp_f32 v126, v14
    v_exp_f32 v127, v15
    v_cvt_pk_bf16_f32 v98, v124, v125
    s_waitcnt lgkmcnt(0)
    v_mfma_f32_32x32x16_bf16 v[0:15], v[68:71], v[64:67], v[32:47]
    v_exp_f32 v112, v16
    v_exp_f32 v113, v17
    v_cvt_pk_bf16_f32 v99, v126, v127
    v_exp_f32 v114, v18
    v_exp_f32 v115, v19
    v_cvt_pk_bf16_f32 v92, v112, v113
    v_exp_f32 v116, v20
    v_exp_f32 v117, v21
    v_mfma_f32_32x32x16_bf16 v[48:63], v[80:83], v[96:99], v[48:63]
    v_add_u32 v102, v103, v105
    ds_read_b128 v[76:79], v102 offset:1024
    ds_read_b128 v[80:83], v102 offset:1536
    ds_read_b128 v[72:75], v101 offset:2048
    v_cvt_pk_bf16_f32 v93, v114, v115
    v_exp_f32 v118, v22
    v_exp_f32 v119, v23
    v_cvt_pk_bf16_f32 v94, v116, v117
    v_exp_f32 v120, v24
    v_exp_f32 v121, v25
    v_cvt_pk_bf16_f32 v95, v118, v119
    v_exp_f32 v122, v26
    v_exp_f32 v123, v27
    v_mfma_f32_32x32x16_bf16 v[48:63], v[84:87], v[92:95], v[48:63]
    v_cvt_pk_bf16_f32 v96, v120, v121
    v_exp_f32 v124, v28
    v_exp_f32 v125, v29
    v_cvt_pk_bf16_f32 v97, v122, v123
    v_exp_f32 v126, v30
    v_exp_f32 v127, v31
    v_cvt_pk_bf16_f32 v98, v124, v125
    s_barrier
    s_waitcnt lgkmcnt(0)
    v_mfma_f32_32x32x16_bf16 v[16:31], v[72:75], v[64:67], v[32:47]
    v_exp_f32 v112, v0
    v_exp_f32 v113, v1
    v_cvt_pk_bf16_f32 v99, v126, v127
    v_exp_f32 v114, v2
    v_exp_f32 v115, v3
    v_cvt_pk_bf16_f32 v92, v112, v113
    v_exp_f32 v116, v4
    v_exp_f32 v117, v5
    v_mfma_f32_32x32x16_bf16 v[48:63], v[88:91], v[96:99], v[48:63]
    ds_read_b128 v[84:87], v102 offset:3072
    ds_read_b128 v[88:91], v102 offset:3584
    ds_read_b128 v[68:71], v101 offset:4096
    v_cvt_pk_bf16_f32 v93, v114, v115
    v_exp_f32 v118, v6
    v_exp_f32 v119, v7
    v_cvt_pk_bf16_f32 v94, v116, v117
    v_exp_f32 v120, v8
    v_exp_f32 v121, v9
    v_cvt_pk_bf16_f32 v95, v118, v119
    v_exp_f32 v122, v10
    v_exp_f32 v123, v11
    v_mfma_f32_32x32x16_bf16 v[48:63], v[76:79], v[92:95], v[48:63]
    v_cvt_pk_bf16_f32 v96, v120, v121
    v_exp_f32 v124, v12
    v_exp_f32 v125, v13
    v_cvt_pk_bf16_f32 v97, v122, v123
    v_exp_f32 v126, v14
    v_exp_f32 v127, v15
    v_cvt_pk_bf16_f32 v98, v124, v125
    s_waitcnt lgkmcnt(0)
    v_mfma_f32_32x32x16_bf16 v[0:15], v[68:71], v[64:67], v[32:47]
    v_exp_f32 v112, v16
    v_exp_f32 v113, v17
    v_cvt_pk_bf16_f32 v99, v126, v127
    v_exp_f32 v114, v18
    v_exp_f32 v115, v19
    v_cvt_pk_bf16_f32 v92, v112, v113
    v_exp_f32 v116, v20
    v_exp_f32 v117, v21
    v_mfma_f32_32x32x16_bf16 v[48:63], v[80:83], v[96:99], v[48:63]
    ds_read_b128 v[76:79], v102 offset:5120
    ds_read_b128 v[80:83], v102 offset:5632
    ds_read_b128 v[72:75], v101 offset:6144
    v_cvt_pk_bf16_f32 v93, v114, v115
    v_exp_f32 v118, v22
    v_exp_f32 v119, v23
    v_cvt_pk_bf16_f32 v94, v116, v117
    v_exp_f32 v120, v24
    v_exp_f32 v121, v25
    v_cvt_pk_bf16_f32 v95, v118, v119
    v_exp_f32 v122, v26
    v_exp_f32 v123, v27
    v_mfma_f32_32x32x16_bf16 v[48:63], v[84:87], v[92:95], v[48:63]
    v_cvt_pk_bf16_f32 v96, v120, v121
    v_exp_f32 v124, v28
    v_exp_f32 v125, v29
    v_cvt_pk_bf16_f32 v97, v122, v123
    v_exp_f32 v126, v30
    v_exp_f32 v127, v31
    v_cvt_pk_bf16_f32 v98, v124, v125
    s_waitcnt lgkmcnt(0)
    v_mfma_f32_32x32x16_bf16 v[16:31], v[72:75], v[64:67], v[32:47]
    v_exp_f32 v112, v0
    v_exp_f32 v113, v1
    v_cvt_pk_bf16_f32 v99, v126, v127
    v_exp_f32 v114, v2
    v_exp_f32 v115, v3
    v_cvt_pk_bf16_f32 v92, v112, v113
    v_exp_f32 v116, v4
    v_exp_f32 v117, v5
    v_mfma_f32_32x32x16_bf16 v[48:63], v[88:91], v[96:99], v[48:63]
    ds_read_b128 v[84:87], v102 offset:7168
    ds_read_b128 v[88:91], v102 offset:7680
    ds_read_b128 v[68:71], v101 offset:16384
    v_cvt_pk_bf16_f32 v93, v114, v115
    v_exp_f32 v118, v6
    v_exp_f32 v119, v7
    v_cvt_pk_bf16_f32 v94, v116, v117
    v_exp_f32 v120, v8
    v_exp_f32 v121, v9
    v_cvt_pk_bf16_f32 v95, v118, v119
    v_exp_f32 v122, v10
    v_exp_f32 v123, v11
    v_mfma_f32_32x32x16_bf16 v[48:63], v[76:79], v[92:95], v[48:63]
    v_cvt_pk_bf16_f32 v96, v120, v121
    v_exp_f32 v124, v12
    v_exp_f32 v125, v13
    v_cvt_pk_bf16_f32 v97, v122, v123
    v_exp_f32 v126, v14
    v_exp_f32 v127, v15
    v_cvt_pk_bf16_f32 v98, v124, v125
    s_waitcnt lgkmcnt(0)
    v_mfma_f32_32x32x16_bf16 v[0:15], v[68:71], v[64:67], v[32:47]
    v_exp_f32 v112, v16
    v_exp_f32 v113, v17
    v_cvt_pk_bf16_f32 v99, v126, v127
    v_exp_f32 v114, v18
    v_exp_f32 v115, v19
    v_cvt_pk_bf16_f32 v92, v112, v113
    v_exp_f32 v116, v20
    v_exp_f32 v117, v21
    v_mfma_f32_32x32x16_bf16 v[48:63], v[80:83], v[96:99], v[48:63]
    v_add_u32 v103, v102, v105
    ds_read_b128 v[76:79], v103 offset:1024
    ds_read_b128 v[80:83], v103 offset:1536
    ds_read_b128 v[72:75], v101 offset:18432
    v_cvt_pk_bf16_f32 v93, v114, v115
    v_exp_f32 v118, v22
    v_exp_f32 v119, v23
    v_cvt_pk_bf16_f32 v94, v116, v117
    v_exp_f32 v120, v24
    v_exp_f32 v121, v25
    v_cvt_pk_bf16_f32 v95, v118, v119
    v_exp_f32 v122, v26
    v_exp_f32 v123, v27
    v_mfma_f32_32x32x16_bf16 v[48:63], v[84:87], v[92:95], v[48:63]
    v_cvt_pk_bf16_f32 v96, v120, v121
    v_exp_f32 v124, v28
    v_exp_f32 v125, v29
    v_cvt_pk_bf16_f32 v97, v122, v123
    v_exp_f32 v126, v30
    v_exp_f32 v127, v31
    v_cvt_pk_bf16_f32 v98, v124, v125
    s_waitcnt lgkmcnt(0)
    v_mfma_f32_32x32x16_bf16 v[16:31], v[72:75], v[64:67], v[32:47]
    v_exp_f32 v112, v0
    v_exp_f32 v113, v1
    v_cvt_pk_bf16_f32 v99, v126, v127
    v_exp_f32 v114, v2
    v_exp_f32 v115, v3
    v_cvt_pk_bf16_f32 v92, v112, v113
    v_exp_f32 v116, v4
    v_exp_f32 v117, v5
    v_mfma_f32_32x32x16_bf16 v[48:63], v[88:91], v[96:99], v[48:63]
    ds_read_b128 v[84:87], v103 offset:3072
    ds_read_b128 v[88:91], v103 offset:3584
    ds_read_b128 v[68:71], v101 offset:20480
    v_cvt_pk_bf16_f32 v93, v114, v115
    v_exp_f32 v118, v6
    v_exp_f32 v119, v7
    v_cvt_pk_bf16_f32 v94, v116, v117
    v_exp_f32 v120, v8
    v_exp_f32 v121, v9
    v_cvt_pk_bf16_f32 v95, v118, v119
    v_exp_f32 v122, v10
    v_exp_f32 v123, v11
    v_mfma_f32_32x32x16_bf16 v[48:63], v[76:79], v[92:95], v[48:63]
    v_cvt_pk_bf16_f32 v96, v120, v121
    v_exp_f32 v124, v12
    v_exp_f32 v125, v13
    v_cvt_pk_bf16_f32 v97, v122, v123
    v_exp_f32 v126, v14
    v_exp_f32 v127, v15
    v_cvt_pk_bf16_f32 v98, v124, v125
    s_waitcnt lgkmcnt(0)
    v_mfma_f32_32x32x16_bf16 v[0:15], v[68:71], v[64:67], v[32:47]
    v_exp_f32 v112, v16
    v_exp_f32 v113, v17
    v_cvt_pk_bf16_f32 v99, v126, v127
    v_exp_f32 v114, v18
    v_exp_f32 v115, v19
    v_cvt_pk_bf16_f32 v92, v112, v113
    v_exp_f32 v116, v20
    v_exp_f32 v117, v21
    v_mfma_f32_32x32x16_bf16 v[48:63], v[80:83], v[96:99], v[48:63]
    ds_read_b128 v[76:79], v103 offset:5120
    ds_read_b128 v[80:83], v103 offset:5632
    ds_read_b128 v[72:75], v101 offset:22528
    v_cvt_pk_bf16_f32 v93, v114, v115
    v_exp_f32 v118, v22
    v_exp_f32 v119, v23
    v_cvt_pk_bf16_f32 v94, v116, v117
    v_exp_f32 v120, v24
    v_exp_f32 v121, v25
    v_cvt_pk_bf16_f32 v95, v118, v119
    v_exp_f32 v122, v26
    v_exp_f32 v123, v27
    v_mfma_f32_32x32x16_bf16 v[48:63], v[84:87], v[92:95], v[48:63]
    v_cvt_pk_bf16_f32 v96, v120, v121
    v_exp_f32 v124, v28
    v_exp_f32 v125, v29
    v_cvt_pk_bf16_f32 v97, v122, v123
    v_exp_f32 v126, v30
    v_exp_f32 v127, v31
    v_cvt_pk_bf16_f32 v98, v124, v125
    s_waitcnt lgkmcnt(0)
    v_mfma_f32_32x32x16_bf16 v[16:31], v[72:75], v[64:67], v[32:47]
    v_exp_f32 v112, v0
    v_exp_f32 v113, v1
    v_cvt_pk_bf16_f32 v99, v126, v127
    v_exp_f32 v114, v2
    v_exp_f32 v115, v3
    v_cvt_pk_bf16_f32 v92, v112, v113
    v_exp_f32 v116, v4
    v_exp_f32 v117, v5
    v_mfma_f32_32x32x16_bf16 v[48:63], v[88:91], v[96:99], v[48:63]
    ds_read_b128 v[84:87], v103 offset:7168
    ds_read_b128 v[88:91], v103 offset:7680
    ds_read_b128 v[68:71], v101 offset:32768
    v_cvt_pk_bf16_f32 v93, v114, v115
    v_exp_f32 v118, v6
    v_exp_f32 v119, v7
    v_cvt_pk_bf16_f32 v94, v116, v117
    v_exp_f32 v120, v8
    v_exp_f32 v121, v9
    v_cvt_pk_bf16_f32 v95, v118, v119
    v_exp_f32 v122, v10
    v_exp_f32 v123, v11
    v_mfma_f32_32x32x16_bf16 v[48:63], v[76:79], v[92:95], v[48:63]
    v_cvt_pk_bf16_f32 v96, v120, v121
    v_exp_f32 v124, v12
    v_exp_f32 v125, v13
    v_cvt_pk_bf16_f32 v97, v122, v123
    v_exp_f32 v126, v14
    v_exp_f32 v127, v15
    v_cvt_pk_bf16_f32 v98, v124, v125
    s_waitcnt lgkmcnt(0)
    v_mfma_f32_32x32x16_bf16 v[0:15], v[68:71], v[64:67], v[32:47]
    v_exp_f32 v112, v16
    v_exp_f32 v113, v17
    v_cvt_pk_bf16_f32 v99, v126, v127
    v_exp_f32 v114, v18
    v_exp_f32 v115, v19
    v_cvt_pk_bf16_f32 v92, v112, v113
    v_exp_f32 v116, v20
    v_exp_f32 v117, v21
    v_mfma_f32_32x32x16_bf16 v[48:63], v[80:83], v[96:99], v[48:63]
    v_add_u32 v102, v103, v105
    ds_read_b128 v[76:79], v102 offset:1024
    ds_read_b128 v[80:83], v102 offset:1536
    ds_read_b128 v[72:75], v101 offset:34816
    v_cvt_pk_bf16_f32 v93, v114, v115
    v_exp_f32 v118, v22
    v_exp_f32 v119, v23
    v_cvt_pk_bf16_f32 v94, v116, v117
    v_exp_f32 v120, v24
    v_exp_f32 v121, v25
    v_cvt_pk_bf16_f32 v95, v118, v119
    v_exp_f32 v122, v26
    v_exp_f32 v123, v27
    v_mfma_f32_32x32x16_bf16 v[48:63], v[84:87], v[92:95], v[48:63]
    v_cvt_pk_bf16_f32 v96, v120, v121
    v_exp_f32 v124, v28
    v_exp_f32 v125, v29
    v_cvt_pk_bf16_f32 v97, v122, v123
    v_exp_f32 v126, v30
    v_exp_f32 v127, v31
    v_cvt_pk_bf16_f32 v98, v124, v125
    s_barrier
    s_waitcnt lgkmcnt(0)
    v_mfma_f32_32x32x16_bf16 v[16:31], v[72:75], v[64:67], v[32:47]
    v_exp_f32 v112, v0
    v_exp_f32 v113, v1
    v_cvt_pk_bf16_f32 v99, v126, v127
    v_exp_f32 v114, v2
    v_exp_f32 v115, v3
    v_cvt_pk_bf16_f32 v92, v112, v113
    v_exp_f32 v116, v4
    v_exp_f32 v117, v5
    v_mfma_f32_32x32x16_bf16 v[48:63], v[88:91], v[96:99], v[48:63]
    ds_read_b128 v[84:87], v102 offset:3072
    ds_read_b128 v[88:91], v102 offset:3584
    ds_read_b128 v[68:71], v101 offset:36864
    v_cvt_pk_bf16_f32 v93, v114, v115
    v_exp_f32 v118, v6
    v_exp_f32 v119, v7
    v_cvt_pk_bf16_f32 v94, v116, v117
    v_exp_f32 v120, v8
    v_exp_f32 v121, v9
    v_cvt_pk_bf16_f32 v95, v118, v119
    v_exp_f32 v122, v10
    v_exp_f32 v123, v11
    v_mfma_f32_32x32x16_bf16 v[48:63], v[76:79], v[92:95], v[48:63]
    v_cvt_pk_bf16_f32 v96, v120, v121
    v_exp_f32 v124, v12
    v_exp_f32 v125, v13
    v_cvt_pk_bf16_f32 v97, v122, v123
    v_exp_f32 v126, v14
    v_exp_f32 v127, v15
    v_cvt_pk_bf16_f32 v98, v124, v125
    s_waitcnt lgkmcnt(0)
    v_mfma_f32_32x32x16_bf16 v[0:15], v[68:71], v[64:67], v[32:47]
    v_exp_f32 v112, v16
    v_exp_f32 v113, v17
    v_cvt_pk_bf16_f32 v99, v126, v127
    v_exp_f32 v114, v18
    v_exp_f32 v115, v19
    v_cvt_pk_bf16_f32 v92, v112, v113
    v_exp_f32 v116, v20
    v_exp_f32 v117, v21
    v_mfma_f32_32x32x16_bf16 v[48:63], v[80:83], v[96:99], v[48:63]
    ds_read_b128 v[76:79], v102 offset:5120
    ds_read_b128 v[80:83], v102 offset:5632
    ds_read_b128 v[72:75], v101 offset:38912
    v_cvt_pk_bf16_f32 v93, v114, v115
    v_exp_f32 v118, v22
    v_exp_f32 v119, v23
    v_cvt_pk_bf16_f32 v94, v116, v117
    v_exp_f32 v120, v24
    v_exp_f32 v121, v25
    v_cvt_pk_bf16_f32 v95, v118, v119
    v_exp_f32 v122, v26
    v_exp_f32 v123, v27
    v_mfma_f32_32x32x16_bf16 v[48:63], v[84:87], v[92:95], v[48:63]
    v_cvt_pk_bf16_f32 v96, v120, v121
    v_exp_f32 v124, v28
    v_exp_f32 v125, v29
    v_cvt_pk_bf16_f32 v97, v122, v123
    v_exp_f32 v126, v30
    v_exp_f32 v127, v31
    v_cvt_pk_bf16_f32 v98, v124, v125
    s_waitcnt lgkmcnt(0)
    v_mfma_f32_32x32x16_bf16 v[16:31], v[72:75], v[64:67], v[32:47]
    v_exp_f32 v112, v0
    v_exp_f32 v113, v1
    v_cvt_pk_bf16_f32 v99, v126, v127
    v_exp_f32 v114, v2
    v_exp_f32 v115, v3
    v_cvt_pk_bf16_f32 v92, v112, v113
    v_exp_f32 v116, v4
    v_exp_f32 v117, v5
    v_mfma_f32_32x32x16_bf16 v[48:63], v[88:91], v[96:99], v[48:63]
    ds_read_b128 v[84:87], v102 offset:7168
    ds_read_b128 v[88:91], v102 offset:7680
    ds_read_b128 v[68:71], v101 offset:49152
    v_cvt_pk_bf16_f32 v93, v114, v115
    v_exp_f32 v118, v6
    v_exp_f32 v119, v7
    v_cvt_pk_bf16_f32 v94, v116, v117
    v_exp_f32 v120, v8
    v_exp_f32 v121, v9
    v_cvt_pk_bf16_f32 v95, v118, v119
    v_exp_f32 v122, v10
    v_exp_f32 v123, v11
    v_mfma_f32_32x32x16_bf16 v[48:63], v[76:79], v[92:95], v[48:63]
    v_cvt_pk_bf16_f32 v96, v120, v121
    v_exp_f32 v124, v12
    v_exp_f32 v125, v13
    v_cvt_pk_bf16_f32 v97, v122, v123
    v_exp_f32 v126, v14
    v_exp_f32 v127, v15
    v_cvt_pk_bf16_f32 v98, v124, v125
    s_waitcnt lgkmcnt(0)
    v_mfma_f32_32x32x16_bf16 v[0:15], v[68:71], v[64:67], v[32:47]
    v_exp_f32 v112, v16
    v_exp_f32 v113, v17
    v_cvt_pk_bf16_f32 v99, v126, v127
    v_exp_f32 v114, v18
    v_exp_f32 v115, v19
    v_cvt_pk_bf16_f32 v92, v112, v113
    v_exp_f32 v116, v20
    v_exp_f32 v117, v21
    v_mfma_f32_32x32x16_bf16 v[48:63], v[80:83], v[96:99], v[48:63]
    v_add_u32 v103, v102, v105
    ds_read_b128 v[76:79], v103 offset:1024
    ds_read_b128 v[80:83], v103 offset:1536
    ds_read_b128 v[72:75], v101 offset:51200
    v_cvt_pk_bf16_f32 v93, v114, v115
    v_exp_f32 v118, v22
    v_exp_f32 v119, v23
    v_cvt_pk_bf16_f32 v94, v116, v117
    v_exp_f32 v120, v24
    v_exp_f32 v121, v25
    v_cvt_pk_bf16_f32 v95, v118, v119
    v_exp_f32 v122, v26
    v_exp_f32 v123, v27
    v_mfma_f32_32x32x16_bf16 v[48:63], v[84:87], v[92:95], v[48:63]
    v_cvt_pk_bf16_f32 v96, v120, v121
    v_exp_f32 v124, v28
    v_exp_f32 v125, v29
    v_cvt_pk_bf16_f32 v97, v122, v123
    v_exp_f32 v126, v30
    v_exp_f32 v127, v31
    v_cvt_pk_bf16_f32 v98, v124, v125
    s_waitcnt lgkmcnt(0)
    v_mfma_f32_32x32x16_bf16 v[16:31], v[72:75], v[64:67], v[32:47]
    v_exp_f32 v112, v0
    v_exp_f32 v113, v1
    v_cvt_pk_bf16_f32 v99, v126, v127
    v_exp_f32 v114, v2
    v_exp_f32 v115, v3
    v_cvt_pk_bf16_f32 v92, v112, v113
    v_exp_f32 v116, v4
    v_exp_f32 v117, v5
    v_mfma_f32_32x32x16_bf16 v[48:63], v[88:91], v[96:99], v[48:63]
    ds_read_b128 v[84:87], v103 offset:3072
    ds_read_b128 v[88:91], v103 offset:3584
    ds_read_b128 v[68:71], v101 offset:53248
    v_cvt_pk_bf16_f32 v93, v114, v115
    v_exp_f32 v118, v6
    v_exp_f32 v119, v7
    v_cvt_pk_bf16_f32 v94, v116, v117
    v_exp_f32 v120, v8
    v_exp_f32 v121, v9
    v_cvt_pk_bf16_f32 v95, v118, v119
    v_exp_f32 v122, v10
    v_exp_f32 v123, v11
    v_mfma_f32_32x32x16_bf16 v[48:63], v[76:79], v[92:95], v[48:63]
    v_cvt_pk_bf16_f32 v96, v120, v121
    v_exp_f32 v124, v12
    v_exp_f32 v125, v13
    v_cvt_pk_bf16_f32 v97, v122, v123
    v_exp_f32 v126, v14
    v_exp_f32 v127, v15
    v_cvt_pk_bf16_f32 v98, v124, v125
    s_waitcnt lgkmcnt(0)
    v_mfma_f32_32x32x16_bf16 v[0:15], v[68:71], v[64:67], v[32:47]
    v_exp_f32 v112, v16
    v_exp_f32 v113, v17
    v_cvt_pk_bf16_f32 v99, v126, v127
    v_exp_f32 v114, v18
    v_exp_f32 v115, v19
    v_cvt_pk_bf16_f32 v92, v112, v113
    v_exp_f32 v116, v20
    v_exp_f32 v117, v21
    v_mfma_f32_32x32x16_bf16 v[48:63], v[80:83], v[96:99], v[48:63]
    ds_read_b128 v[76:79], v103 offset:5120
    ds_read_b128 v[80:83], v103 offset:5632
    ds_read_b128 v[72:75], v101 offset:55296
    v_cvt_pk_bf16_f32 v93, v114, v115
    v_exp_f32 v118, v22
    v_exp_f32 v119, v23
    v_cvt_pk_bf16_f32 v94, v116, v117
    v_exp_f32 v120, v24
    v_exp_f32 v121, v25
    v_cvt_pk_bf16_f32 v95, v118, v119
    v_exp_f32 v122, v26
    v_exp_f32 v123, v27
    v_mfma_f32_32x32x16_bf16 v[48:63], v[84:87], v[92:95], v[48:63]
    v_cvt_pk_bf16_f32 v96, v120, v121
    v_exp_f32 v124, v28
    v_exp_f32 v125, v29
    v_cvt_pk_bf16_f32 v97, v122, v123
    v_exp_f32 v126, v30
    v_exp_f32 v127, v31
    v_cvt_pk_bf16_f32 v98, v124, v125
    s_waitcnt lgkmcnt(0)
    v_mfma_f32_32x32x16_bf16 v[16:31], v[72:75], v[64:67], v[32:47]
    v_exp_f32 v112, v0
    v_exp_f32 v113, v1
    v_cvt_pk_bf16_f32 v99, v126, v127
    v_exp_f32 v114, v2
    v_exp_f32 v115, v3
    v_cvt_pk_bf16_f32 v92, v112, v113
    v_exp_f32 v116, v4
    v_exp_f32 v117, v5
    v_mfma_f32_32x32x16_bf16 v[48:63], v[88:91], v[96:99], v[48:63]
    ds_read_b128 v[84:87], v103 offset:7168
    ds_read_b128 v[88:91], v103 offset:7680
    v_cvt_pk_bf16_f32 v93, v114, v115
    v_exp_f32 v118, v6
    v_exp_f32 v119, v7
    v_cvt_pk_bf16_f32 v94, v116, v117
    v_exp_f32 v120, v8
    v_exp_f32 v121, v9
    v_cvt_pk_bf16_f32 v95, v118, v119
    v_exp_f32 v122, v10
    v_exp_f32 v123, v11
    v_mfma_f32_32x32x16_bf16 v[48:63], v[76:79], v[92:95], v[48:63]
    v_cvt_pk_bf16_f32 v96, v120, v121
    v_exp_f32 v124, v12
    v_exp_f32 v125, v13
    v_cvt_pk_bf16_f32 v97, v122, v123
    v_exp_f32 v126, v14
    v_exp_f32 v127, v15
    v_cvt_pk_bf16_f32 v98, v124, v125
    s_waitcnt lgkmcnt(0)
    v_exp_f32 v112, v16
    v_exp_f32 v113, v17
    v_cvt_pk_bf16_f32 v99, v126, v127
    v_exp_f32 v114, v18
    v_exp_f32 v115, v19
    v_cvt_pk_bf16_f32 v92, v112, v113
    v_exp_f32 v116, v20
    v_exp_f32 v117, v21
    v_mfma_f32_32x32x16_bf16 v[48:63], v[80:83], v[96:99], v[48:63]
    v_cvt_pk_bf16_f32 v93, v114, v115
    v_exp_f32 v118, v22
    v_exp_f32 v119, v23
    v_cvt_pk_bf16_f32 v94, v116, v117
    v_exp_f32 v120, v24
    v_exp_f32 v121, v25
    v_cvt_pk_bf16_f32 v95, v118, v119
    v_exp_f32 v122, v26
    v_exp_f32 v123, v27
    v_mfma_f32_32x32x16_bf16 v[48:63], v[84:87], v[92:95], v[48:63]
    v_cvt_pk_bf16_f32 v96, v120, v121
    v_exp_f32 v124, v28
    v_exp_f32 v125, v29
    v_cvt_pk_bf16_f32 v97, v122, v123
    v_exp_f32 v126, v30
    v_exp_f32 v127, v31
    v_cvt_pk_bf16_f32 v98, v124, v125
    s_branch P2_end_22
P2_B_21:
    s_setprio 2
    s_waitcnt lgkmcnt(0)
    v_mfma_f32_32x32x16_bf16 v[16:31], v[72:75], v[64:67], v[32:47]
    s_nop 6
    v_exp_f32 v112, v0
    v_exp_f32 v113, v1
    v_cvt_pk_bf16_f32 v99, v126, v127
    v_exp_f32 v114, v2
    v_exp_f32 v115, v3
    v_cvt_pk_bf16_f32 v92, v112, v113
    v_exp_f32 v116, v4
    v_exp_f32 v117, v5
    v_mfma_f32_32x32x16_bf16 v[48:63], v[88:91], v[96:99], v[48:63]
    ds_read_b128 v[84:87], v102 offset:3072
    ds_read_b128 v[88:91], v102 offset:3584
    ds_read_b128 v[68:71], v100 offset:4096
    v_cvt_pk_bf16_f32 v93, v114, v115
    v_exp_f32 v118, v6
    v_exp_f32 v119, v7
    v_cvt_pk_bf16_f32 v94, v116, v117
    v_exp_f32 v120, v8
    v_exp_f32 v121, v9
    v_cvt_pk_bf16_f32 v95, v118, v119
    v_exp_f32 v122, v10
    v_exp_f32 v123, v11
    v_mfma_f32_32x32x16_bf16 v[48:63], v[76:79], v[92:95], v[48:63]
    v_cvt_pk_bf16_f32 v96, v120, v121
    v_exp_f32 v124, v12
    v_exp_f32 v125, v13
    v_cvt_pk_bf16_f32 v97, v122, v123
    v_exp_f32 v126, v14
    v_exp_f32 v127, v15
    v_cvt_pk_bf16_f32 v98, v124, v125
    s_waitcnt lgkmcnt(0)
    v_mfma_f32_32x32x16_bf16 v[0:15], v[68:71], v[64:67], v[32:47]
    v_exp_f32 v112, v16
    v_exp_f32 v113, v17
    v_cvt_pk_bf16_f32 v99, v126, v127
    v_exp_f32 v114, v18
    v_exp_f32 v115, v19
    v_cvt_pk_bf16_f32 v92, v112, v113
    v_exp_f32 v116, v20
    v_exp_f32 v117, v21
    v_mfma_f32_32x32x16_bf16 v[48:63], v[80:83], v[96:99], v[48:63]
    ds_read_b128 v[76:79], v102 offset:5120
    ds_read_b128 v[80:83], v102 offset:5632
    ds_read_b128 v[72:75], v100 offset:6144
    v_cvt_pk_bf16_f32 v93, v114, v115
    v_exp_f32 v118, v22
    v_exp_f32 v119, v23
    v_cvt_pk_bf16_f32 v94, v116, v117
    v_exp_f32 v120, v24
    v_exp_f32 v121, v25
    v_cvt_pk_bf16_f32 v95, v118, v119
    v_exp_f32 v122, v26
    v_exp_f32 v123, v27
    v_mfma_f32_32x32x16_bf16 v[48:63], v[84:87], v[92:95], v[48:63]
    v_cvt_pk_bf16_f32 v96, v120, v121
    v_exp_f32 v124, v28
    v_exp_f32 v125, v29
    v_cvt_pk_bf16_f32 v97, v122, v123
    v_exp_f32 v126, v30
    v_exp_f32 v127, v31
    v_cvt_pk_bf16_f32 v98, v124, v125
    s_setprio 0
    s_waitcnt lgkmcnt(0)
    v_mfma_f32_32x32x16_bf16 v[16:31], v[72:75], v[64:67], v[32:47]
    v_exp_f32 v112, v0
    v_exp_f32 v113, v1
    v_cvt_pk_bf16_f32 v99, v126, v127
    v_exp_f32 v114, v2
    v_exp_f32 v115, v3
    v_cvt_pk_bf16_f32 v92, v112, v113
    v_exp_f32 v116, v4
    v_exp_f32 v117, v5
    v_mfma_f32_32x32x16_bf16 v[48:63], v[88:91], v[96:99], v[48:63]
    ds_read_b128 v[84:87], v102 offset:7168
    ds_read_b128 v[88:91], v102 offset:7680
    v_cvt_pk_bf16_f32 v93, v114, v115
    v_exp_f32 v118, v6
    v_exp_f32 v119, v7
    v_cvt_pk_bf16_f32 v94, v116, v117
    v_exp_f32 v120, v8
    v_exp_f32 v121, v9
    v_cvt_pk_bf16_f32 v95, v118, v119
    v_exp_f32 v122, v10
    v_exp_f32 v123, v11
    v_mfma_f32_32x32x16_bf16 v[48:63], v[76:79], v[92:95], v[48:63]
    v_cvt_pk_bf16_f32 v96, v120, v121
    v_exp_f32 v124, v12
    v_exp_f32 v125, v13
    v_cvt_pk_bf16_f32 v97, v122, v123
    v_exp_f32 v126, v14
    v_exp_f32 v127, v15
    v_cvt_pk_bf16_f32 v98, v124, v125
    s_waitcnt vmcnt(0)
    s_barrier
    s_setprio 2
    ds_read_b128 v[68:71], v100 offset:16384
    s_waitcnt lgkmcnt(0)
    v_mfma_f32_32x32x16_bf16 v[0:15], v[68:71], v[64:67], v[32:47]
    v_exp_f32 v112, v16
    v_exp_f32 v113, v17
    v_cvt_pk_bf16_f32 v99, v126, v127
    v_exp_f32 v114, v18
    v_exp_f32 v115, v19
    v_cvt_pk_bf16_f32 v92, v112, v113
    v_exp_f32 v116, v20
    v_exp_f32 v117, v21
    v_mfma_f32_32x32x16_bf16 v[48:63], v[80:83], v[96:99], v[48:63]
    v_add_u32 v103, v102, v105
    ds_read_b128 v[76:79], v103 offset:1024
    ds_read_b128 v[80:83], v103 offset:1536
    ds_read_b128 v[72:75], v100 offset:18432
    v_cvt_pk_bf16_f32 v93, v114, v115
    v_exp_f32 v118, v22
    v_exp_f32 v119, v23
    v_cvt_pk_bf16_f32 v94, v116, v117
    v_exp_f32 v120, v24
    v_exp_f32 v121, v25
    v_cvt_pk_bf16_f32 v95, v118, v119
    v_exp_f32 v122, v26
    v_exp_f32 v123, v27
    v_mfma_f32_32x32x16_bf16 v[48:63], v[84:87], v[92:95], v[48:63]
    v_cvt_pk_bf16_f32 v96, v120, v121
    v_exp_f32 v124, v28
    v_exp_f32 v125, v29
    v_cvt_pk_bf16_f32 v97, v122, v123
    v_exp_f32 v126, v30
    v_exp_f32 v127, v31
    v_cvt_pk_bf16_f32 v98, v124, v125
    s_waitcnt lgkmcnt(0)
    v_mfma_f32_32x32x16_bf16 v[16:31], v[72:75], v[64:67], v[32:47]
    v_exp_f32 v112, v0
    v_exp_f32 v113, v1
    v_cvt_pk_bf16_f32 v99, v126, v127
    v_exp_f32 v114, v2
    v_exp_f32 v115, v3
    v_cvt_pk_bf16_f32 v92, v112, v113
    v_exp_f32 v116, v4
    v_exp_f32 v117, v5
    v_mfma_f32_32x32x16_bf16 v[48:63], v[88:91], v[96:99], v[48:63]
    ds_read_b128 v[84:87], v103 offset:3072
    ds_read_b128 v[88:91], v103 offset:3584
    ds_read_b128 v[68:71], v100 offset:20480
    v_cvt_pk_bf16_f32 v93, v114, v115
    v_exp_f32 v118, v6
    v_exp_f32 v119, v7
    v_cvt_pk_bf16_f32 v94, v116, v117
    v_exp_f32 v120, v8
    v_exp_f32 v121, v9
    v_cvt_pk_bf16_f32 v95, v118, v119
    v_exp_f32 v122, v10
    v_exp_f32 v123, v11
    v_mfma_f32_32x32x16_bf16 v[48:63], v[76:79], v[92:95], v[48:63]
    v_cvt_pk_bf16_f32 v96, v120, v121
    v_exp_f32 v124, v12
    v_exp_f32 v125, v13
    v_cvt_pk_bf16_f32 v97, v122, v123
    v_exp_f32 v126, v14
    v_exp_f32 v127, v15
    v_cvt_pk_bf16_f32 v98, v124, v125
    s_setprio 0
    s_waitcnt lgkmcnt(0)
    v_mfma_f32_32x32x16_bf16 v[0:15], v[68:71], v[64:67], v[32:47]
    v_exp_f32 v112, v16
    v_exp_f32 v113, v17
    v_cvt_pk_bf16_f32 v99, v126, v127
    v_exp_f32 v114, v18
    v_exp_f32 v115, v19
    v_cvt_pk_bf16_f32 v92, v112, v113
    v_exp_f32 v116, v20
    v_exp_f32 v117, v21
    v_mfma_f32_32x32x16_bf16 v[48:63], v[80:83], v[96:99], v[48:63]
    ds_read_b128 v[76:79], v103 offset:5120
    ds_read_b128 v[80:83], v103 offset:5632
    ds_read_b128 v[72:75], v100 offset:22528
    v_cvt_pk_bf16_f32 v93, v114, v115
    v_exp_f32 v118, v22
    v_exp_f32 v119, v23
    v_cvt_pk_bf16_f32 v94, v116, v117
    v_exp_f32 v120, v24
    v_exp_f32 v121, v25
    v_cvt_pk_bf16_f32 v95, v118, v119
    v_exp_f32 v122, v26
    v_exp_f32 v123, v27
    v_mfma_f32_32x32x16_bf16 v[48:63], v[84:87], v[92:95], v[48:63]
    v_cvt_pk_bf16_f32 v96, v120, v121
    v_exp_f32 v124, v28
    v_exp_f32 v125, v29
    v_cvt_pk_bf16_f32 v97, v122, v123
    v_exp_f32 v126, v30
    v_exp_f32 v127, v31
    v_cvt_pk_bf16_f32 v98, v124, v125
    s_waitcnt lgkmcnt(0)
    v_mfma_f32_32x32x16_bf16 v[16:31], v[72:75], v[64:67], v[32:47]
    v_exp_f32 v112, v0
    v_exp_f32 v113, v1
    v_cvt_pk_bf16_f32 v99, v126, v127
    v_exp_f32 v114, v2
    v_exp_f32 v115, v3
    v_cvt_pk_bf16_f32 v92, v112, v113
    v_exp_f32 v116, v4
    v_exp_f32 v117, v5
    v_mfma_f32_32x32x16_bf16 v[48:63], v[88:91], v[96:99], v[48:63]
    ds_read_b128 v[84:87], v103 offset:7168
    ds_read_b128 v[88:91], v103 offset:7680
    ds_read_b128 v[68:71], v100 offset:32768
    v_cvt_pk_bf16_f32 v93, v114, v115
    v_exp_f32 v118, v6
    v_exp_f32 v119, v7
    v_cvt_pk_bf16_f32 v94, v116, v117
    v_exp_f32 v120, v8
    v_exp_f32 v121, v9
    v_cvt_pk_bf16_f32 v95, v118, v119
    v_exp_f32 v122, v10
    v_exp_f32 v123, v11
    v_mfma_f32_32x32x16_bf16 v[48:63], v[76:79], v[92:95], v[48:63]
    v_cvt_pk_bf16_f32 v96, v120, v121
    v_exp_f32 v124, v12
    v_exp_f32 v125, v13
    v_cvt_pk_bf16_f32 v97, v122, v123
    v_exp_f32 v126, v14
    v_exp_f32 v127, v15
    v_cvt_pk_bf16_f32 v98, v124, v125
    s_waitcnt lgkmcnt(0)
    v_mfma_f32_32x32x16_bf16 v[0:15], v[68:71], v[64:67], v[32:47]
    v_exp_f32 v112, v16
    v_exp_f32 v113, v17
    v_cvt_pk_bf16_f32 v99, v126, v127
    v_exp_f32 v114, v18
    v_exp_f32 v115, v19
    v_cvt_pk_bf16_f32 v92, v112, v113
    v_exp_f32 v116, v20
    v_exp_f32 v117, v21
    v_mfma_f32_32x32x16_bf16 v[48:63], v[80:83], v[96:99], v[48:63]
    v_add_u32 v102, v103, v105
    ds_read_b128 v[76:79], v102 offset:1024
    ds_read_b128 v[80:83], v102 offset:1536
    ds_read_b128 v[72:75], v100 offset:34816
    v_cvt_pk_bf16_f32 v93, v114, v115
    v_exp_f32 v118, v22
    v_exp_f32 v119, v23
    v_cvt_pk_bf16_f32 v94, v116, v117
    v_exp_f32 v120, v24
    v_exp_f32 v121, v25
    v_cvt_pk_bf16_f32 v95, v118, v119
    v_exp_f32 v122, v26
    v_exp_f32 v123, v27
    v_mfma_f32_32x32x16_bf16 v[48:63], v[84:87], v[92:95], v[48:63]
    v_cvt_pk_bf16_f32 v96, v120, v121
    v_exp_f32 v124, v28
    v_exp_f32 v125, v29
    v_cvt_pk_bf16_f32 v97, v122, v123
    v_exp_f32 v126, v30
    v_exp_f32 v127, v31
    v_cvt_pk_bf16_f32 v98, v124, v125
    s_barrier
    s_setprio 2
    s_waitcnt lgkmcnt(0)
    v_mfma_f32_32x32x16_bf16 v[16:31], v[72:75], v[64:67], v[32:47]
    v_exp_f32 v112, v0
    v_exp_f32 v113, v1
    v_cvt_pk_bf16_f32 v99, v126, v127
    v_exp_f32 v114, v2
    v_exp_f32 v115, v3
    v_cvt_pk_bf16_f32 v92, v112, v113
    v_exp_f32 v116, v4
    v_exp_f32 v117, v5
    v_mfma_f32_32x32x16_bf16 v[48:63], v[88:91], v[96:99], v[48:63]
    ds_read_b128 v[84:87], v102 offset:3072
    ds_read_b128 v[88:91], v102 offset:3584
    ds_read_b128 v[68:71], v100 offset:36864
    v_cvt_pk_bf16_f32 v93, v114, v115
    v_exp_f32 v118, v6
    v_exp_f32 v119, v7
    v_cvt_pk_bf16_f32 v94, v116, v117
    v_exp_f32 v120, v8
    v_exp_f32 v121, v9
    v_cvt_pk_bf16_f32 v95, v118, v119
    v_exp_f32 v122, v10
    v_exp_f32 v123, v11
    v_mfma_f32_32x32x16_bf16 v[48:63], v[76:79], v[92:95], v[48:63]
    v_cvt_pk_bf16_f32 v96, v120, v121
    v_exp_f32 v124, v12
    v_exp_f32 v125, v13
    v_cvt_pk_bf16_f32 v97, v122, v123
    v_exp_f32 v126, v14
    v_exp_f32 v127, v15
    v_cvt_pk_bf16_f32 v98, v124, v125
    s_waitcnt lgkmcnt(0)
    v_mfma_f32_32x32x16_bf16 v[0:15], v[68:71], v[64:67], v[32:47]
    v_exp_f32 v112, v16
    v_exp_f32 v113, v17
    v_cvt_pk_bf16_f32 v99, v126, v127
    v_exp_f32 v114, v18
    v_exp_f32 v115, v19
    v_cvt_pk_bf16_f32 v92, v112, v113
    v_exp_f32 v116, v20
    v_exp_f32 v117, v21
    v_mfma_f32_32x32x16_bf16 v[48:63], v[80:83], v[96:99], v[48:63]
    ds_read_b128 v[76:79], v102 offset:5120
    ds_read_b128 v[80:83], v102 offset:5632
    ds_read_b128 v[72:75], v100 offset:38912
    v_cvt_pk_bf16_f32 v93, v114, v115
    v_exp_f32 v118, v22
    v_exp_f32 v119, v23
    v_cvt_pk_bf16_f32 v94, v116, v117
    v_exp_f32 v120, v24
    v_exp_f32 v121, v25
    v_cvt_pk_bf16_f32 v95, v118, v119
    v_exp_f32 v122, v26
    v_exp_f32 v123, v27
    v_mfma_f32_32x32x16_bf16 v[48:63], v[84:87], v[92:95], v[48:63]
    v_cvt_pk_bf16_f32 v96, v120, v121
    v_exp_f32 v124, v28
    v_exp_f32 v125, v29
    v_cvt_pk_bf16_f32 v97, v122, v123
    v_exp_f32 v126, v30
    v_exp_f32 v127, v31
    v_cvt_pk_bf16_f32 v98, v124, v125
    s_waitcnt lgkmcnt(0)
    v_mfma_f32_32x32x16_bf16 v[16:31], v[72:75], v[64:67], v[32:47]
    v_exp_f32 v112, v0
    v_exp_f32 v113, v1
    v_cvt_pk_bf16_f32 v99, v126, v127
    v_exp_f32 v114, v2
    v_exp_f32 v115, v3
    v_cvt_pk_bf16_f32 v92, v112, v113
    v_exp_f32 v116, v4
    v_exp_f32 v117, v5
    v_mfma_f32_32x32x16_bf16 v[48:63], v[88:91], v[96:99], v[48:63]
    ds_read_b128 v[84:87], v102 offset:7168
    ds_read_b128 v[88:91], v102 offset:7680
    ds_read_b128 v[68:71], v100 offset:49152
    v_cvt_pk_bf16_f32 v93, v114, v115
    v_exp_f32 v118, v6
    v_exp_f32 v119, v7
    v_cvt_pk_bf16_f32 v94, v116, v117
    v_exp_f32 v120, v8
    v_exp_f32 v121, v9
    v_cvt_pk_bf16_f32 v95, v118, v119
    v_exp_f32 v122, v10
    v_exp_f32 v123, v11
    v_mfma_f32_32x32x16_bf16 v[48:63], v[76:79], v[92:95], v[48:63]
    v_cvt_pk_bf16_f32 v96, v120, v121
    v_exp_f32 v124, v12
    v_exp_f32 v125, v13
    v_cvt_pk_bf16_f32 v97, v122, v123
    v_exp_f32 v126, v14
    v_exp_f32 v127, v15
    v_cvt_pk_bf16_f32 v98, v124, v125
    s_waitcnt lgkmcnt(0)
    v_mfma_f32_32x32x16_bf16 v[0:15], v[68:71], v[64:67], v[32:47]
    v_exp_f32 v112, v16
    v_exp_f32 v113, v17
    v_cvt_pk_bf16_f32 v99, v126, v127
    v_exp_f32 v114, v18
    v_exp_f32 v115, v19
    v_cvt_pk_bf16_f32 v92, v112, v113
    v_exp_f32 v116, v20
    v_exp_f32 v117, v21
    v_mfma_f32_32x32x16_bf16 v[48:63], v[80:83], v[96:99], v[48:63]
    v_add_u32 v103, v102, v105
    ds_read_b128 v[76:79], v103 offset:1024
    ds_read_b128 v[80:83], v103 offset:1536
    ds_read_b128 v[72:75], v100 offset:51200
    v_cvt_pk_bf16_f32 v93, v114, v115
    v_exp_f32 v118, v22
    v_exp_f32 v119, v23
    v_cvt_pk_bf16_f32 v94, v116, v117
    v_exp_f32 v120, v24
    v_exp_f32 v121, v25
    v_cvt_pk_bf16_f32 v95, v118, v119
    v_exp_f32 v122, v26
    v_exp_f32 v123, v27
    v_mfma_f32_32x32x16_bf16 v[48:63], v[84:87], v[92:95], v[48:63]
    v_cvt_pk_bf16_f32 v96, v120, v121
    v_exp_f32 v124, v28
    v_exp_f32 v125, v29
    v_cvt_pk_bf16_f32 v97, v122, v123
    v_exp_f32 v126, v30
    v_exp_f32 v127, v31
    v_cvt_pk_bf16_f32 v98, v124, v125
    s_waitcnt lgkmcnt(0)
    v_mfma_f32_32x32x16_bf16 v[16:31], v[72:75], v[64:67], v[32:47]
    v_exp_f32 v112, v0
    v_exp_f32 v113, v1
    v_cvt_pk_bf16_f32 v99, v126, v127
    v_exp_f32 v114, v2
    v_exp_f32 v115, v3
    v_cvt_pk_bf16_f32 v92, v112, v113
    v_exp_f32 v116, v4
    v_exp_f32 v117, v5
    v_mfma_f32_32x32x16_bf16 v[48:63], v[88:91], v[96:99], v[48:63]
    ds_read_b128 v[84:87], v103 offset:3072
    ds_read_b128 v[88:91], v103 offset:3584
    ds_read_b128 v[68:71], v100 offset:53248
    v_cvt_pk_bf16_f32 v93, v114, v115
    v_exp_f32 v118, v6
    v_exp_f32 v119, v7
    v_cvt_pk_bf16_f32 v94, v116, v117
    v_exp_f32 v120, v8
    v_exp_f32 v121, v9
    v_cvt_pk_bf16_f32 v95, v118, v119
    v_exp_f32 v122, v10
    v_exp_f32 v123, v11
    v_mfma_f32_32x32x16_bf16 v[48:63], v[76:79], v[92:95], v[48:63]
    v_cvt_pk_bf16_f32 v96, v120, v121
    v_exp_f32 v124, v12
    v_exp_f32 v125, v13
    v_cvt_pk_bf16_f32 v97, v122, v123
    v_exp_f32 v126, v14
    v_exp_f32 v127, v15
    v_cvt_pk_bf16_f32 v98, v124, v125
    s_setprio 0
    s_waitcnt lgkmcnt(0)
    v_mfma_f32_32x32x16_bf16 v[0:15], v[68:71], v[64:67], v[32:47]
    v_exp_f32 v112, v16
    v_exp_f32 v113, v17
    v_cvt_pk_bf16_f32 v99, v126, v127
    v_exp_f32 v114, v18
    v_exp_f32 v115, v19
    v_cvt_pk_bf16_f32 v92, v112, v113
    v_exp_f32 v116, v20
    v_exp_f32 v117, v21
    v_mfma_f32_32x32x16_bf16 v[48:63], v[80:83], v[96:99], v[48:63]
    ds_read_b128 v[76:79], v103 offset:5120
    ds_read_b128 v[80:83], v103 offset:5632
    ds_read_b128 v[72:75], v100 offset:55296
    v_cvt_pk_bf16_f32 v93, v114, v115
    v_exp_f32 v118, v22
    v_exp_f32 v119, v23
    v_cvt_pk_bf16_f32 v94, v116, v117
    v_exp_f32 v120, v24
    v_exp_f32 v121, v25
    v_cvt_pk_bf16_f32 v95, v118, v119
    v_exp_f32 v122, v26
    v_exp_f32 v123, v27
    v_mfma_f32_32x32x16_bf16 v[48:63], v[84:87], v[92:95], v[48:63]
    v_cvt_pk_bf16_f32 v96, v120, v121
    v_exp_f32 v124, v28
    v_exp_f32 v125, v29
    v_cvt_pk_bf16_f32 v97, v122, v123
    v_exp_f32 v126, v30
    v_exp_f32 v127, v31
    v_cvt_pk_bf16_f32 v98, v124, v125
    s_waitcnt lgkmcnt(0)
    v_mfma_f32_32x32x16_bf16 v[16:31], v[72:75], v[64:67], v[32:47]
    v_exp_f32 v112, v0
    v_exp_f32 v113, v1
    v_cvt_pk_bf16_f32 v99, v126, v127
    v_exp_f32 v114, v2
    v_exp_f32 v115, v3
    v_cvt_pk_bf16_f32 v92, v112, v113
    v_exp_f32 v116, v4
    v_exp_f32 v117, v5
    v_mfma_f32_32x32x16_bf16 v[48:63], v[88:91], v[96:99], v[48:63]
    ds_read_b128 v[84:87], v103 offset:7168
    ds_read_b128 v[88:91], v103 offset:7680
    ds_read_b128 v[68:71], v101 offset:0
    v_cvt_pk_bf16_f32 v93, v114, v115
    v_exp_f32 v118, v6
    v_exp_f32 v119, v7
    v_cvt_pk_bf16_f32 v94, v116, v117
    v_exp_f32 v120, v8
    v_exp_f32 v121, v9
    v_cvt_pk_bf16_f32 v95, v118, v119
    v_exp_f32 v122, v10
    v_exp_f32 v123, v11
    v_mfma_f32_32x32x16_bf16 v[48:63], v[76:79], v[92:95], v[48:63]
    v_cvt_pk_bf16_f32 v96, v120, v121
    v_exp_f32 v124, v12
    v_exp_f32 v125, v13
    v_cvt_pk_bf16_f32 v97, v122, v123
    v_exp_f32 v126, v14
    v_exp_f32 v127, v15
    v_cvt_pk_bf16_f32 v98, v124, v125
    s_waitcnt lgkmcnt(0)
    v_mfma_f32_32x32x16_bf16 v[0:15], v[68:71], v[64:67], v[32:47]
    v_exp_f32 v112, v16
    v_exp_f32 v113, v17
    v_cvt_pk_bf16_f32 v99, v126, v127
    v_exp_f32 v114, v18
    v_exp_f32 v115, v19
    v_cvt_pk_bf16_f32 v92, v112, v113
    v_exp_f32 v116, v20
    v_exp_f32 v117, v21
    v_mfma_f32_32x32x16_bf16 v[48:63], v[80:83], v[96:99], v[48:63]
    v_add_u32 v102, v103, v105
    ds_read_b128 v[76:79], v102 offset:1024
    ds_read_b128 v[80:83], v102 offset:1536
    ds_read_b128 v[72:75], v101 offset:2048
    v_cvt_pk_bf16_f32 v93, v114, v115
    v_exp_f32 v118, v22
    v_exp_f32 v119, v23
    v_cvt_pk_bf16_f32 v94, v116, v117
    v_exp_f32 v120, v24
    v_exp_f32 v121, v25
    v_cvt_pk_bf16_f32 v95, v118, v119
    v_exp_f32 v122, v26
    v_exp_f32 v123, v27
    v_mfma_f32_32x32x16_bf16 v[48:63], v[84:87], v[92:95], v[48:63]
    v_cvt_pk_bf16_f32 v96, v120, v121
    v_exp_f32 v124, v28
    v_exp_f32 v125, v29
    v_cvt_pk_bf16_f32 v97, v122, v123
    v_exp_f32 v126, v30
    v_exp_f32 v127, v31
    v_cvt_pk_bf16_f32 v98, v124, v125
    s_barrier
    s_setprio 2
    s_waitcnt lgkmcnt(0)
    v_mfma_f32_32x32x16_bf16 v[16:31], v[72:75], v[64:67], v[32:47]
    v_exp_f32 v112, v0
    v_exp_f32 v113, v1
    v_cvt_pk_bf16_f32 v99, v126, v127
    v_exp_f32 v114, v2
    v_exp_f32 v115, v3
    v_cvt_pk_bf16_f32 v92, v112, v113
    v_exp_f32 v116, v4
    v_exp_f32 v117, v5
    v_mfma_f32_32x32x16_bf16 v[48:63], v[88:91], v[96:99], v[48:63]
    ds_read_b128 v[84:87], v102 offset:3072
    ds_read_b128 v[88:91], v102 offset:3584
    ds_read_b128 v[68:71], v101 offset:4096
    v_cvt_pk_bf16_f32 v93, v114, v115
    v_exp_f32 v118, v6
    v_exp_f32 v119, v7
    v_cvt_pk_bf16_f32 v94, v116, v117
    v_exp_f32 v120, v8
    v_exp_f32 v121, v9
    v_cvt_pk_bf16_f32 v95, v118, v119
    v_exp_f32 v122, v10
    v_exp_f32 v123, v11
    v_mfma_f32_32x32x16_bf16 v[48:63], v[76:79], v[92:95], v[48:63]
    v_cvt_pk_bf16_f32 v96, v120, v121
    v_exp_f32 v124, v12
    v_exp_f32 v125, v13
    v_cvt_pk_bf16_f32 v97, v122, v123
    v_exp_f32 v126, v14
    v_exp_f32 v127, v15
    v_cvt_pk_bf16_f32 v98, v124, v125
    s_waitcnt lgkmcnt(0)
    v_mfma_f32_32x32x16_bf16 v[0:15], v[68:71], v[64:67], v[32:47]
    v_exp_f32 v112, v16
    v_exp_f32 v113, v17
    v_cvt_pk_bf16_f32 v99, v126, v127
    v_exp_f32 v114, v18
    v_exp_f32 v115, v19
    v_cvt_pk_bf16_f32 v92, v112, v113
    v_exp_f32 v116, v20
    v_exp_f32 v117, v21
    v_mfma_f32_32x32x16_bf16 v[48:63], v[80:83], v[96:99], v[48:63]
    ds_read_b128 v[76:79], v102 offset:5120
    ds_read_b128 v[80:83], v102 offset:5632
    ds_read_b128 v[72:75], v101 offset:6144
    v_cvt_pk_bf16_f32 v93, v114, v115
    v_exp_f32 v118, v22
    v_exp_f32 v119, v23
    v_cvt_pk_bf16_f32 v94, v116, v117
    v_exp_f32 v120, v24
    v_exp_f32 v121, v25
    v_cvt_pk_bf16_f32 v95, v118, v119
    v_exp_f32 v122, v26
    v_exp_f32 v123, v27
    v_mfma_f32_32x32x16_bf16 v[48:63], v[84:87], v[92:95], v[48:63]
    v_cvt_pk_bf16_f32 v96, v120, v121
    v_exp_f32 v124, v28
    v_exp_f32 v125, v29
    v_cvt_pk_bf16_f32 v97, v122, v123
    v_exp_f32 v126, v30
    v_exp_f32 v127, v31
    v_cvt_pk_bf16_f32 v98, v124, v125
    s_waitcnt lgkmcnt(0)
    v_mfma_f32_32x32x16_bf16 v[16:31], v[72:75], v[64:67], v[32:47]
    v_exp_f32 v112, v0
    v_exp_f32 v113, v1
    v_cvt_pk_bf16_f32 v99, v126, v127
    v_exp_f32 v114, v2
    v_exp_f32 v115, v3
    v_cvt_pk_bf16_f32 v92, v112, v113
    v_exp_f32 v116, v4
    v_exp_f32 v117, v5
    v_mfma_f32_32x32x16_bf16 v[48:63], v[88:91], v[96:99], v[48:63]
    ds_read_b128 v[84:87], v102 offset:7168
    ds_read_b128 v[88:91], v102 offset:7680
    ds_read_b128 v[68:71], v101 offset:16384
    v_cvt_pk_bf16_f32 v93, v114, v115
    v_exp_f32 v118, v6
    v_exp_f32 v119, v7
    v_cvt_pk_bf16_f32 v94, v116, v117
    v_exp_f32 v120, v8
    v_exp_f32 v121, v9
    v_cvt_pk_bf16_f32 v95, v118, v119
    v_exp_f32 v122, v10
    v_exp_f32 v123, v11
    v_mfma_f32_32x32x16_bf16 v[48:63], v[76:79], v[92:95], v[48:63]
    v_cvt_pk_bf16_f32 v96, v120, v121
    v_exp_f32 v124, v12
    v_exp_f32 v125, v13
    v_cvt_pk_bf16_f32 v97, v122, v123
    v_exp_f32 v126, v14
    v_exp_f32 v127, v15
    v_cvt_pk_bf16_f32 v98, v124, v125
    s_waitcnt lgkmcnt(0)
    v_mfma_f32_32x32x16_bf16 v[0:15], v[68:71], v[64:67], v[32:47]
    v_exp_f32 v112, v16
    v_exp_f32 v113, v17
    v_cvt_pk_bf16_f32 v99, v126, v127
    v_exp_f32 v114, v18
    v_exp_f32 v115, v19
    v_cvt_pk_bf16_f32 v92, v112, v113
    v_exp_f32 v116, v20
    v_exp_f32 v117, v21
    v_mfma_f32_32x32x16_bf16 v[48:63], v[80:83], v[96:99], v[48:63]
    v_add_u32 v103, v102, v105
    ds_read_b128 v[76:79], v103 offset:1024
    ds_read_b128 v[80:83], v103 offset:1536
    ds_read_b128 v[72:75], v101 offset:18432
    v_cvt_pk_bf16_f32 v93, v114, v115
    v_exp_f32 v118, v22
    v_exp_f32 v119, v23
    v_cvt_pk_bf16_f32 v94, v116, v117
    v_exp_f32 v120, v24
    v_exp_f32 v121, v25
    v_cvt_pk_bf16_f32 v95, v118, v119
    v_exp_f32 v122, v26
    v_exp_f32 v123, v27
    v_mfma_f32_32x32x16_bf16 v[48:63], v[84:87], v[92:95], v[48:63]
    v_cvt_pk_bf16_f32 v96, v120, v121
    v_exp_f32 v124, v28
    v_exp_f32 v125, v29
    v_cvt_pk_bf16_f32 v97, v122, v123
    v_exp_f32 v126, v30
    v_exp_f32 v127, v31
    v_cvt_pk_bf16_f32 v98, v124, v125
    s_waitcnt lgkmcnt(0)
    v_mfma_f32_32x32x16_bf16 v[16:31], v[72:75], v[64:67], v[32:47]
    v_exp_f32 v112, v0
    v_exp_f32 v113, v1
    v_cvt_pk_bf16_f32 v99, v126, v127
    v_exp_f32 v114, v2
    v_exp_f32 v115, v3
    v_cvt_pk_bf16_f32 v92, v112, v113
    v_exp_f32 v116, v4
    v_exp_f32 v117, v5
    v_mfma_f32_32x32x16_bf16 v[48:63], v[88:91], v[96:99], v[48:63]
    ds_read_b128 v[84:87], v103 offset:3072
    ds_read_b128 v[88:91], v103 offset:3584
    ds_read_b128 v[68:71], v101 offset:20480
    v_cvt_pk_bf16_f32 v93, v114, v115
    v_exp_f32 v118, v6
    v_exp_f32 v119, v7
    v_cvt_pk_bf16_f32 v94, v116, v117
    v_exp_f32 v120, v8
    v_exp_f32 v121, v9
    v_cvt_pk_bf16_f32 v95, v118, v119
    v_exp_f32 v122, v10
    v_exp_f32 v123, v11
    v_mfma_f32_32x32x16_bf16 v[48:63], v[76:79], v[92:95], v[48:63]
    v_cvt_pk_bf16_f32 v96, v120, v121
    v_exp_f32 v124, v12
    v_exp_f32 v125, v13
    v_cvt_pk_bf16_f32 v97, v122, v123
    v_exp_f32 v126, v14
    v_exp_f32 v127, v15
    v_cvt_pk_bf16_f32 v98, v124, v125
    s_setprio 0
    s_waitcnt lgkmcnt(0)
    v_mfma_f32_32x32x16_bf16 v[0:15], v[68:71], v[64:67], v[32:47]
    v_exp_f32 v112, v16
    v_exp_f32 v113, v17
    v_cvt_pk_bf16_f32 v99, v126, v127
    v_exp_f32 v114, v18
    v_exp_f32 v115, v19
    v_cvt_pk_bf16_f32 v92, v112, v113
    v_exp_f32 v116, v20
    v_exp_f32 v117, v21
    v_mfma_f32_32x32x16_bf16 v[48:63], v[80:83], v[96:99], v[48:63]
    ds_read_b128 v[76:79], v103 offset:5120
    ds_read_b128 v[80:83], v103 offset:5632
    ds_read_b128 v[72:75], v101 offset:22528
    v_cvt_pk_bf16_f32 v93, v114, v115
    v_exp_f32 v118, v22
    v_exp_f32 v119, v23
    v_cvt_pk_bf16_f32 v94, v116, v117
    v_exp_f32 v120, v24
    v_exp_f32 v121, v25
    v_cvt_pk_bf16_f32 v95, v118, v119
    v_exp_f32 v122, v26
    v_exp_f32 v123, v27
    v_mfma_f32_32x32x16_bf16 v[48:63], v[84:87], v[92:95], v[48:63]
    v_cvt_pk_bf16_f32 v96, v120, v121
    v_exp_f32 v124, v28
    v_exp_f32 v125, v29
    v_cvt_pk_bf16_f32 v97, v122, v123
    v_exp_f32 v126, v30
    v_exp_f32 v127, v31
    v_cvt_pk_bf16_f32 v98, v124, v125
    s_waitcnt lgkmcnt(0)
    v_mfma_f32_32x32x16_bf16 v[16:31], v[72:75], v[64:67], v[32:47]
    v_exp_f32 v112, v0
    v_exp_f32 v113, v1
    v_cvt_pk_bf16_f32 v99, v126, v127
    v_exp_f32 v114, v2
    v_exp_f32 v115, v3
    v_cvt_pk_bf16_f32 v92, v112, v113
    v_exp_f32 v116, v4
    v_exp_f32 v117, v5
    v_mfma_f32_32x32x16_bf16 v[48:63], v[88:91], v[96:99], v[48:63]
    ds_read_b128 v[84:87], v103 offset:7168
    ds_read_b128 v[88:91], v103 offset:7680
    ds_read_b128 v[68:71], v101 offset:32768
    v_cvt_pk_bf16_f32 v93, v114, v115
    v_exp_f32 v118, v6
    v_exp_f32 v119, v7
    v_cvt_pk_bf16_f32 v94, v116, v117
    v_exp_f32 v120, v8
    v_exp_f32 v121, v9
    v_cvt_pk_bf16_f32 v95, v118, v119
    v_exp_f32 v122, v10
    v_exp_f32 v123, v11
    v_mfma_f32_32x32x16_bf16 v[48:63], v[76:79], v[92:95], v[48:63]
    v_cvt_pk_bf16_f32 v96, v120, v121
    v_exp_f32 v124, v12
    v_exp_f32 v125, v13
    v_cvt_pk_bf16_f32 v97, v122, v123
    v_exp_f32 v126, v14
    v_exp_f32 v127, v15
    v_cvt_pk_bf16_f32 v98, v124, v125
    s_waitcnt lgkmcnt(0)
    v_mfma_f32_32x32x16_bf16 v[0:15], v[68:71], v[64:67], v[32:47]
    v_exp_f32 v112, v16
    v_exp_f32 v113, v17
    v_cvt_pk_bf16_f32 v99, v126, v127
    v_exp_f32 v114, v18
    v_exp_f32 v115, v19
    v_cvt_pk_bf16_f32 v92, v112, v113
    v_exp_f32 v116, v20
    v_exp_f32 v117, v21
    v_mfma_f32_32x32x16_bf16 v[48:63], v[80:83], v[96:99], v[48:63]
    v_add_u32 v102, v103, v105
    ds_read_b128 v[76:79], v102 offset:1024
    ds_read_b128 v[80:83], v102 offset:1536
    ds_read_b128 v[72:75], v101 offset:34816
    v_cvt_pk_bf16_f32 v93, v114, v115
    v_exp_f32 v118, v22
    v_exp_f32 v119, v23
    v_cvt_pk_bf16_f32 v94, v116, v117
    v_exp_f32 v120, v24
    v_exp_f32 v121, v25
    v_cvt_pk_bf16_f32 v95, v118, v119
    v_exp_f32 v122, v26
    v_exp_f32 v123, v27
    v_mfma_f32_32x32x16_bf16 v[48:63], v[84:87], v[92:95], v[48:63]
    v_cvt_pk_bf16_f32 v96, v120, v121
    v_exp_f32 v124, v28
    v_exp_f32 v125, v29
    v_cvt_pk_bf16_f32 v97, v122, v123
    v_exp_f32 v126, v30
    v_exp_f32 v127, v31
    v_cvt_pk_bf16_f32 v98, v124, v125
    s_barrier
    s_setprio 2
    s_waitcnt lgkmcnt(0)
    v_mfma_f32_32x32x16_bf16 v[16:31], v[72:75], v[64:67], v[32:47]
    v_exp_f32 v112, v0
    v_exp_f32 v113, v1
    v_cvt_pk_bf16_f32 v99, v126, v127
    v_exp_f32 v114, v2
    v_exp_f32 v115, v3
    v_cvt_pk_bf16_f32 v92, v112, v113
    v_exp_f32 v116, v4
    v_exp_f32 v117, v5
    v_mfma_f32_32x32x16_bf16 v[48:63], v[88:91], v[96:99], v[48:63]
    ds_read_b128 v[84:87], v102 offset:3072
    ds_read_b128 v[88:91], v102 offset:3584
    ds_read_b128 v[68:71], v101 offset:36864
    v_cvt_pk_bf16_f32 v93, v114, v115
    v_exp_f32 v118, v6
    v_exp_f32 v119, v7
    v_cvt_pk_bf16_f32 v94, v116, v117
    v_exp_f32 v120, v8
    v_exp_f32 v121, v9
    v_cvt_pk_bf16_f32 v95, v118, v119
    v_exp_f32 v122, v10
    v_exp_f32 v123, v11
    v_mfma_f32_32x32x16_bf16 v[48:63], v[76:79], v[92:95], v[48:63]
    v_cvt_pk_bf16_f32 v96, v120, v121
    v_exp_f32 v124, v12
    v_exp_f32 v125, v13
    v_cvt_pk_bf16_f32 v97, v122, v123
    v_exp_f32 v126, v14
    v_exp_f32 v127, v15
    v_cvt_pk_bf16_f32 v98, v124, v125
    s_waitcnt lgkmcnt(0)
    v_mfma_f32_32x32x16_bf16 v[0:15], v[68:71], v[64:67], v[32:47]
    v_exp_f32 v112, v16
    v_exp_f32 v113, v17
    v_cvt_pk_bf16_f32 v99, v126, v127
    v_exp_f32 v114, v18
    v_exp_f32 v115, v19
    v_cvt_pk_bf16_f32 v92, v112, v113
    v_exp_f32 v116, v20
    v_exp_f32 v117, v21
    v_mfma_f32_32x32x16_bf16 v[48:63], v[80:83], v[96:99], v[48:63]
    ds_read_b128 v[76:79], v102 offset:5120
    ds_read_b128 v[80:83], v102 offset:5632
    ds_read_b128 v[72:75], v101 offset:38912
    v_cvt_pk_bf16_f32 v93, v114, v115
    v_exp_f32 v118, v22
    v_exp_f32 v119, v23
    v_cvt_pk_bf16_f32 v94, v116, v117
    v_exp_f32 v120, v24
    v_exp_f32 v121, v25
    v_cvt_pk_bf16_f32 v95, v118, v119
    v_exp_f32 v122, v26
    v_exp_f32 v123, v27
    v_mfma_f32_32x32x16_bf16 v[48:63], v[84:87], v[92:95], v[48:63]
    v_cvt_pk_bf16_f32 v96, v120, v121
    v_exp_f32 v124, v28
    v_exp_f32 v125, v29
    v_cvt_pk_bf16_f32 v97, v122, v123
    v_exp_f32 v126, v30
    v_exp_f32 v127, v31
    v_cvt_pk_bf16_f32 v98, v124, v125
    s_waitcnt lgkmcnt(0)
    v_mfma_f32_32x32x16_bf16 v[16:31], v[72:75], v[64:67], v[32:47]
    v_exp_f32 v112, v0
    v_exp_f32 v113, v1
    v_cvt_pk_bf16_f32 v99, v126, v127
    v_exp_f32 v114, v2
    v_exp_f32 v115, v3
    v_cvt_pk_bf16_f32 v92, v112, v113
    v_exp_f32 v116, v4
    v_exp_f32 v117, v5
    v_mfma_f32_32x32x16_bf16 v[48:63], v[88:91], v[96:99], v[48:63]
    ds_read_b128 v[84:87], v102 offset:7168
    ds_read_b128 v[88:91], v102 offset:7680
    ds_read_b128 v[68:71], v101 offset:49152
    v_cvt_pk_bf16_f32 v93, v114, v115
    v_exp_f32 v118, v6
    v_exp_f32 v119, v7
    v_cvt_pk_bf16_f32 v94, v116, v117
    v_exp_f32 v120, v8
    v_exp_f32 v121, v9
    v_cvt_pk_bf16_f32 v95, v118, v119
    v_exp_f32 v122, v10
    v_exp_f32 v123, v11
    v_mfma_f32_32x32x16_bf16 v[48:63], v[76:79], v[92:95], v[48:63]
    v_cvt_pk_bf16_f32 v96, v120, v121
    v_exp_f32 v124, v12
    v_exp_f32 v125, v13
    v_cvt_pk_bf16_f32 v97, v122, v123
    v_exp_f32 v126, v14
    v_exp_f32 v127, v15
    v_cvt_pk_bf16_f32 v98, v124, v125
    s_waitcnt lgkmcnt(0)
    v_mfma_f32_32x32x16_bf16 v[0:15], v[68:71], v[64:67], v[32:47]
    v_exp_f32 v112, v16
    v_exp_f32 v113, v17
    v_cvt_pk_bf16_f32 v99, v126, v127
    v_exp_f32 v114, v18
    v_exp_f32 v115, v19
    v_cvt_pk_bf16_f32 v92, v112, v113
    v_exp_f32 v116, v20
    v_exp_f32 v117, v21
    v_mfma_f32_32x32x16_bf16 v[48:63], v[80:83], v[96:99], v[48:63]
    v_add_u32 v103, v102, v105
    ds_read_b128 v[76:79], v103 offset:1024
    ds_read_b128 v[80:83], v103 offset:1536
    ds_read_b128 v[72:75], v101 offset:51200
    v_cvt_pk_bf16_f32 v93, v114, v115
    v_exp_f32 v118, v22
    v_exp_f32 v119, v23
    v_cvt_pk_bf16_f32 v94, v116, v117
    v_exp_f32 v120, v24
    v_exp_f32 v121, v25
    v_cvt_pk_bf16_f32 v95, v118, v119
    v_exp_f32 v122, v26
    v_exp_f32 v123, v27
    v_mfma_f32_32x32x16_bf16 v[48:63], v[84:87], v[92:95], v[48:63]
    v_cvt_pk_bf16_f32 v96, v120, v121
    v_exp_f32 v124, v28
    v_exp_f32 v125, v29
    v_cvt_pk_bf16_f32 v97, v122, v123
    v_exp_f32 v126, v30
    v_exp_f32 v127, v31
    v_cvt_pk_bf16_f32 v98, v124, v125
    s_waitcnt lgkmcnt(0)
    v_mfma_f32_32x32x16_bf16 v[16:31], v[72:75], v[64:67], v[32:47]
    v_exp_f32 v112, v0
    v_exp_f32 v113, v1
    v_cvt_pk_bf16_f32 v99, v126, v127
    v_exp_f32 v114, v2
    v_exp_f32 v115, v3
    v_cvt_pk_bf16_f32 v92, v112, v113
    v_exp_f32 v116, v4
    v_exp_f32 v117, v5
    v_mfma_f32_32x32x16_bf16 v[48:63], v[88:91], v[96:99], v[48:63]
    ds_read_b128 v[84:87], v103 offset:3072
    ds_read_b128 v[88:91], v103 offset:3584
    ds_read_b128 v[68:71], v101 offset:53248
    v_cvt_pk_bf16_f32 v93, v114, v115
    v_exp_f32 v118, v6
    v_exp_f32 v119, v7
    v_cvt_pk_bf16_f32 v94, v116, v117
    v_exp_f32 v120, v8
    v_exp_f32 v121, v9
    v_cvt_pk_bf16_f32 v95, v118, v119
    v_exp_f32 v122, v10
    v_exp_f32 v123, v11
    v_mfma_f32_32x32x16_bf16 v[48:63], v[76:79], v[92:95], v[48:63]
    v_cvt_pk_bf16_f32 v96, v120, v121
    v_exp_f32 v124, v12
    v_exp_f32 v125, v13
    v_cvt_pk_bf16_f32 v97, v122, v123
    v_exp_f32 v126, v14
    v_exp_f32 v127, v15
    v_cvt_pk_bf16_f32 v98, v124, v125
    s_setprio 0
    s_waitcnt lgkmcnt(0)
    v_mfma_f32_32x32x16_bf16 v[0:15], v[68:71], v[64:67], v[32:47]
    v_exp_f32 v112, v16
    v_exp_f32 v113, v17
    v_cvt_pk_bf16_f32 v99, v126, v127
    v_exp_f32 v114, v18
    v_exp_f32 v115, v19
    v_cvt_pk_bf16_f32 v92, v112, v113
    v_exp_f32 v116, v20
    v_exp_f32 v117, v21
    v_mfma_f32_32x32x16_bf16 v[48:63], v[80:83], v[96:99], v[48:63]
    ds_read_b128 v[76:79], v103 offset:5120
    ds_read_b128 v[80:83], v103 offset:5632
    ds_read_b128 v[72:75], v101 offset:55296
    v_cvt_pk_bf16_f32 v93, v114, v115
    v_exp_f32 v118, v22
    v_exp_f32 v119, v23
    v_cvt_pk_bf16_f32 v94, v116, v117
    v_exp_f32 v120, v24
    v_exp_f32 v121, v25
    v_cvt_pk_bf16_f32 v95, v118, v119
    v_exp_f32 v122, v26
    v_exp_f32 v123, v27
    v_mfma_f32_32x32x16_bf16 v[48:63], v[84:87], v[92:95], v[48:63]
    v_cvt_pk_bf16_f32 v96, v120, v121
    v_exp_f32 v124, v28
    v_exp_f32 v125, v29
    v_cvt_pk_bf16_f32 v97, v122, v123
    v_exp_f32 v126, v30
    v_exp_f32 v127, v31
    v_cvt_pk_bf16_f32 v98, v124, v125
    s_waitcnt lgkmcnt(0)
    v_mfma_f32_32x32x16_bf16 v[16:31], v[72:75], v[64:67], v[32:47]
    v_exp_f32 v112, v0
    v_exp_f32 v113, v1
    v_cvt_pk_bf16_f32 v99, v126, v127
    v_exp_f32 v114, v2
    v_exp_f32 v115, v3
    v_cvt_pk_bf16_f32 v92, v112, v113
    v_exp_f32 v116, v4
    v_exp_f32 v117, v5
    v_mfma_f32_32x32x16_bf16 v[48:63], v[88:91], v[96:99], v[48:63]
    ds_read_b128 v[84:87], v103 offset:7168
    ds_read_b128 v[88:91], v103 offset:7680
    ds_read_b128 v[68:71], v100 offset:0
    v_cvt_pk_bf16_f32 v93, v114, v115
    v_exp_f32 v118, v6
    v_exp_f32 v119, v7
    v_cvt_pk_bf16_f32 v94, v116, v117
    v_exp_f32 v120, v8
    v_exp_f32 v121, v9
    v_cvt_pk_bf16_f32 v95, v118, v119
    v_exp_f32 v122, v10
    v_exp_f32 v123, v11
    v_mfma_f32_32x32x16_bf16 v[48:63], v[76:79], v[92:95], v[48:63]
    v_cvt_pk_bf16_f32 v96, v120, v121
    v_exp_f32 v124, v12
    v_exp_f32 v125, v13
    v_cvt_pk_bf16_f32 v97, v122, v123
    v_exp_f32 v126, v14
    v_exp_f32 v127, v15
    v_cvt_pk_bf16_f32 v98, v124, v125
    s_waitcnt lgkmcnt(0)
    v_mfma_f32_32x32x16_bf16 v[0:15], v[68:71], v[64:67], v[32:47]
    v_exp_f32 v112, v16
    v_exp_f32 v113, v17
    v_cvt_pk_bf16_f32 v99, v126, v127
    v_exp_f32 v114, v18
    v_exp_f32 v115, v19
    v_cvt_pk_bf16_f32 v92, v112, v113
    v_exp_f32 v116, v20
    v_exp_f32 v117, v21
    v_mfma_f32_32x32x16_bf16 v[48:63], v[80:83], v[96:99], v[48:63]
    v_mov_b32 v102, v104
    ds_read_b128 v[76:79], v102 offset:1024
    ds_read_b128 v[80:83], v102 offset:1536
    ds_read_b128 v[72:75], v100 offset:2048
    v_cvt_pk_bf16_f32 v93, v114, v115
    v_exp_f32 v118, v22
    v_exp_f32 v119, v23
    v_cvt_pk_bf16_f32 v94, v116, v117
    v_exp_f32 v120, v24
    v_exp_f32 v121, v25
    v_cvt_pk_bf16_f32 v95, v118, v119
    v_exp_f32 v122, v26
    v_exp_f32 v123, v27
    v_mfma_f32_32x32x16_bf16 v[48:63], v[84:87], v[92:95], v[48:63]
    v_cvt_pk_bf16_f32 v96, v120, v121
    v_exp_f32 v124, v28
    v_exp_f32 v125, v29
    v_cvt_pk_bf16_f32 v97, v122, v123
    v_exp_f32 v126, v30
    v_exp_f32 v127, v31
    v_cvt_pk_bf16_f32 v98, v124, v125
    s_barrier
    s_setprio 2
    s_waitcnt lgkmcnt(0)
    v_mfma_f32_32x32x16_bf16 v[16:31], v[72:75], v[64:67], v[32:47]
    v_exp_f32 v112, v0
    v_exp_f32 v113, v1
    v_cvt_pk_bf16_f32 v99, v126, v127
    v_exp_f32 v114, v2
    v_exp_f32 v115, v3
    v_cvt_pk_bf16_f32 v92, v112, v113
    v_exp_f32 v116, v4
    v_exp_f32 v117, v5
    v_mfma_f32_32x32x16_bf16 v[48:63], v[88:91], v[96:99], v[48:63]
    ds_read_b128 v[84:87], v102 offset:3072
    ds_read_b128 v[88:91], v102 offset:3584
    ds_read_b128 v[68:71], v100 offset:4096
    v_cvt_pk_bf16_f32 v93, v114, v115
    v_exp_f32 v118, v6
    v_exp_f32 v119, v7
    v_cvt_pk_bf16_f32 v94, v116, v117
    v_exp_f32 v120, v8
    v_exp_f32 v121, v9
    v_cvt_pk_bf16_f32 v95, v118, v119
    v_exp_f32 v122, v10
    v_exp_f32 v123, v11
    v_mfma_f32_32x32x16_bf16 v[48:63], v[76:79], v[92:95], v[48:63]
    v_cvt_pk_bf16_f32 v96, v120, v121
    v_exp_f32 v124, v12
    v_exp_f32 v125, v13
    v_cvt_pk_bf16_f32 v97, v122, v123
    v_exp_f32 v126, v14
    v_exp_f32 v127, v15
    v_cvt_pk_bf16_f32 v98, v124, v125
    s_waitcnt lgkmcnt(0)
    v_mfma_f32_32x32x16_bf16 v[0:15], v[68:71], v[64:67], v[32:47]
    v_exp_f32 v112, v16
    v_exp_f32 v113, v17
    v_cvt_pk_bf16_f32 v99, v126, v127
    v_exp_f32 v114, v18
    v_exp_f32 v115, v19
    v_cvt_pk_bf16_f32 v92, v112, v113
    v_exp_f32 v116, v20
    v_exp_f32 v117, v21
    v_mfma_f32_32x32x16_bf16 v[48:63], v[80:83], v[96:99], v[48:63]
    ds_read_b128 v[76:79], v102 offset:5120
    ds_read_b128 v[80:83], v102 offset:5632
    ds_read_b128 v[72:75], v100 offset:6144
    v_cvt_pk_bf16_f32 v93, v114, v115
    v_exp_f32 v118, v22
    v_exp_f32 v119, v23
    v_cvt_pk_bf16_f32 v94, v116, v117
    v_exp_f32 v120, v24
    v_exp_f32 v121, v25
    v_cvt_pk_bf16_f32 v95, v118, v119
    v_exp_f32 v122, v26
    v_exp_f32 v123, v27
    v_mfma_f32_32x32x16_bf16 v[48:63], v[84:87], v[92:95], v[48:63]
    v_cvt_pk_bf16_f32 v96, v120, v121
    v_exp_f32 v124, v28
    v_exp_f32 v125, v29
    v_cvt_pk_bf16_f32 v97, v122, v123
    v_exp_f32 v126, v30
    v_exp_f32 v127, v31
    v_cvt_pk_bf16_f32 v98, v124, v125
    s_waitcnt lgkmcnt(0)
    v_mfma_f32_32x32x16_bf16 v[16:31], v[72:75], v[64:67], v[32:47]
    v_exp_f32 v112, v0
    v_exp_f32 v113, v1
    v_cvt_pk_bf16_f32 v99, v126, v127
    v_exp_f32 v114, v2
    v_exp_f32 v115, v3
    v_cvt_pk_bf16_f32 v92, v112, v113
    v_exp_f32 v116, v4
    v_exp_f32 v117, v5
    v_mfma_f32_32x32x16_bf16 v[48:63], v[88:91], v[96:99], v[48:63]
    ds_read_b128 v[84:87], v102 offset:7168
    ds_read_b128 v[88:91], v102 offset:7680
    ds_read_b128 v[68:71], v100 offset:16384
    v_cvt_pk_bf16_f32 v93, v114, v115
    v_exp_f32 v118, v6
    v_exp_f32 v119, v7
    v_cvt_pk_bf16_f32 v94, v116, v117
    v_exp_f32 v120, v8
    v_exp_f32 v121, v9
    v_cvt_pk_bf16_f32 v95, v118, v119
    v_exp_f32 v122, v10
    v_exp_f32 v123, v11
    v_mfma_f32_32x32x16_bf16 v[48:63], v[76:79], v[92:95], v[48:63]
    v_cvt_pk_bf16_f32 v96, v120, v121
    v_exp_f32 v124, v12
    v_exp_f32 v125, v13
    v_cvt_pk_bf16_f32 v97, v122, v123
    v_exp_f32 v126, v14
    v_exp_f32 v127, v15
    v_cvt_pk_bf16_f32 v98, v124, v125
    s_waitcnt lgkmcnt(0)
    v_mfma_f32_32x32x16_bf16 v[0:15], v[68:71], v[64:67], v[32:47]
    v_exp_f32 v112, v16
    v_exp_f32 v113, v17
    v_cvt_pk_bf16_f32 v99, v126, v127
    v_exp_f32 v114, v18
    v_exp_f32 v115, v19
    v_cvt_pk_bf16_f32 v92, v112, v113
    v_exp_f32 v116, v20
    v_exp_f32 v117, v21
    v_mfma_f32_32x32x16_bf16 v[48:63], v[80:83], v[96:99], v[48:63]
    v_add_u32 v103, v102, v105
    ds_read_b128 v[76:79], v103 offset:1024
    ds_read_b128 v[80:83], v103 offset:1536
    ds_read_b128 v[72:75], v100 offset:18432
    v_cvt_pk_bf16_f32 v93, v114, v115
    v_exp_f32 v118, v22
    v_exp_f32 v119, v23
    v_cvt_pk_bf16_f32 v94, v116, v117
    v_exp_f32 v120, v24
    v_exp_f32 v121, v25
    v_cvt_pk_bf16_f32 v95, v118, v119
    v_exp_f32 v122, v26
    v_exp_f32 v123, v27
    v_mfma_f32_32x32x16_bf16 v[48:63], v[84:87], v[92:95], v[48:63]
    v_cvt_pk_bf16_f32 v96, v120, v121
    v_exp_f32 v124, v28
    v_exp_f32 v125, v29
    v_cvt_pk_bf16_f32 v97, v122, v123
    v_exp_f32 v126, v30
    v_exp_f32 v127, v31
    v_cvt_pk_bf16_f32 v98, v124, v125
    s_waitcnt lgkmcnt(0)
    v_mfma_f32_32x32x16_bf16 v[16:31], v[72:75], v[64:67], v[32:47]
    v_exp_f32 v112, v0
    v_exp_f32 v113, v1
    v_cvt_pk_bf16_f32 v99, v126, v127
    v_exp_f32 v114, v2
    v_exp_f32 v115, v3
    v_cvt_pk_bf16_f32 v92, v112, v113
    v_exp_f32 v116, v4
    v_exp_f32 v117, v5
    v_mfma_f32_32x32x16_bf16 v[48:63], v[88:91], v[96:99], v[48:63]
    ds_read_b128 v[84:87], v103 offset:3072
    ds_read_b128 v[88:91], v103 offset:3584
    ds_read_b128 v[68:71], v100 offset:20480
    v_cvt_pk_bf16_f32 v93, v114, v115
    v_exp_f32 v118, v6
    v_exp_f32 v119, v7
    v_cvt_pk_bf16_f32 v94, v116, v117
    v_exp_f32 v120, v8
    v_exp_f32 v121, v9
    v_cvt_pk_bf16_f32 v95, v118, v119
    v_exp_f32 v122, v10
    v_exp_f32 v123, v11
    v_mfma_f32_32x32x16_bf16 v[48:63], v[76:79], v[92:95], v[48:63]
    v_cvt_pk_bf16_f32 v96, v120, v121
    v_exp_f32 v124, v12
    v_exp_f32 v125, v13
    v_cvt_pk_bf16_f32 v97, v122, v123
    v_exp_f32 v126, v14
    v_exp_f32 v127, v15
    v_cvt_pk_bf16_f32 v98, v124, v125
    s_setprio 0
    s_waitcnt lgkmcnt(0)
    v_mfma_f32_32x32x16_bf16 v[0:15], v[68:71], v[64:67], v[32:47]
    v_exp_f32 v112, v16
    v_exp_f32 v113, v17
    v_cvt_pk_bf16_f32 v99, v126, v127
    v_exp_f32 v114, v18
    v_exp_f32 v115, v19
    v_cvt_pk_bf16_f32 v92, v112, v113
    v_exp_f32 v116, v20
    v_exp_f32 v117, v21
    v_mfma_f32_32x32x16_bf16 v[48:63], v[80:83], v[96:99], v[48:63]
    ds_read_b128 v[76:79], v103 offset:5120
    ds_read_b128 v[80:83], v103 offset:5632
    ds_read_b128 v[72:75], v100 offset:22528
    v_cvt_pk_bf16_f32 v93, v114, v115
    v_exp_f32 v118, v22
    v_exp_f32 v119, v23
    v_cvt_pk_bf16_f32 v94, v116, v117
    v_exp_f32 v120, v24
    v_exp_f32 v121, v25
    v_cvt_pk_bf16_f32 v95, v118, v119
    v_exp_f32 v122, v26
    v_exp_f32 v123, v27
    v_mfma_f32_32x32x16_bf16 v[48:63], v[84:87], v[92:95], v[48:63]
    v_cvt_pk_bf16_f32 v96, v120, v121
    v_exp_f32 v124, v28
    v_exp_f32 v125, v29
    v_cvt_pk_bf16_f32 v97, v122, v123
    v_exp_f32 v126, v30
    v_exp_f32 v127, v31
    v_cvt_pk_bf16_f32 v98, v124, v125
    s_waitcnt lgkmcnt(0)
    v_mfma_f32_32x32x16_bf16 v[16:31], v[72:75], v[64:67], v[32:47]
    v_exp_f32 v112, v0
    v_exp_f32 v113, v1
    v_cvt_pk_bf16_f32 v99, v126, v127
    v_exp_f32 v114, v2
    v_exp_f32 v115, v3
    v_cvt_pk_bf16_f32 v92, v112, v113
    v_exp_f32 v116, v4
    v_exp_f32 v117, v5
    v_mfma_f32_32x32x16_bf16 v[48:63], v[88:91], v[96:99], v[48:63]
    ds_read_b128 v[84:87], v103 offset:7168
    ds_read_b128 v[88:91], v103 offset:7680
    ds_read_b128 v[68:71], v100 offset:32768
    v_cvt_pk_bf16_f32 v93, v114, v115
    v_exp_f32 v118, v6
    v_exp_f32 v119, v7
    v_cvt_pk_bf16_f32 v94, v116, v117
    v_exp_f32 v120, v8
    v_exp_f32 v121, v9
    v_cvt_pk_bf16_f32 v95, v118, v119
    v_exp_f32 v122, v10
    v_exp_f32 v123, v11
    v_mfma_f32_32x32x16_bf16 v[48:63], v[76:79], v[92:95], v[48:63]
    v_cvt_pk_bf16_f32 v96, v120, v121
    v_exp_f32 v124, v12
    v_exp_f32 v125, v13
    v_cvt_pk_bf16_f32 v97, v122, v123
    v_exp_f32 v126, v14
    v_exp_f32 v127, v15
    v_cvt_pk_bf16_f32 v98, v124, v125
    s_waitcnt lgkmcnt(0)
    v_mfma_f32_32x32x16_bf16 v[0:15], v[68:71], v[64:67], v[32:47]
    v_exp_f32 v112, v16
    v_exp_f32 v113, v17
    v_cvt_pk_bf16_f32 v99, v126, v127
    v_exp_f32 v114, v18
    v_exp_f32 v115, v19
    v_cvt_pk_bf16_f32 v92, v112, v113
    v_exp_f32 v116, v20
    v_exp_f32 v117, v21
    v_mfma_f32_32x32x16_bf16 v[48:63], v[80:83], v[96:99], v[48:63]
    v_add_u32 v102, v103, v105
    ds_read_b128 v[76:79], v102 offset:1024
    ds_read_b128 v[80:83], v102 offset:1536
    ds_read_b128 v[72:75], v100 offset:34816
    v_cvt_pk_bf16_f32 v93, v114, v115
    v_exp_f32 v118, v22
    v_exp_f32 v119, v23
    v_cvt_pk_bf16_f32 v94, v116, v117
    v_exp_f32 v120, v24
    v_exp_f32 v121, v25
    v_cvt_pk_bf16_f32 v95, v118, v119
    v_exp_f32 v122, v26
    v_exp_f32 v123, v27
    v_mfma_f32_32x32x16_bf16 v[48:63], v[84:87], v[92:95], v[48:63]
    v_cvt_pk_bf16_f32 v96, v120, v121
    v_exp_f32 v124, v28
    v_exp_f32 v125, v29
    v_cvt_pk_bf16_f32 v97, v122, v123
    v_exp_f32 v126, v30
    v_exp_f32 v127, v31
    v_cvt_pk_bf16_f32 v98, v124, v125
    s_barrier
    s_setprio 2
    s_waitcnt lgkmcnt(0)
    v_mfma_f32_32x32x16_bf16 v[16:31], v[72:75], v[64:67], v[32:47]
    v_exp_f32 v112, v0
    v_exp_f32 v113, v1
    v_cvt_pk_bf16_f32 v99, v126, v127
    v_exp_f32 v114, v2
    v_exp_f32 v115, v3
    v_cvt_pk_bf16_f32 v92, v112, v113
    v_exp_f32 v116, v4
    v_exp_f32 v117, v5
    v_mfma_f32_32x32x16_bf16 v[48:63], v[88:91], v[96:99], v[48:63]
    ds_read_b128 v[84:87], v102 offset:3072
    ds_read_b128 v[88:91], v102 offset:3584
    ds_read_b128 v[68:71], v100 offset:36864
    v_cvt_pk_bf16_f32 v93, v114, v115
    v_exp_f32 v118, v6
    v_exp_f32 v119, v7
    v_cvt_pk_bf16_f32 v94, v116, v117
    v_exp_f32 v120, v8
    v_exp_f32 v121, v9
    v_cvt_pk_bf16_f32 v95, v118, v119
    v_exp_f32 v122, v10
    v_exp_f32 v123, v11
    v_mfma_f32_32x32x16_bf16 v[48:63], v[76:79], v[92:95], v[48:63]
    v_cvt_pk_bf16_f32 v96, v120, v121
    v_exp_f32 v124, v12
    v_exp_f32 v125, v13
    v_cvt_pk_bf16_f32 v97, v122, v123
    v_exp_f32 v126, v14
    v_exp_f32 v127, v15
    v_cvt_pk_bf16_f32 v98, v124, v125
    s_waitcnt lgkmcnt(0)
    v_mfma_f32_32x32x16_bf16 v[0:15], v[68:71], v[64:67], v[32:47]
    v_exp_f32 v112, v16
    v_exp_f32 v113, v17
    v_cvt_pk_bf16_f32 v99, v126, v127
    v_exp_f32 v114, v18
    v_exp_f32 v115, v19
    v_cvt_pk_bf16_f32 v92, v112, v113
    v_exp_f32 v116, v20
    v_exp_f32 v117, v21
    v_mfma_f32_32x32x16_bf16 v[48:63], v[80:83], v[96:99], v[48:63]
    ds_read_b128 v[76:79], v102 offset:5120
    ds_read_b128 v[80:83], v102 offset:5632
    ds_read_b128 v[72:75], v100 offset:38912
    v_cvt_pk_bf16_f32 v93, v114, v115
    v_exp_f32 v118, v22
    v_exp_f32 v119, v23
    v_cvt_pk_bf16_f32 v94, v116, v117
    v_exp_f32 v120, v24
    v_exp_f32 v121, v25
    v_cvt_pk_bf16_f32 v95, v118, v119
    v_exp_f32 v122, v26
    v_exp_f32 v123, v27
    v_mfma_f32_32x32x16_bf16 v[48:63], v[84:87], v[92:95], v[48:63]
    v_cvt_pk_bf16_f32 v96, v120, v121
    v_exp_f32 v124, v28
    v_exp_f32 v125, v29
    v_cvt_pk_bf16_f32 v97, v122, v123
    v_exp_f32 v126, v30
    v_exp_f32 v127, v31
    v_cvt_pk_bf16_f32 v98, v124, v125
    s_waitcnt lgkmcnt(0)
    v_mfma_f32_32x32x16_bf16 v[16:31], v[72:75], v[64:67], v[32:47]
    v_exp_f32 v112, v0
    v_exp_f32 v113, v1
    v_cvt_pk_bf16_f32 v99, v126, v127
    v_exp_f32 v114, v2
    v_exp_f32 v115, v3
    v_cvt_pk_bf16_f32 v92, v112, v113
    v_exp_f32 v116, v4
    v_exp_f32 v117, v5
    v_mfma_f32_32x32x16_bf16 v[48:63], v[88:91], v[96:99], v[48:63]
    ds_read_b128 v[84:87], v102 offset:7168
    ds_read_b128 v[88:91], v102 offset:7680
    ds_read_b128 v[68:71], v100 offset:49152
    v_cvt_pk_bf16_f32 v93, v114, v115
    v_exp_f32 v118, v6
    v_exp_f32 v119, v7
    v_cvt_pk_bf16_f32 v94, v116, v117
    v_exp_f32 v120, v8
    v_exp_f32 v121, v9
    v_cvt_pk_bf16_f32 v95, v118, v119
    v_exp_f32 v122, v10
    v_exp_f32 v123, v11
    v_mfma_f32_32x32x16_bf16 v[48:63], v[76:79], v[92:95], v[48:63]
    v_cvt_pk_bf16_f32 v96, v120, v121
    v_exp_f32 v124, v12
    v_exp_f32 v125, v13
    v_cvt_pk_bf16_f32 v97, v122, v123
    v_exp_f32 v126, v14
    v_exp_f32 v127, v15
    v_cvt_pk_bf16_f32 v98, v124, v125
    s_waitcnt lgkmcnt(0)
    v_mfma_f32_32x32x16_bf16 v[0:15], v[68:71], v[64:67], v[32:47]
    v_exp_f32 v112, v16
    v_exp_f32 v113, v17
    v_cvt_pk_bf16_f32 v99, v126, v127
    v_exp_f32 v114, v18
    v_exp_f32 v115, v19
    v_cvt_pk_bf16_f32 v92, v112, v113
    v_exp_f32 v116, v20
    v_exp_f32 v117, v21
    v_mfma_f32_32x32x16_bf16 v[48:63], v[80:83], v[96:99], v[48:63]
    v_add_u32 v103, v102, v105
    ds_read_b128 v[76:79], v103 offset:1024
    ds_read_b128 v[80:83], v103 offset:1536
    ds_read_b128 v[72:75], v100 offset:51200
    v_cvt_pk_bf16_f32 v93, v114, v115
    v_exp_f32 v118, v22
    v_exp_f32 v119, v23
    v_cvt_pk_bf16_f32 v94, v116, v117
    v_exp_f32 v120, v24
    v_exp_f32 v121, v25
    v_cvt_pk_bf16_f32 v95, v118, v119
    v_exp_f32 v122, v26
    v_exp_f32 v123, v27
    v_mfma_f32_32x32x16_bf16 v[48:63], v[84:87], v[92:95], v[48:63]
    v_cvt_pk_bf16_f32 v96, v120, v121
    v_exp_f32 v124, v28
    v_exp_f32 v125, v29
    v_cvt_pk_bf16_f32 v97, v122, v123
    v_exp_f32 v126, v30
    v_exp_f32 v127, v31
    v_cvt_pk_bf16_f32 v98, v124, v125
    s_waitcnt lgkmcnt(0)
    v_mfma_f32_32x32x16_bf16 v[16:31], v[72:75], v[64:67], v[32:47]
    v_exp_f32 v112, v0
    v_exp_f32 v113, v1
    v_cvt_pk_bf16_f32 v99, v126, v127
    v_exp_f32 v114, v2
    v_exp_f32 v115, v3
    v_cvt_pk_bf16_f32 v92, v112, v113
    v_exp_f32 v116, v4
    v_exp_f32 v117, v5
    v_mfma_f32_32x32x16_bf16 v[48:63], v[88:91], v[96:99], v[48:63]
    ds_read_b128 v[84:87], v103 offset:3072
    ds_read_b128 v[88:91], v103 offset:3584
    ds_read_b128 v[68:71], v100 offset:53248
    v_cvt_pk_bf16_f32 v93, v114, v115
    v_exp_f32 v118, v6
    v_exp_f32 v119, v7
    v_cvt_pk_bf16_f32 v94, v116, v117
    v_exp_f32 v120, v8
    v_exp_f32 v121, v9
    v_cvt_pk_bf16_f32 v95, v118, v119
    v_exp_f32 v122, v10
    v_exp_f32 v123, v11
    v_mfma_f32_32x32x16_bf16 v[48:63], v[76:79], v[92:95], v[48:63]
    v_cvt_pk_bf16_f32 v96, v120, v121
    v_exp_f32 v124, v12
    v_exp_f32 v125, v13
    v_cvt_pk_bf16_f32 v97, v122, v123
    v_exp_f32 v126, v14
    v_exp_f32 v127, v15
    v_cvt_pk_bf16_f32 v98, v124, v125
    s_setprio 0
    s_waitcnt lgkmcnt(0)
    v_mfma_f32_32x32x16_bf16 v[0:15], v[68:71], v[64:67], v[32:47]
    v_exp_f32 v112, v16
    v_exp_f32 v113, v17
    v_cvt_pk_bf16_f32 v99, v126, v127
    v_exp_f32 v114, v18
    v_exp_f32 v115, v19
    v_cvt_pk_bf16_f32 v92, v112, v113
    v_exp_f32 v116, v20
    v_exp_f32 v117, v21
    v_mfma_f32_32x32x16_bf16 v[48:63], v[80:83], v[96:99], v[48:63]
    ds_read_b128 v[76:79], v103 offset:5120
    ds_read_b128 v[80:83], v103 offset:5632
    ds_read_b128 v[72:75], v100 offset:55296
    v_cvt_pk_bf16_f32 v93, v114, v115
    v_exp_f32 v118, v22
    v_exp_f32 v119, v23
    v_cvt_pk_bf16_f32 v94, v116, v117
    v_exp_f32 v120, v24
    v_exp_f32 v121, v25
    v_cvt_pk_bf16_f32 v95, v118, v119
    v_exp_f32 v122, v26
    v_exp_f32 v123, v27
    v_mfma_f32_32x32x16_bf16 v[48:63], v[84:87], v[92:95], v[48:63]
    v_cvt_pk_bf16_f32 v96, v120, v121
    v_exp_f32 v124, v28
    v_exp_f32 v125, v29
    v_cvt_pk_bf16_f32 v97, v122, v123
    v_exp_f32 v126, v30
    v_exp_f32 v127, v31
    v_cvt_pk_bf16_f32 v98, v124, v125
    s_waitcnt lgkmcnt(0)
    v_mfma_f32_32x32x16_bf16 v[16:31], v[72:75], v[64:67], v[32:47]
    v_exp_f32 v112, v0
    v_exp_f32 v113, v1
    v_cvt_pk_bf16_f32 v99, v126, v127
    v_exp_f32 v114, v2
    v_exp_f32 v115, v3
    v_cvt_pk_bf16_f32 v92, v112, v113
    v_exp_f32 v116, v4
    v_exp_f32 v117, v5
    v_mfma_f32_32x32x16_bf16 v[48:63], v[88:91], v[96:99], v[48:63]
    ds_read_b128 v[84:87], v103 offset:7168
    ds_read_b128 v[88:91], v103 offset:7680
    ds_read_b128 v[68:71], v101 offset:0
    v_cvt_pk_bf16_f32 v93, v114, v115
    v_exp_f32 v118, v6
    v_exp_f32 v119, v7
    v_cvt_pk_bf16_f32 v94, v116, v117
    v_exp_f32 v120, v8
    v_exp_f32 v121, v9
    v_cvt_pk_bf16_f32 v95, v118, v119
    v_exp_f32 v122, v10
    v_exp_f32 v123, v11
    v_mfma_f32_32x32x16_bf16 v[48:63], v[76:79], v[92:95], v[48:63]
    v_cvt_pk_bf16_f32 v96, v120, v121
    v_exp_f32 v124, v12
    v_exp_f32 v125, v13
    v_cvt_pk_bf16_f32 v97, v122, v123
    v_exp_f32 v126, v14
    v_exp_f32 v127, v15
    v_cvt_pk_bf16_f32 v98, v124, v125
    s_waitcnt lgkmcnt(0)
    v_mfma_f32_32x32x16_bf16 v[0:15], v[68:71], v[64:67], v[32:47]
    v_exp_f32 v112, v16
    v_exp_f32 v113, v17
    v_cvt_pk_bf16_f32 v99, v126, v127
    v_exp_f32 v114, v18
    v_exp_f32 v115, v19
    v_cvt_pk_bf16_f32 v92, v112, v113
    v_exp_f32 v116, v20
    v_exp_f32 v117, v21
    v_mfma_f32_32x32x16_bf16 v[48:63], v[80:83], v[96:99], v[48:63]
    v_add_u32 v102, v103, v105
    ds_read_b128 v[76:79], v102 offset:1024
    ds_read_b128 v[80:83], v102 offset:1536
    ds_read_b128 v[72:75], v101 offset:2048
    v_cvt_pk_bf16_f32 v93, v114, v115
    v_exp_f32 v118, v22
    v_exp_f32 v119, v23
    v_cvt_pk_bf16_f32 v94, v116, v117
    v_exp_f32 v120, v24
    v_exp_f32 v121, v25
    v_cvt_pk_bf16_f32 v95, v118, v119
    v_exp_f32 v122, v26
    v_exp_f32 v123, v27
    v_mfma_f32_32x32x16_bf16 v[48:63], v[84:87], v[92:95], v[48:63]
    v_cvt_pk_bf16_f32 v96, v120, v121
    v_exp_f32 v124, v28
    v_exp_f32 v125, v29
    v_cvt_pk_bf16_f32 v97, v122, v123
    v_exp_f32 v126, v30
    v_exp_f32 v127, v31
    v_cvt_pk_bf16_f32 v98, v124, v125
    s_barrier
    s_setprio 2
    s_waitcnt lgkmcnt(0)
    v_mfma_f32_32x32x16_bf16 v[16:31], v[72:75], v[64:67], v[32:47]
    v_exp_f32 v112, v0
    v_exp_f32 v113, v1
    v_cvt_pk_bf16_f32 v99, v126, v127
    v_exp_f32 v114, v2
    v_exp_f32 v115, v3
    v_cvt_pk_bf16_f32 v92, v112, v113
    v_exp_f32 v116, v4
    v_exp_f32 v117, v5
    v_mfma_f32_32x32x16_bf16 v[48:63], v[88:91], v[96:99], v[48:63]
    ds_read_b128 v[84:87], v102 offset:3072
    ds_read_b128 v[88:91], v102 offset:3584
    ds_read_b128 v[68:71], v101 offset:4096
    v_cvt_pk_bf16_f32 v93, v114, v115
    v_exp_f32 v118, v6
    v_exp_f32 v119, v7
    v_cvt_pk_bf16_f32 v94, v116, v117
    v_exp_f32 v120, v8
    v_exp_f32 v121, v9
    v_cvt_pk_bf16_f32 v95, v118, v119
    v_exp_f32 v122, v10
    v_exp_f32 v123, v11
    v_mfma_f32_32x32x16_bf16 v[48:63], v[76:79], v[92:95], v[48:63]
    v_cvt_pk_bf16_f32 v96, v120, v121
    v_exp_f32 v124, v12
    v_exp_f32 v125, v13
    v_cvt_pk_bf16_f32 v97, v122, v123
    v_exp_f32 v126, v14
    v_exp_f32 v127, v15
    v_cvt_pk_bf16_f32 v98, v124, v125
    s_waitcnt lgkmcnt(0)
    v_mfma_f32_32x32x16_bf16 v[0:15], v[68:71], v[64:67], v[32:47]
    v_exp_f32 v112, v16
    v_exp_f32 v113, v17
    v_cvt_pk_bf16_f32 v99, v126, v127
    v_exp_f32 v114, v18
    v_exp_f32 v115, v19
    v_cvt_pk_bf16_f32 v92, v112, v113
    v_exp_f32 v116, v20
    v_exp_f32 v117, v21
    v_mfma_f32_32x32x16_bf16 v[48:63], v[80:83], v[96:99], v[48:63]
    ds_read_b128 v[76:79], v102 offset:5120
    ds_read_b128 v[80:83], v102 offset:5632
    ds_read_b128 v[72:75], v101 offset:6144
    v_cvt_pk_bf16_f32 v93, v114, v115
    v_exp_f32 v118, v22
    v_exp_f32 v119, v23
    v_cvt_pk_bf16_f32 v94, v116, v117
    v_exp_f32 v120, v24
    v_exp_f32 v121, v25
    v_cvt_pk_bf16_f32 v95, v118, v119
    v_exp_f32 v122, v26
    v_exp_f32 v123, v27
    v_mfma_f32_32x32x16_bf16 v[48:63], v[84:87], v[92:95], v[48:63]
    v_cvt_pk_bf16_f32 v96, v120, v121
    v_exp_f32 v124, v28
    v_exp_f32 v125, v29
    v_cvt_pk_bf16_f32 v97, v122, v123
    v_exp_f32 v126, v30
    v_exp_f32 v127, v31
    v_cvt_pk_bf16_f32 v98, v124, v125
    s_waitcnt lgkmcnt(0)
    v_mfma_f32_32x32x16_bf16 v[16:31], v[72:75], v[64:67], v[32:47]
    v_exp_f32 v112, v0
    v_exp_f32 v113, v1
    v_cvt_pk_bf16_f32 v99, v126, v127
    v_exp_f32 v114, v2
    v_exp_f32 v115, v3
    v_cvt_pk_bf16_f32 v92, v112, v113
    v_exp_f32 v116, v4
    v_exp_f32 v117, v5
    v_mfma_f32_32x32x16_bf16 v[48:63], v[88:91], v[96:99], v[48:63]
    ds_read_b128 v[84:87], v102 offset:7168
    ds_read_b128 v[88:91], v102 offset:7680
    ds_read_b128 v[68:71], v101 offset:16384
    v_cvt_pk_bf16_f32 v93, v114, v115
    v_exp_f32 v118, v6
    v_exp_f32 v119, v7
    v_cvt_pk_bf16_f32 v94, v116, v117
    v_exp_f32 v120, v8
    v_exp_f32 v121, v9
    v_cvt_pk_bf16_f32 v95, v118, v119
    v_exp_f32 v122, v10
    v_exp_f32 v123, v11
    v_mfma_f32_32x32x16_bf16 v[48:63], v[76:79], v[92:95], v[48:63]
    v_cvt_pk_bf16_f32 v96, v120, v121
    v_exp_f32 v124, v12
    v_exp_f32 v125, v13
    v_cvt_pk_bf16_f32 v97, v122, v123
    v_exp_f32 v126, v14
    v_exp_f32 v127, v15
    v_cvt_pk_bf16_f32 v98, v124, v125
    s_waitcnt lgkmcnt(0)
    v_mfma_f32_32x32x16_bf16 v[0:15], v[68:71], v[64:67], v[32:47]
    v_exp_f32 v112, v16
    v_exp_f32 v113, v17
    v_cvt_pk_bf16_f32 v99, v126, v127
    v_exp_f32 v114, v18
    v_exp_f32 v115, v19
    v_cvt_pk_bf16_f32 v92, v112, v113
    v_exp_f32 v116, v20
    v_exp_f32 v117, v21
    v_mfma_f32_32x32x16_bf16 v[48:63], v[80:83], v[96:99], v[48:63]
    v_add_u32 v103, v102, v105
    ds_read_b128 v[76:79], v103 offset:1024
    ds_read_b128 v[80:83], v103 offset:1536
    ds_read_b128 v[72:75], v101 offset:18432
    v_cvt_pk_bf16_f32 v93, v114, v115
    v_exp_f32 v118, v22
    v_exp_f32 v119, v23
    v_cvt_pk_bf16_f32 v94, v116, v117
    v_exp_f32 v120, v24
    v_exp_f32 v121, v25
    v_cvt_pk_bf16_f32 v95, v118, v119
    v_exp_f32 v122, v26
    v_exp_f32 v123, v27
    v_mfma_f32_32x32x16_bf16 v[48:63], v[84:87], v[92:95], v[48:63]
    v_cvt_pk_bf16_f32 v96, v120, v121
    v_exp_f32 v124, v28
    v_exp_f32 v125, v29
    v_cvt_pk_bf16_f32 v97, v122, v123
    v_exp_f32 v126, v30
    v_exp_f32 v127, v31
    v_cvt_pk_bf16_f32 v98, v124, v125
    s_waitcnt lgkmcnt(0)
    v_mfma_f32_32x32x16_bf16 v[16:31], v[72:75], v[64:67], v[32:47]
    v_exp_f32 v112, v0
    v_exp_f32 v113, v1
    v_cvt_pk_bf16_f32 v99, v126, v127
    v_exp_f32 v114, v2
    v_exp_f32 v115, v3
    v_cvt_pk_bf16_f32 v92, v112, v113
    v_exp_f32 v116, v4
    v_exp_f32 v117, v5
    v_mfma_f32_32x32x16_bf16 v[48:63], v[88:91], v[96:99], v[48:63]
    ds_read_b128 v[84:87], v103 offset:3072
    ds_read_b128 v[88:91], v103 offset:3584
    ds_read_b128 v[68:71], v101 offset:20480
    v_cvt_pk_bf16_f32 v93, v114, v115
    v_exp_f32 v118, v6
    v_exp_f32 v119, v7
    v_cvt_pk_bf16_f32 v94, v116, v117
    v_exp_f32 v120, v8
    v_exp_f32 v121, v9
    v_cvt_pk_bf16_f32 v95, v118, v119
    v_exp_f32 v122, v10
    v_exp_f32 v123, v11
    v_mfma_f32_32x32x16_bf16 v[48:63], v[76:79], v[92:95], v[48:63]
    v_cvt_pk_bf16_f32 v96, v120, v121
    v_exp_f32 v124, v12
    v_exp_f32 v125, v13
    v_cvt_pk_bf16_f32 v97, v122, v123
    v_exp_f32 v126, v14
    v_exp_f32 v127, v15
    v_cvt_pk_bf16_f32 v98, v124, v125
    s_setprio 0
    s_waitcnt lgkmcnt(0)
    v_mfma_f32_32x32x16_bf16 v[0:15], v[68:71], v[64:67], v[32:47]
    v_exp_f32 v112, v16
    v_exp_f32 v113, v17
    v_cvt_pk_bf16_f32 v99, v126, v127
    v_exp_f32 v114, v18
    v_exp_f32 v115, v19
    v_cvt_pk_bf16_f32 v92, v112, v113
    v_exp_f32 v116, v20
    v_exp_f32 v117, v21
    v_mfma_f32_32x32x16_bf16 v[48:63], v[80:83], v[96:99], v[48:63]
    ds_read_b128 v[76:79], v103 offset:5120
    ds_read_b128 v[80:83], v103 offset:5632
    ds_read_b128 v[72:75], v101 offset:22528
    v_cvt_pk_bf16_f32 v93, v114, v115
    v_exp_f32 v118, v22
    v_exp_f32 v119, v23
    v_cvt_pk_bf16_f32 v94, v116, v117
    v_exp_f32 v120, v24
    v_exp_f32 v121, v25
    v_cvt_pk_bf16_f32 v95, v118, v119
    v_exp_f32 v122, v26
    v_exp_f32 v123, v27
    v_mfma_f32_32x32x16_bf16 v[48:63], v[84:87], v[92:95], v[48:63]
    v_cvt_pk_bf16_f32 v96, v120, v121
    v_exp_f32 v124, v28
    v_exp_f32 v125, v29
    v_cvt_pk_bf16_f32 v97, v122, v123
    v_exp_f32 v126, v30
    v_exp_f32 v127, v31
    v_cvt_pk_bf16_f32 v98, v124, v125
    s_waitcnt lgkmcnt(0)
    v_mfma_f32_32x32x16_bf16 v[16:31], v[72:75], v[64:67], v[32:47]
    v_exp_f32 v112, v0
    v_exp_f32 v113, v1
    v_cvt_pk_bf16_f32 v99, v126, v127
    v_exp_f32 v114, v2
    v_exp_f32 v115, v3
    v_cvt_pk_bf16_f32 v92, v112, v113
    v_exp_f32 v116, v4
    v_exp_f32 v117, v5
    v_mfma_f32_32x32x16_bf16 v[48:63], v[88:91], v[96:99], v[48:63]
    ds_read_b128 v[84:87], v103 offset:7168
    ds_read_b128 v[88:91], v103 offset:7680
    ds_read_b128 v[68:71], v101 offset:32768
    v_cvt_pk_bf16_f32 v93, v114, v115
    v_exp_f32 v118, v6
    v_exp_f32 v119, v7
    v_cvt_pk_bf16_f32 v94, v116, v117
    v_exp_f32 v120, v8
    v_exp_f32 v121, v9
    v_cvt_pk_bf16_f32 v95, v118, v119
    v_exp_f32 v122, v10
    v_exp_f32 v123, v11
    v_mfma_f32_32x32x16_bf16 v[48:63], v[76:79], v[92:95], v[48:63]
    v_cvt_pk_bf16_f32 v96, v120, v121
    v_exp_f32 v124, v12
    v_exp_f32 v125, v13
    v_cvt_pk_bf16_f32 v97, v122, v123
    v_exp_f32 v126, v14
    v_exp_f32 v127, v15
    v_cvt_pk_bf16_f32 v98, v124, v125
    s_waitcnt lgkmcnt(0)
    v_mfma_f32_32x32x16_bf16 v[0:15], v[68:71], v[64:67], v[32:47]
    v_exp_f32 v112, v16
    v_exp_f32 v113, v17
    v_cvt_pk_bf16_f32 v99, v126, v127
    v_exp_f32 v114, v18
    v_exp_f32 v115, v19
    v_cvt_pk_bf16_f32 v92, v112, v113
    v_exp_f32 v116, v20
    v_exp_f32 v117, v21
    v_mfma_f32_32x32x16_bf16 v[48:63], v[80:83], v[96:99], v[48:63]
    v_add_u32 v102, v103, v105
    ds_read_b128 v[76:79], v102 offset:1024
    ds_read_b128 v[80:83], v102 offset:1536
    ds_read_b128 v[72:75], v101 offset:34816
    v_cvt_pk_bf16_f32 v93, v114, v115
    v_exp_f32 v118, v22
    v_exp_f32 v119, v23
    v_cvt_pk_bf16_f32 v94, v116, v117
    v_exp_f32 v120, v24
    v_exp_f32 v121, v25
    v_cvt_pk_bf16_f32 v95, v118, v119
    v_exp_f32 v122, v26
    v_exp_f32 v123, v27
    v_mfma_f32_32x32x16_bf16 v[48:63], v[84:87], v[92:95], v[48:63]
    v_cvt_pk_bf16_f32 v96, v120, v121
    v_exp_f32 v124, v28
    v_exp_f32 v125, v29
    v_cvt_pk_bf16_f32 v97, v122, v123
    v_exp_f32 v126, v30
    v_exp_f32 v127, v31
    v_cvt_pk_bf16_f32 v98, v124, v125
    s_barrier
    s_setprio 2
    s_waitcnt lgkmcnt(0)
    v_mfma_f32_32x32x16_bf16 v[16:31], v[72:75], v[64:67], v[32:47]
    v_exp_f32 v112, v0
    v_exp_f32 v113, v1
    v_cvt_pk_bf16_f32 v99, v126, v127
    v_exp_f32 v114, v2
    v_exp_f32 v115, v3
    v_cvt_pk_bf16_f32 v92, v112, v113
    v_exp_f32 v116, v4
    v_exp_f32 v117, v5
    v_mfma_f32_32x32x16_bf16 v[48:63], v[88:91], v[96:99], v[48:63]
    ds_read_b128 v[84:87], v102 offset:3072
    ds_read_b128 v[88:91], v102 offset:3584
    ds_read_b128 v[68:71], v101 offset:36864
    v_cvt_pk_bf16_f32 v93, v114, v115
    v_exp_f32 v118, v6
    v_exp_f32 v119, v7
    v_cvt_pk_bf16_f32 v94, v116, v117
    v_exp_f32 v120, v8
    v_exp_f32 v121, v9
    v_cvt_pk_bf16_f32 v95, v118, v119
    v_exp_f32 v122, v10
    v_exp_f32 v123, v11
    v_mfma_f32_32x32x16_bf16 v[48:63], v[76:79], v[92:95], v[48:63]
    v_cvt_pk_bf16_f32 v96, v120, v121
    v_exp_f32 v124, v12
    v_exp_f32 v125, v13
    v_cvt_pk_bf16_f32 v97, v122, v123
    v_exp_f32 v126, v14
    v_exp_f32 v127, v15
    v_cvt_pk_bf16_f32 v98, v124, v125
    s_waitcnt lgkmcnt(0)
    v_mfma_f32_32x32x16_bf16 v[0:15], v[68:71], v[64:67], v[32:47]
    v_exp_f32 v112, v16
    v_exp_f32 v113, v17
    v_cvt_pk_bf16_f32 v99, v126, v127
    v_exp_f32 v114, v18
    v_exp_f32 v115, v19
    v_cvt_pk_bf16_f32 v92, v112, v113
    v_exp_f32 v116, v20
    v_exp_f32 v117, v21
    v_mfma_f32_32x32x16_bf16 v[48:63], v[80:83], v[96:99], v[48:63]
    ds_read_b128 v[76:79], v102 offset:5120
    ds_read_b128 v[80:83], v102 offset:5632
    ds_read_b128 v[72:75], v101 offset:38912
    v_cvt_pk_bf16_f32 v93, v114, v115
    v_exp_f32 v118, v22
    v_exp_f32 v119, v23
    v_cvt_pk_bf16_f32 v94, v116, v117
    v_exp_f32 v120, v24
    v_exp_f32 v121, v25
    v_cvt_pk_bf16_f32 v95, v118, v119
    v_exp_f32 v122, v26
    v_exp_f32 v123, v27
    v_mfma_f32_32x32x16_bf16 v[48:63], v[84:87], v[92:95], v[48:63]
    v_cvt_pk_bf16_f32 v96, v120, v121
    v_exp_f32 v124, v28
    v_exp_f32 v125, v29
    v_cvt_pk_bf16_f32 v97, v122, v123
    v_exp_f32 v126, v30
    v_exp_f32 v127, v31
    v_cvt_pk_bf16_f32 v98, v124, v125
    s_waitcnt lgkmcnt(0)
    v_mfma_f32_32x32x16_bf16 v[16:31], v[72:75], v[64:67], v[32:47]
    v_exp_f32 v112, v0
    v_exp_f32 v113, v1
    v_cvt_pk_bf16_f32 v99, v126, v127
    v_exp_f32 v114, v2
    v_exp_f32 v115, v3
    v_cvt_pk_bf16_f32 v92, v112, v113
    v_exp_f32 v116, v4
    v_exp_f32 v117, v5
    v_mfma_f32_32x32x16_bf16 v[48:63], v[88:91], v[96:99], v[48:63]
    ds_read_b128 v[84:87], v102 offset:7168
    ds_read_b128 v[88:91], v102 offset:7680
    ds_read_b128 v[68:71], v101 offset:49152
    v_cvt_pk_bf16_f32 v93, v114, v115
    v_exp_f32 v118, v6
    v_exp_f32 v119, v7
    v_cvt_pk_bf16_f32 v94, v116, v117
    v_exp_f32 v120, v8
    v_exp_f32 v121, v9
    v_cvt_pk_bf16_f32 v95, v118, v119
    v_exp_f32 v122, v10
    v_exp_f32 v123, v11
    v_mfma_f32_32x32x16_bf16 v[48:63], v[76:79], v[92:95], v[48:63]
    v_cvt_pk_bf16_f32 v96, v120, v121
    v_exp_f32 v124, v12
    v_exp_f32 v125, v13
    v_cvt_pk_bf16_f32 v97, v122, v123
    v_exp_f32 v126, v14
    v_exp_f32 v127, v15
    v_cvt_pk_bf16_f32 v98, v124, v125
    s_waitcnt lgkmcnt(0)
    v_mfma_f32_32x32x16_bf16 v[0:15], v[68:71], v[64:67], v[32:47]
    v_exp_f32 v112, v16
    v_exp_f32 v113, v17
    v_cvt_pk_bf16_f32 v99, v126, v127
    v_exp_f32 v114, v18
    v_exp_f32 v115, v19
    v_cvt_pk_bf16_f32 v92, v112, v113
    v_exp_f32 v116, v20
    v_exp_f32 v117, v21
    v_mfma_f32_32x32x16_bf16 v[48:63], v[80:83], v[96:99], v[48:63]
    v_add_u32 v103, v102, v105
    ds_read_b128 v[76:79], v103 offset:1024
    ds_read_b128 v[80:83], v103 offset:1536
    ds_read_b128 v[72:75], v101 offset:51200
    v_cvt_pk_bf16_f32 v93, v114, v115
    v_exp_f32 v118, v22
    v_exp_f32 v119, v23
    v_cvt_pk_bf16_f32 v94, v116, v117
    v_exp_f32 v120, v24
    v_exp_f32 v121, v25
    v_cvt_pk_bf16_f32 v95, v118, v119
    v_exp_f32 v122, v26
    v_exp_f32 v123, v27
    v_mfma_f32_32x32x16_bf16 v[48:63], v[84:87], v[92:95], v[48:63]
    v_cvt_pk_bf16_f32 v96, v120, v121
    v_exp_f32 v124, v28
    v_exp_f32 v125, v29
    v_cvt_pk_bf16_f32 v97, v122, v123
    v_exp_f32 v126, v30
    v_exp_f32 v127, v31
    v_cvt_pk_bf16_f32 v98, v124, v125
    s_waitcnt lgkmcnt(0)
    v_mfma_f32_32x32x16_bf16 v[16:31], v[72:75], v[64:67], v[32:47]
    v_exp_f32 v112, v0
    v_exp_f32 v113, v1
    v_cvt_pk_bf16_f32 v99, v126, v127
    v_exp_f32 v114, v2
    v_exp_f32 v115, v3
    v_cvt_pk_bf16_f32 v92, v112, v113
    v_exp_f32 v116, v4
    v_exp_f32 v117, v5
    v_mfma_f32_32x32x16_bf16 v[48:63], v[88:91], v[96:99], v[48:63]
    ds_read_b128 v[84:87], v103 offset:3072
    ds_read_b128 v[88:91], v103 offset:3584
    ds_read_b128 v[68:71], v101 offset:53248
    v_cvt_pk_bf16_f32 v93, v114, v115
    v_exp_f32 v118, v6
    v_exp_f32 v119, v7
    v_cvt_pk_bf16_f32 v94, v116, v117
    v_exp_f32 v120, v8
    v_exp_f32 v121, v9
    v_cvt_pk_bf16_f32 v95, v118, v119
    v_exp_f32 v122, v10
    v_exp_f32 v123, v11
    v_mfma_f32_32x32x16_bf16 v[48:63], v[76:79], v[92:95], v[48:63]
    v_cvt_pk_bf16_f32 v96, v120, v121
    v_exp_f32 v124, v12
    v_exp_f32 v125, v13
    v_cvt_pk_bf16_f32 v97, v122, v123
    v_exp_f32 v126, v14
    v_exp_f32 v127, v15
    v_cvt_pk_bf16_f32 v98, v124, v125
    s_setprio 0
    s_waitcnt lgkmcnt(0)
    v_mfma_f32_32x32x16_bf16 v[0:15], v[68:71], v[64:67], v[32:47]
    v_exp_f32 v112, v16
    v_exp_f32 v113, v17
    v_cvt_pk_bf16_f32 v99, v126, v127
    v_exp_f32 v114, v18
    v_exp_f32 v115, v19
    v_cvt_pk_bf16_f32 v92, v112, v113
    v_exp_f32 v116, v20
    v_exp_f32 v117, v21
    v_mfma_f32_32x32x16_bf16 v[48:63], v[80:83], v[96:99], v[48:63]
    ds_read_b128 v[76:79], v103 offset:5120
    ds_read_b128 v[80:83], v103 offset:5632
    ds_read_b128 v[72:75], v101 offset:55296
    v_cvt_pk_bf16_f32 v93, v114, v115
    v_exp_f32 v118, v22
    v_exp_f32 v119, v23
    v_cvt_pk_bf16_f32 v94, v116, v117
    v_exp_f32 v120, v24
    v_exp_f32 v121, v25
    v_cvt_pk_bf16_f32 v95, v118, v119
    v_exp_f32 v122, v26
    v_exp_f32 v123, v27
    v_mfma_f32_32x32x16_bf16 v[48:63], v[84:87], v[92:95], v[48:63]
    v_cvt_pk_bf16_f32 v96, v120, v121
    v_exp_f32 v124, v28
    v_exp_f32 v125, v29
    v_cvt_pk_bf16_f32 v97, v122, v123
    v_exp_f32 v126, v30
    v_exp_f32 v127, v31
    v_cvt_pk_bf16_f32 v98, v124, v125
    s_waitcnt lgkmcnt(0)
    v_mfma_f32_32x32x16_bf16 v[16:31], v[72:75], v[64:67], v[32:47]
    v_exp_f32 v112, v0
    v_exp_f32 v113, v1
    v_cvt_pk_bf16_f32 v99, v126, v127
    v_exp_f32 v114, v2
    v_exp_f32 v115, v3
    v_cvt_pk_bf16_f32 v92, v112, v113
    v_exp_f32 v116, v4
    v_exp_f32 v117, v5
    v_mfma_f32_32x32x16_bf16 v[48:63], v[88:91], v[96:99], v[48:63]
    ds_read_b128 v[84:87], v103 offset:7168
    ds_read_b128 v[88:91], v103 offset:7680
    v_cvt_pk_bf16_f32 v93, v114, v115
    v_exp_f32 v118, v6
    v_exp_f32 v119, v7
    v_cvt_pk_bf16_f32 v94, v116, v117
    v_exp_f32 v120, v8
    v_exp_f32 v121, v9
    v_cvt_pk_bf16_f32 v95, v118, v119
    v_exp_f32 v122, v10
    v_exp_f32 v123, v11
    v_mfma_f32_32x32x16_bf16 v[48:63], v[76:79], v[92:95], v[48:63]
    v_cvt_pk_bf16_f32 v96, v120, v121
    v_exp_f32 v124, v12
    v_exp_f32 v125, v13
    v_cvt_pk_bf16_f32 v97, v122, v123
    v_exp_f32 v126, v14
    v_exp_f32 v127, v15
    v_cvt_pk_bf16_f32 v98, v124, v125
    s_waitcnt lgkmcnt(0)
    v_exp_f32 v112, v16
    v_exp_f32 v113, v17
    v_cvt_pk_bf16_f32 v99, v126, v127
    v_exp_f32 v114, v18
    v_exp_f32 v115, v19
    v_cvt_pk_bf16_f32 v92, v112, v113
    v_exp_f32 v116, v20
    v_exp_f32 v117, v21
    v_mfma_f32_32x32x16_bf16 v[48:63], v[80:83], v[96:99], v[48:63]
    v_cvt_pk_bf16_f32 v93, v114, v115
    v_exp_f32 v118, v22
    v_exp_f32 v119, v23
    v_cvt_pk_bf16_f32 v94, v116, v117
    v_exp_f32 v120, v24
    v_exp_f32 v121, v25
    v_cvt_pk_bf16_f32 v95, v118, v119
    v_exp_f32 v122, v26
    v_exp_f32 v123, v27
    v_mfma_f32_32x32x16_bf16 v[48:63], v[84:87], v[92:95], v[48:63]
    v_cvt_pk_bf16_f32 v96, v120, v121
    v_exp_f32 v124, v28
    v_exp_f32 v125, v29
    v_cvt_pk_bf16_f32 v97, v122, v123
    v_exp_f32 v126, v30
    v_exp_f32 v127, v31
    v_cvt_pk_bf16_f32 v98, v124, v125
    s_branch P2_end_22
P2_end_22:
    s_setprio 0
    v_cvt_pk_bf16_f32 v99, v126, v127
    s_nop 1
    v_mfma_f32_32x32x16_bf16 v[48:63], v[88:91], v[96:99], v[48:63]
    s_nop 11
    v_mov_b32 v108, v56
    v_mov_b32 v112, v56
    s_nop 1
    v_permlane32_swap_b32 v108, v112
    v_and_b32 v114, 0x7fffffff, v48
    v_and_b32 v115, 0x7fffffff, v49
    v_max_u32 v114, v114, v115
    v_and_b32 v115, 0x7fffffff, v50
    v_max_u32 v114, v114, v115
    v_and_b32 v115, 0x7fffffff, v51
    v_max_u32 v114, v114, v115
    v_and_b32 v115, 0x7fffffff, v52
    v_max_u32 v114, v114, v115
    v_and_b32 v115, 0x7fffffff, v53
    v_max_u32 v114, v114, v115
    v_and_b32 v115, 0x7fffffff, v54
    v_max_u32 v114, v114, v115
    v_and_b32 v115, 0x7fffffff, v55
    v_max_u32 v114, v114, v115
    v_cmp_le_u32 vcc, 0x7f800000, v114
    s_nop 2
    s_mov_b64 s[66:67], vcc
    v_mov_b32 v115, 0x71800000
    v_cmp_nlt_f32 vcc, v108, v115
    s_nop 2
    s_or_b64 s[66:67], s[66:67], vcc
    s_cmp_eq_u64 s[66:67], 0
    s_cbranch_scc1 sm_ok_23
    s_lshl_b32 s56, s44, 13
    v_add_u32 v100, s56, v107
    v_mov_b32 v108, 0xff800000
    s_mov_b32 s64, 0
slow_max_24:
    s_lshr_b32 s56, s64, 2
    s_lshl_b32 s56, s56, 15
    s_and_b32 s57, s64, 3
    s_lshl_b32 s57, s57, 11
    s_add_u32 s56, s56, s57
    buffer_load_dwordx4 v[68:71], v100, s[32:35], s56 offen sc1
    s_waitcnt vmcnt(0)
    v_mfma_f32_32x32x16_bf16 v[0:15], v[68:71], v[64:67], 0
    s_nop 11
    v_max3_f32 v108, v108, v0, v1
    v_max3_f32 v108, v108, v2, v3
    v_max3_f32 v108, v108, v4, v5
    v_max3_f32 v108, v108, v6, v7
    v_max3_f32 v108, v108, v8, v9
    v_max3_f32 v108, v108, v10, v11
    v_max3_f32 v108, v108, v12, v13
    v_max3_f32 v108, v108, v14, v15
    s_add_u32 s64, s64, 1
    s_cmp_lt_u32 s64, 64
    s_cbranch_scc1 slow_max_24
    v_mov_b32 v112, v108
    s_nop 1
    v_permlane32_swap_b32 v108, v112
    v_max_f32 v108, v108, v112
    v_sub_f32 v32, 0, v108
    v_sub_f32 v33, 0, v108
    v_sub_f32 v34, 0, v108
    v_sub_f32 v35, 0, v108
    v_sub_f32 v36, 0, v108
    v_sub_f32 v37, 0, v108
    v_sub_f32 v38, 0, v108
    v_sub_f32 v39, 0, v108
    v_sub_f32 v40, 0, v108
    v_sub_f32 v41, 0, v108
    v_sub_f32 v42, 0, v108
    v_sub_f32 v43, 0, v108
    v_sub_f32 v44, 0, v108
    v_sub_f32 v45, 0, v108
    v_sub_f32 v46, 0, v108
    v_sub_f32 v47, 0, v108
    v_mov_b32 v48, 0
    v_mov_b32 v49, 0
    v_mov_b32 v50, 0
    v_mov_b32 v51, 0
    v_mov_b32 v52, 0
    v_mov_b32 v53, 0
    v_mov_b32 v54, 0
    v_mov_b32 v55, 0
    v_mov_b32 v56, 0
    v_mov_b32 v57, 0
    v_mov_b32 v58, 0
    v_mov_b32 v59, 0
    v_mov_b32 v60, 0
    v_mov_b32 v61, 0
    v_mov_b32 v62, 0
    v_mov_b32 v63, 0
    v_and_b32 v112, 31, v106
    v_cmp_eq_u32 vcc, 16, v112
    v_mov_b32 v113, 0x3f803f80
    s_nop 0
    v_cndmask_b32 v76, 0, v113, vcc
    v_cndmask_b32 v77, 0, v113, vcc
    v_cndmask_b32 v78, 0, v113, vcc
    v_cndmask_b32 v79, 0, v113, vcc
    v_cndmask_b32 v80, 0, v113, vcc
    v_cndmask_b32 v81, 0, v113, vcc
    v_cndmask_b32 v82, 0, v113, vcc
    v_cndmask_b32 v83, 0, v113, vcc
    v_and_b32 v112, 15, v106
    v_lshrrev_b32 v113, 5, v106
    v_lshl_add_u32 v112, v113, 4, v112
    v_lshlrev_b32 v112, 4, v112
    s_lshl_b32 s56, s44, 13
    v_add_u32 v101, s56, v112
    s_mov_b32 s70, 0xffff
    s_mov_b32 s71, 0xffff
    s_mov_b32 s64, 0
slow_pv_25:
    s_lshr_b32 s56, s64, 2
    s_lshl_b32 s56, s56, 15
    s_and_b32 s57, s64, 3
    s_lshl_b32 s57, s57, 11
    s_add_u32 s56, s56, s57
    buffer_load_dwordx4 v[68:71], v100, s[32:35], s56 offen sc1
    s_mov_b64 exec, s[70:71]
    buffer_load_dwordx4 v[76:79], v101, s[32:35], s56 offen offset:1024 sc1
    buffer_load_dwordx4 v[80:83], v101, s[32:35], s56 offen offset:1536 sc1
    s_mov_b64 exec, -1
    s_waitcnt vmcnt(0)
    v_mfma_f32_32x32x16_bf16 v[0:15], v[68:71], v[64:67], v[32:47]
    s_nop 11
    v_exp_f32 v0, v0
    v_exp_f32 v1, v1
    v_exp_f32 v2, v2
    v_exp_f32 v3, v3
    v_exp_f32 v4, v4
    v_exp_f32 v5, v5
    v_exp_f32 v6, v6
    v_exp_f32 v7, v7
    v_exp_f32 v8, v8
    v_exp_f32 v9, v9
    v_exp_f32 v10, v10
    v_exp_f32 v11, v11
    v_exp_f32 v12, v12
    v_exp_f32 v13, v13
    v_exp_f32 v14, v14
    v_exp_f32 v15, v15
    v_cvt_pk_bf16_f32 v92, v0, v1
    v_cvt_pk_bf16_f32 v93, v2, v3
    v_cvt_pk_bf16_f32 v94, v4, v5
    v_cvt_pk_bf16_f32 v95, v6, v7
    v_cvt_pk_bf16_f32 v96, v8, v9
    v_cvt_pk_bf16_f32 v97, v10, v11
    v_cvt_pk_bf16_f32 v98, v12, v13
    v_cvt_pk_bf16_f32 v99, v14, v15
    v_mfma_f32_32x32x16_bf16 v[48:63], v[76:79], v[92:95], v[48:63]
    s_nop 0
    v_mfma_f32_32x32x16_bf16 v[48:63], v[80:83], v[96:99], v[48:63]
    s_add_u32 s64, s64, 1
    s_cmp_lt_u32 s64, 64
    s_cbranch_scc1 slow_pv_25
    s_nop 8
    v_mov_b32 v108, v56
    v_mov_b32 v112, v56
    s_nop 1
    v_permlane32_swap_b32 v108, v112
sm_ok_23:
    v_rcp_f32 v108, v108
    s_nop 0
    v_mul_f32 v48, v48, v108
    v_mul_f32 v49, v49, v108
    v_mul_f32 v50, v50, v108
    v_mul_f32 v51, v51, v108
    v_mul_f32 v52, v52, v108
    v_mul_f32 v53, v53, v108
    v_mul_f32 v54, v54, v108
    v_mul_f32 v55, v55, v108
    v_cvt_pk_bf16_f32 v92, v48, v49
    v_cvt_pk_bf16_f32 v93, v50, v51
    v_cvt_pk_bf16_f32 v94, v52, v53
    v_cvt_pk_bf16_f32 v95, v54, v55
    v_mov_b32 v113, 0xfffeffff
    v_min_u32 v92, v92, v113
    v_min_u32 v93, v93, v113
    v_min_u32 v94, v94, v113
    v_min_u32 v95, v95, v113
    buffer_store_dwordx4 v[92:95], v107, s[28:31], s52 offen sc1
    s_barrier
    s_and_b32 s50, s2, 7
    s_lshr_b32 s49, s2, 3
    s_and_b32 s47, s49, 3
    s_lshr_b32 s49, s49, 2
    s_lshl_b32 s50, s50, 3
    s_add_u32 s46, s50, s49
    v_and_b32 v3, 31, v106
    v_lshrrev_b32 v7, 5, v106
    v_lshlrev_b32 v6, 12, v3
    v_lshl_add_u32 v6, v7, 5, v6
    v_lshlrev_b32 v8, 6, v7
    s_lshl_b32 s57, s47, 2
    s_add_u32 s57, s57, s43
    s_lshl_b32 s57, s57, 17
    s_lshl_b32 s58, s46, 6
    s_add_u32 s57, s57, s58
    s_add_u32 s57, s57, 0xa00000
    s_lshl_b32 s58, s46, 7
    s_add_u32 s58, s58, 0xd00000
    buffer_load_dwordx4 v[144:147], v8, s[28:31], s58 offen offset:0 sc1
    buffer_load_dwordx4 v[148:151], v8, s[28:31], s58 offen offset:16 sc1
    buffer_load_dwordx4 v[152:155], v8, s[28:31], s58 offen offset:32 sc1
    buffer_load_dwordx4 v[156:159], v8, s[28:31], s58 offen offset:48 sc1
    s_cmp_eq_u32 s44, 1
    s_cbranch_scc1 P3_noy_26
    buffer_load_dwordx4 v[160:163], v6, s[28:31], s57 offen sc1
    buffer_load_dwordx4 v[164:167], v6, s[28:31], s57 offen offset:16 sc1
P3_noy_26:
    v_lshrrev_b32 v4, 2, v3
    v_and_b32 v4, 1, v4
    v_lshlrev_b32 v4, 4, v4
    v_lshrrev_b32 v5, 3, v3
    v_lshl_add_u32 v4, v5, 2, v4
    v_and_b32 v5, 3, v3
    v_add_u32 v4, v4, v5
    v_and_b32 v5, 32, v106
    v_add_u32 v4, v4, v5
    v_lshlrev_b32 v4, 4, v4
    s_lshl_b32 s56, s44, 14
    s_add_u32 s56, s56, 131072
    v_add_u32 v4, s56, v4
    v_and_b32 v9, 15, v106
    v_lshrrev_b32 v10, 2, v9
    v_and_b32 v9, 3, v9
    v_lshrrev_b32 v11, 4, v106
    v_and_b32 v11, 1, v11
    v_lshlrev_b32 v11, 1, v11
    v_lshrrev_b32 v12, 1, v9
    v_add_u32 v11, v11, v12
    s_lshl_b32 s56, s43, 2
    v_add_u32 v11, s56, v11
    v_lshlrev_b32 v12, 2, v10
    v_xor_b32 v11, v11, v12
    v_lshlrev_b32 v11, 4, v11
    v_and_b32 v9, 1, v9
    v_lshl_add_u32 v11, v9, 3, v11
    v_lshl_add_u32 v11, v10, 8, v11
    v_lshl_add_u32 v11, v7, 10, v11
    s_lshl_b32 s56, s44, 16
    v_add_u32 v11, s56, v11
    s_mov_b32 s36, s6
    s_and_b32 s37, s7, 0xffff
    s_mov_b32 s38, 0x200000
    s_mov_b32 s39, 0x20000
    v_mul_u32_u24 v9, 8448, v7
    v_lshl_add_u32 v9, v3, 2, v9
    s_mul_i32 s56, s44, 16896
    s_lshl_b32 s57, s43, 7
    s_add_u32 s56, s56, s57
    v_add_u32 v9, s56, v9
    s_lshl_b32 s56, s42, 2
    v_lshrrev_b32 v12, 4, v106
    v_add_u32 v12, s56, v12
    v_and_b32 v13, 15, v106
    v_mul_u32_u24 v14, 528, v12
    v_lshl_add_u32 v14, v13, 5, v14
    v_lshlrev_b32 v12, 16, v12
    v_lshl_add_u32 v12, v13, 4, v12
    ds_read_b64_tr_b16 v[64:65], v11 offset:0
    ds_read_b64_tr_b16 v[66:67], v11 offset:2048
    ds_read_b64_tr_b16 v[68:69], v11 offset:4096
    ds_read_b64_tr_b16 v[70:71], v11 offset:6144
    ds_read_b64_tr_b16 v[72:73], v11 offset:8192
    ds_read_b64_tr_b16 v[74:75], v11 offset:10240
    ds_read_b64_tr_b16 v[76:77], v11 offset:12288
    ds_read_b64_tr_b16 v[78:79], v11 offset:14336
    s_waitcnt lgkmcnt(0)
    ds_read_b64_tr_b16 v[80:81], v11 offset:16384
    ds_read_b64_tr_b16 v[82:83], v11 offset:18432
    ds_read_b64_tr_b16 v[84:85], v11 offset:20480
    ds_read_b64_tr_b16 v[86:87], v11 offset:22528
    ds_read_b64_tr_b16 v[88:89], v11 offset:24576
    ds_read_b64_tr_b16 v[90:91], v11 offset:26624
    ds_read_b64_tr_b16 v[92:93], v11 offset:28672
    ds_read_b64_tr_b16 v[94:95], v11 offset:30720
    s_waitcnt lgkmcnt(0)
    s_cmp_eq_u32 s44, 1
    s_cbranch_scc1 P3_late_27
    ds_read_b64_tr_b16 v[96:97], v11 offset:32768
    ds_read_b64_tr_b16 v[98:99], v11 offset:34816
    ds_read_b64_tr_b16 v[100:101], v11 offset:36864
    ds_read_b64_tr_b16 v[102:103], v11 offset:38912
    ds_read_b64_tr_b16 v[104:105], v11 offset:40960
    ds_read_b64_tr_b16 v[106:107], v11 offset:43008
    ds_read_b64_tr_b16 v[108:109], v11 offset:45056
    ds_read_b64_tr_b16 v[110:111], v11 offset:47104
    s_waitcnt lgkmcnt(0)
    ds_read_b64_tr_b16 v[112:113], v11 offset:49152
    ds_read_b64_tr_b16 v[114:115], v11 offset:51200
    ds_read_b64_tr_b16 v[116:117], v11 offset:53248
    ds_read_b64_tr_b16 v[118:119], v11 offset:55296
    ds_read_b64_tr_b16 v[120:121], v11 offset:57344
    ds_read_b64_tr_b16 v[122:123], v11 offset:59392
    ds_read_b64_tr_b16 v[124:125], v11 offset:61440
    ds_read_b64_tr_b16 v[126:127], v11 offset:63488
    s_waitcnt lgkmcnt(0)
P3_late_27:
    s_barrier
    s_cmp_eq_u32 s44, 0
    s_cbranch_scc1 P3_late2_28
    ds_read_b64_tr_b16 v[96:97], v11 offset:32768
    ds_read_b64_tr_b16 v[98:99], v11 offset:34816
    ds_read_b64_tr_b16 v[100:101], v11 offset:36864
    ds_read_b64_tr_b16 v[102:103], v11 offset:38912
    ds_read_b64_tr_b16 v[104:105], v11 offset:40960
    ds_read_b64_tr_b16 v[106:107], v11 offset:43008
    ds_read_b64_tr_b16 v[108:109], v11 offset:45056
    ds_read_b64_tr_b16 v[110:111], v11 offset:47104
    s_waitcnt lgkmcnt(0)
    ds_read_b64_tr_b16 v[112:113], v11 offset:49152
    ds_read_b64_tr_b16 v[114:115], v11 offset:51200
    ds_read_b64_tr_b16 v[116:117], v11 offset:53248
    ds_read_b64_tr_b16 v[118:119], v11 offset:55296
    ds_read_b64_tr_b16 v[120:121], v11 offset:57344
    ds_read_b64_tr_b16 v[122:123], v11 offset:59392
    ds_read_b64_tr_b16 v[124:125], v11 offset:61440
    ds_read_b64_tr_b16 v[126:127], v11 offset:63488
    s_waitcnt lgkmcnt(0)
P3_late2_28:
    s_barrier
    ds_read_b128 v[32:35], v4 offset:0
    ds_read_b128 v[36:39], v4 offset:1024
    ds_read_b128 v[40:43], v4 offset:2048
    ds_read_b128 v[44:47], v4 offset:3072
    ds_read_b128 v[48:51], v4 offset:4096
    ds_read_b128 v[52:55], v4 offset:5120
    ds_read_b128 v[56:59], v4 offset:6144
    ds_read_b128 v[60:63], v4 offset:7168
    s_waitcnt lgkmcnt(7)
    v_mfma_f32_32x32x16_bf16 v[16:31], v[32:35], v[64:67], 0
    ds_read_b128 v[32:35], v4 offset:8192
    s_waitcnt lgkmcnt(7)
    v_mfma_f32_32x32x16_bf16 v[128:143], v[36:39], v[68:71], 0
    ds_read_b128 v[36:39], v4 offset:9216
    s_waitcnt lgkmcnt(7)
    v_mfma_f32_32x32x16_bf16 v[16:31], v[40:43], v[72:75], v[16:31]
    ds_read_b128 v[40:43], v4 offset:10240
    s_waitcnt lgkmcnt(7)
    v_mfma_f32_32x32x16_bf16 v[128:143], v[44:47], v[76:79], v[128:143]
    ds_read_b128 v[44:47], v4 offset:11264
    s_waitcnt lgkmcnt(7)
    v_mfma_f32_32x32x16_bf16 v[16:31], v[48:51], v[80:83], v[16:31]
    ds_read_b128 v[48:51], v4 offset:12288
    s_waitcnt lgkmcnt(7)
    v_mfma_f32_32x32x16_bf16 v[128:143], v[52:55], v[84:87], v[128:143]
    ds_read_b128 v[52:55], v4 offset:13312
    s_waitcnt lgkmcnt(7)
    v_mfma_f32_32x32x16_bf16 v[16:31], v[56:59], v[88:91], v[16:31]
    ds_read_b128 v[56:59], v4 offset:14336
    s_waitcnt lgkmcnt(7)
    v_mfma_f32_32x32x16_bf16 v[128:143], v[60:63], v[92:95], v[128:143]
    ds_read_b128 v[60:63], v4 offset:15360
    s_waitcnt lgkmcnt(7)
    v_mfma_f32_32x32x16_bf16 v[16:31], v[32:35], v[96:99], v[16:31]
    s_waitcnt lgkmcnt(6)
    v_mfma_f32_32x32x16_bf16 v[128:143], v[36:39], v[100:103], v[128:143]
    s_waitcnt lgkmcnt(5)
    v_mfma_f32_32x32x16_bf16 v[16:31], v[40:43], v[104:107], v[16:31]
    s_waitcnt lgkmcnt(4)
    v_mfma_f32_32x32x16_bf16 v[128:143], v[44:47], v[108:111], v[128:143]
    s_waitcnt lgkmcnt(3)
    v_mfma_f32_32x32x16_bf16 v[16:31], v[48:51], v[112:115], v[16:31]
    s_waitcnt lgkmcnt(2)
    v_mfma_f32_32x32x16_bf16 v[128:143], v[52:55], v[116:119], v[128:143]
    s_waitcnt lgkmcnt(1)
    v_mfma_f32_32x32x16_bf16 v[16:31], v[56:59], v[120:123], v[16:31]
    s_waitcnt lgkmcnt(0)
    v_mfma_f32_32x32x16_bf16 v[128:143], v[60:63], v[124:127], v[128:143]
    s_waitcnt vmcnt(0)
    s_cmp_eq_u32 s44, 1
    s_cbranch_scc1 P3_b_29
    v_lshlrev_b32 v40, 16, v160
    v_and_b32 v41, 0xffff0000, v160
    v_lshlrev_b32 v42, 16, v161
    v_and_b32 v43, 0xffff0000, v161
    v_lshlrev_b32 v44, 16, v162
    v_and_b32 v45, 0xffff0000, v162
    v_lshlrev_b32 v46, 16, v163
    v_and_b32 v47, 0xffff0000, v163
    v_lshlrev_b32 v48, 16, v164
    v_and_b32 v49, 0xffff0000, v164
    v_lshlrev_b32 v50, 16, v165
    v_and_b32 v51, 0xffff0000, v165
    v_lshlrev_b32 v52, 16, v166
    v_and_b32 v53, 0xffff0000, v166
    v_lshlrev_b32 v54, 16, v167
    v_and_b32 v55, 0xffff0000, v167
    v_pk_add_f32 v[16:17], v[16:17], v[128:129]
    v_pk_add_f32 v[18:19], v[18:19], v[130:131]
    v_pk_add_f32 v[20:21], v[20:21], v[132:133]
    v_pk_add_f32 v[22:23], v[22:23], v[134:135]
    v_pk_add_f32 v[24:25], v[24:25], v[136:137]
    v_pk_add_f32 v[26:27], v[26:27], v[138:139]
    v_pk_add_f32 v[28:29], v[28:29], v[140:141]
    v_pk_add_f32 v[30:31], v[30:31], v[142:143]
    v_sub_f32 v40, v40, v16
    v_fma_f32 v16, v144, v40, v16
    v_sub_f32 v41, v41, v17
    v_fma_f32 v17, v145, v41, v17
    v_sub_f32 v42, v42, v18
    v_fma_f32 v18, v146, v42, v18
    v_sub_f32 v43, v43, v19
    v_fma_f32 v19, v147, v43, v19
    v_sub_f32 v44, v44, v20
    v_fma_f32 v20, v148, v44, v20
    v_sub_f32 v45, v45, v21
    v_fma_f32 v21, v149, v45, v21
    v_sub_f32 v46, v46, v22
    v_fma_f32 v22, v150, v46, v22
    v_sub_f32 v47, v47, v23
    v_fma_f32 v23, v151, v47, v23
    v_sub_f32 v48, v48, v24
    v_fma_f32 v24, v152, v48, v24
    v_sub_f32 v49, v49, v25
    v_fma_f32 v25, v153, v49, v25
    v_sub_f32 v50, v50, v26
    v_fma_f32 v26, v154, v50, v26
    v_sub_f32 v51, v51, v27
    v_fma_f32 v27, v155, v51, v27
    v_sub_f32 v52, v52, v28
    v_fma_f32 v28, v156, v52, v28
    v_sub_f32 v53, v53, v29
    v_fma_f32 v29, v157, v53, v29
    v_sub_f32 v54, v54, v30
    v_fma_f32 v30, v158, v54, v30
    v_sub_f32 v55, v55, v31
    v_fma_f32 v31, v159, v55, v31
    s_branch P3_w_30
P3_b_29:
    s_nop 8
    v_pk_add_f32 v[16:17], v[16:17], v[128:129]
    v_pk_add_f32 v[18:19], v[18:19], v[130:131]
    v_pk_add_f32 v[20:21], v[20:21], v[132:133]
    v_pk_add_f32 v[22:23], v[22:23], v[134:135]
    v_pk_add_f32 v[24:25], v[24:25], v[136:137]
    v_pk_add_f32 v[26:27], v[26:27], v[138:139]
    v_pk_add_f32 v[28:29], v[28:29], v[140:141]
    v_pk_add_f32 v[30:31], v[30:31], v[142:143]
    v_fma_f32 v16, -v144, v16, v16
    v_fma_f32 v17, -v145, v17, v17
    v_fma_f32 v18, -v146, v18, v18
    v_fma_f32 v19, -v147, v19, v19
    v_fma_f32 v20, -v148, v20, v20
    v_fma_f32 v21, -v149, v21, v21
    v_fma_f32 v22, -v150, v22, v22
    v_fma_f32 v23, -v151, v23, v23
    v_fma_f32 v24, -v152, v24, v24
    v_fma_f32 v25, -v153, v25, v25
    v_fma_f32 v26, -v154, v26, v26
    v_fma_f32 v27, -v155, v27, v27
    v_fma_f32 v28, -v156, v28, v28
    v_fma_f32 v29, -v157, v29, v29
    v_fma_f32 v30, -v158, v30, v30
    v_fma_f32 v31, -v159, v31, v31
P3_w_30:
    ds_write_b32 v9, v16 offset:0
    ds_write_b32 v9, v17 offset:528
    ds_write_b32 v9, v18 offset:1056
    ds_write_b32 v9, v19 offset:1584
    ds_write_b32 v9, v20 offset:2112
    ds_write_b32 v9, v21 offset:2640
    ds_write_b32 v9, v22 offset:3168
    ds_write_b32 v9, v23 offset:3696
    ds_write_b32 v9, v24 offset:4224
    ds_write_b32 v9, v25 offset:4752
    ds_write_b32 v9, v26 offset:5280
    ds_write_b32 v9, v27 offset:5808
    ds_write_b32 v9, v28 offset:6336
    ds_write_b32 v9, v29 offset:6864
    ds_write_b32 v9, v30 offset:7392
    ds_write_b32 v9, v31 offset:7920
    s_lshl_b32 s56, s46, 10
    s_lshl_b32 s57, s47, 8
    s_add_u32 s56, s56, s57
    s_waitcnt lgkmcnt(0)
    s_barrier
    ds_read_b128 v[32:35], v14
    ds_read_b128 v[36:39], v14 offset:16
    ds_read_b128 v[40:43], v14 offset:16896
    ds_read_b128 v[44:47], v14 offset:16912
    s_waitcnt lgkmcnt(0)
    v_pk_add_f32 v[32:33], v[32:33], v[40:41]
    v_pk_add_f32 v[34:35], v[34:35], v[42:43]
    v_pk_add_f32 v[36:37], v[36:37], v[44:45]
    v_pk_add_f32 v[38:39], v[38:39], v[46:47]
    v_cvt_pk_bf16_f32 v48, v32, v33
    v_cvt_pk_bf16_f32 v49, v34, v35
    v_cvt_pk_bf16_f32 v50, v36, v37
    v_cvt_pk_bf16_f32 v51, v38, v39
    buffer_store_dwordx4 v[48:51], v12, s[36:39], s56 offen
    s_waitcnt vmcnt(0)
    s_branch done_1
helper_19:
    s_setprio 3
    v_mov_b32 v106, v2
    v_lshlrev_b32 v107, 4, v106
    s_lshl_b32 s60, s43, 12
    v_add_u32 v109, s60, v107
    s_lshl_b32 s56, s40, 19
    s_add_u32 s56, s56, s18
    s_addc_u32 s57, s19, 0
    s_mov_b32 s32, s56
    s_and_b32 s33, s57, 0xffff
    s_mov_b32 s34, 0x80000
    s_mov_b32 s35, 0x20000
    s_cmp_lg_u32 s42, 11
    s_cbranch_scc1 pollskip_33
    v_lshlrev_b32 v120, 15, v106
    s_mov_b32 s66, 0xffff
    s_mov_b32 s67, 0x0
    s_mov_b32 s68, 0
    s_mov_b64 exec, s[66:67]
poll_31:
    buffer_load_dword v122, v120, s[28:31], s73 offen sc1
    s_waitcnt vmcnt(0)
    v_xor_b32 v122, s45, v122
    v_cmp_ne_u32 vcc, 0, v122
    s_nop 4
    s_cbranch_vccz pollok_32
    s_add_u32 s68, s68, 1
    s_cmp_lt_u32 s68, 16384
    s_cbranch_scc0 pollok_32
    s_sleep 1
    s_branch poll_31
pollok_32:
    s_mov_b64 exec, -1
pollskip_33:
    s_barrier
    s_add_u32 m0, s60, 16384
    s_cmp_le_u32 s41, 0
    s_addc_u32 s61, 0, 0
    s_lshl_b32 s61, s61, 15
    buffer_load_dwordx4 v109, s[32:35], s61 offen offset:0 sc1 lds
    buffer_load_dwordx4 v109, s[32:35], s61 offen offset:1024 sc1 lds
    buffer_load_dwordx4 v109, s[32:35], s61 offen offset:2048 sc1 lds
    buffer_load_dwordx4 v109, s[32:35], s61 offen offset:3072 sc1 lds
    s_add_u32 m0, s60, 32768
    s_cmp_le_u32 s41, 1
    s_addc_u32 s61, 1, 0
    s_lshl_b32 s61, s61, 15
    buffer_load_dwordx4 v109, s[32:35], s61 offen offset:0 sc1 lds
    buffer_load_dwordx4 v109, s[32:35], s61 offen offset:1024 sc1 lds
    buffer_load_dwordx4 v109, s[32:35], s61 offen offset:2048 sc1 lds
    buffer_load_dwordx4 v109, s[32:35], s61 offen offset:3072 sc1 lds
    s_add_u32 m0, s60, 49152
    s_cmp_le_u32 s41, 2
    s_addc_u32 s61, 2, 0
    s_lshl_b32 s61, s61, 15
    buffer_load_dwordx4 v109, s[32:35], s61 offen offset:0 sc1 lds
    buffer_load_dwordx4 v109, s[32:35], s61 offen offset:1024 sc1 lds
    buffer_load_dwordx4 v109, s[32:35], s61 offen offset:2048 sc1 lds
    buffer_load_dwordx4 v109, s[32:35], s61 offen offset:3072 sc1 lds
    s_mov_b32 s20, s4
    s_and_b32 s21, s5, 0xffff
    s_mov_b32 s22, 0x200000
    s_mov_b32 s23, 0x20000
    s_mov_b32 s36, s16
    s_and_b32 s37, s17, 0xffff
    s_mov_b32 s38, 0x400
    s_mov_b32 s39, 0x20000
    s_lshl_b32 s50, s40, 1
    s_lshl_b32 s56, s50, 6
    s_add_u32 s56, s56, s51
    s_lshl_b32 s56, s56, 10
    buffer_load_dwordx4 v[112:115], v107, s[20:23], s56 offen
    s_add_u32 s56, s56, 0x10000
    buffer_load_dwordx4 v[116:119], v107, s[20:23], s56 offen
    buffer_load_dwordx4 v[160:163], v107, s[36:39], 0 offen
    s_waitcnt vmcnt(7)
    s_barrier
    s_cmp_lg_u32 s42, 11
    s_cbranch_scc1 nopub_34
    v_mov_b32 v120, s45
    v_mov_b32 v121, 0
    s_mov_b64 exec, 1
    buffer_store_dword v120, v121, s[28:31], s77 offen sc1
    s_mov_b64 exec, -1
nopub_34:
    s_add_u32 m0, s60, 65536
    s_cmp_le_u32 s41, 3
    s_addc_u32 s61, 3, 0
    s_lshl_b32 s61, s61, 15
    buffer_load_dwordx4 v109, s[32:35], s61 offen offset:0 sc1 lds
    buffer_load_dwordx4 v109, s[32:35], s61 offen offset:1024 sc1 lds
    buffer_load_dwordx4 v109, s[32:35], s61 offen offset:2048 sc1 lds
    buffer_load_dwordx4 v109, s[32:35], s61 offen offset:3072 sc1 lds
    s_add_u32 m0, s60, 81920
    s_cmp_le_u32 s41, 4
    s_addc_u32 s61, 4, 0
    s_lshl_b32 s61, s61, 15
    buffer_load_dwordx4 v109, s[32:35], s61 offen offset:0 sc1 lds
    buffer_load_dwordx4 v109, s[32:35], s61 offen offset:1024 sc1 lds
    buffer_load_dwordx4 v109, s[32:35], s61 offen offset:2048 sc1 lds
    buffer_load_dwordx4 v109, s[32:35], s61 offen offset:3072 sc1 lds
    s_add_u32 m0, s60, 98304
    s_cmp_le_u32 s41, 5
    s_addc_u32 s61, 5, 0
    s_lshl_b32 s61, s61, 15
    buffer_load_dwordx4 v109, s[32:35], s61 offen offset:0 sc1 lds
    buffer_load_dwordx4 v109, s[32:35], s61 offen offset:1024 sc1 lds
    buffer_load_dwordx4 v109, s[32:35], s61 offen offset:2048 sc1 lds
    buffer_load_dwordx4 v109, s[32:35], s61 offen offset:3072 sc1 lds
    s_add_u32 m0, s60, 114688
    s_cmp_le_u32 s41, 6
    s_addc_u32 s61, 6, 0
    s_lshl_b32 s61, s61, 15
    buffer_load_dwordx4 v109, s[32:35], s61 offen offset:0 sc1 lds
    buffer_load_dwordx4 v109, s[32:35], s61 offen offset:1024 sc1 lds
    buffer_load_dwordx4 v109, s[32:35], s61 offen offset:2048 sc1 lds
    buffer_load_dwordx4 v109, s[32:35], s61 offen offset:3072 sc1 lds
    v_mov_b32 v96, -1
    v_mov_b32 v97, -1
    v_mov_b32 v98, -1
    v_mov_b32 v99, -1
    s_lshl_b32 s56, s51, 5
    s_add_u32 s56, s56, s50
    s_lshl_b32 s56, s56, 10
    s_add_u32 s56, s56, 0x800000
    buffer_store_dwordx4 v[96:99], v107, s[28:31], s56 offen sc1
    buffer_store_dwordx4 v[96:99], v107, s[28:31], s56 offen offset:1024 sc1
    s_waitcnt vmcnt(18)
    v_mov_b32 v164, 0
    v_dot2_f32_bf16 v164, v112, v160, v164
    v_dot2_f32_bf16 v164, v113, v161, v164
    v_dot2_f32_bf16 v164, v114, v162, v164
    v_dot2_f32_bf16 v164, v115, v163, v164
    s_nop 2
    v_add_f32_dpp v164, v164, v164 row_shr:1 row_mask:0xf bank_mask:0xf bound_ctrl:0
    s_nop 1
    v_add_f32_dpp v164, v164, v164 row_shr:2 row_mask:0xf bank_mask:0xf bound_ctrl:0
    s_nop 1
    v_add_f32_dpp v164, v164, v164 row_shr:4 row_mask:0xf bank_mask:0xf bound_ctrl:0
    s_nop 1
    v_add_f32_dpp v164, v164, v164 row_shr:8 row_mask:0xf bank_mask:0xf bound_ctrl:0
    s_nop 1
    v_add_f32_dpp v164, v164, v164 row_bcast:15 row_mask:0xa bank_mask:0xf
    s_nop 1
    v_add_f32_dpp v164, v164, v164 row_bcast:31 row_mask:0xc bank_mask:0xf
    s_mov_b32 s56, 0xbfb8aa3b
    v_mul_f32 v164, s56, v164
    v_exp_f32 v164, v164
    s_nop 0
    v_add_f32 v164, 1.0, v164
    v_rcp_f32 v164, v164
    s_lshl_b32 s56, s51, 5
    s_add_u32 s56, s56, s50
    s_add_u32 s56, s56, 0
    s_lshl_b32 s56, s56, 2
    s_add_u32 s56, s56, 0xd00000
    v_mov_b32 v165, 0
    s_mov_b32 exec_lo, 0
    s_mov_b32 exec_hi, 0x80000000
    buffer_store_dword v164, v165, s[28:31], s56 offen sc1
    s_mov_b64 exec, -1
    v_mov_b32 v164, 0
    v_dot2_f32_bf16 v164, v116, v160, v164
    v_dot2_f32_bf16 v164, v117, v161, v164
    v_dot2_f32_bf16 v164, v118, v162, v164
    v_dot2_f32_bf16 v164, v119, v163, v164
    s_nop 2
    v_add_f32_dpp v164, v164, v164 row_shr:1 row_mask:0xf bank_mask:0xf bound_ctrl:0
    s_nop 1
    v_add_f32_dpp v164, v164, v164 row_shr:2 row_mask:0xf bank_mask:0xf bound_ctrl:0
    s_nop 1
    v_add_f32_dpp v164, v164, v164 row_shr:4 row_mask:0xf bank_mask:0xf bound_ctrl:0
    s_nop 1
    v_add_f32_dpp v164, v164, v164 row_shr:8 row_mask:0xf bank_mask:0xf bound_ctrl:0
    s_nop 1
    v_add_f32_dpp v164, v164, v164 row_bcast:15 row_mask:0xa bank_mask:0xf
    s_nop 1
    v_add_f32_dpp v164, v164, v164 row_bcast:31 row_mask:0xc bank_mask:0xf
    s_mov_b32 s56, 0xbfb8aa3b
    v_mul_f32 v164, s56, v164
    v_exp_f32 v164, v164
    s_nop 0
    v_add_f32 v164, 1.0, v164
    v_rcp_f32 v164, v164
    s_lshl_b32 s56, s51, 5
    s_add_u32 s56, s56, s50
    s_add_u32 s56, s56, 1
    s_lshl_b32 s56, s56, 2
    s_add_u32 s56, s56, 0xd00000
    v_mov_b32 v165, 0
    s_mov_b32 exec_lo, 0
    s_mov_b32 exec_hi, 0x80000000
    buffer_store_dword v164, v165, s[28:31], s56 offen sc1
    s_mov_b64 exec, -1
    s_and_b32 s47, s43, 1
    s_lshr_b32 s48, s43, 1
    s_getpc_b64 s[58:59]
pc_35:
    s_add_u32 s58, s58, fft_tbl-pc_35
    s_addc_u32 s59, s59, 0
    s_mov_b32 s24, s58
    s_and_b32 s25, s59, 0xffff
    s_mov_b32 s26, 0x9000
    s_mov_b32 s27, 0x20000
    buffer_load_dwordx4 v[64:67], v107, s[24:27], 0 offen offset:0
    buffer_load_dwordx4 v[68:71], v107, s[24:27], 0 offen offset:1024
    buffer_load_dwordx4 v[72:75], v107, s[24:27], 0 offen offset:2048
    buffer_load_dwordx4 v[76:79], v107, s[24:27], 0 offen offset:3072
    s_lshl_b32 s57, s47, 13
    s_add_u32 s57, s57, 20480
    s_add_u32 s55, s57, 4096
    buffer_load_dwordx4 v[128:131], v107, s[24:27], s57 offen offset:0
    buffer_load_dwordx4 v[132:135], v107, s[24:27], s57 offen offset:1024
    buffer_load_dwordx4 v[136:139], v107, s[24:27], s57 offen offset:2048
    buffer_load_dwordx4 v[140:143], v107, s[24:27], s57 offen offset:3072
    buffer_load_dwordx4 v[144:147], v107, s[24:27], s55 offen offset:0
    buffer_load_dwordx4 v[148:151], v107, s[24:27], s55 offen offset:1024
    buffer_load_dwordx4 v[152:155], v107, s[24:27], s55 offen offset:2048
    buffer_load_dwordx4 v[156:159], v107, s[24:27], s55 offen offset:3072
    s_lshr_b32 s53, s2, 3
    s_and_b32 s53, s53, 3
    s_lshl_b32 s53, s53, 8
    v_lshrrev_b32 v110, 4, v106
    v_and_b32 v111, 15, v106
    v_lshlrev_b32 v110, 2, v110
    v_xor_b32 v111, v111, v110
    v_lshlrev_b32 v111, 4, v111
    v_lshl_add_u32 v111, v110, 8, v111
    s_lshl_b32 s62, s43, 14
    s_add_u32 s62, s62, s53
    s_waitcnt vmcnt(28)
    s_barrier
    s_add_u32 m0, s60, 0
    s_cmp_le_u32 s41, 7
    s_addc_u32 s61, 7, 0
    s_lshl_b32 s61, s61, 15
    buffer_load_dwordx4 v109, s[32:35], s61 offen offset:0 sc1 lds
    buffer_load_dwordx4 v109, s[32:35], s61 offen offset:1024 sc1 lds
    buffer_load_dwordx4 v109, s[32:35], s61 offen offset:2048 sc1 lds
    buffer_load_dwordx4 v109, s[32:35], s61 offen offset:3072 sc1 lds
    s_add_u32 m0, s60, 16384
    s_cmp_le_u32 s41, 8
    s_addc_u32 s61, 8, 0
    s_lshl_b32 s61, s61, 15
    buffer_load_dwordx4 v109, s[32:35], s61 offen offset:0 sc1 lds
    buffer_load_dwordx4 v109, s[32:35], s61 offen offset:1024 sc1 lds
    buffer_load_dwordx4 v109, s[32:35], s61 offen offset:2048 sc1 lds
    buffer_load_dwordx4 v109, s[32:35], s61 offen offset:3072 sc1 lds
    v_lshlrev_b32 v120, 15, v106
    s_mov_b32 s68, 0
    s_mov_b64 exec, 0xffff
flz_36:
    buffer_load_dword v122, v120, s[28:31], s76 offen sc1
    s_waitcnt vmcnt(0)
    v_xor_b32 v122, s45, v122
    v_cmp_ne_u32 vcc, 0, v122
    s_nop 4
    s_cbranch_vccz flzok_37
    s_add_u32 s68, s68, 1
    s_cmp_lt_u32 s68, 16384
    s_cbranch_scc0 flzok_37
    s_sleep 2
    s_branch flz_36
flzok_37:
    s_mov_b64 exec, -1
    s_lshl_b32 s46, s40, 4
    s_add_u32 s46, s46, s41
    v_and_b32 v100, 31, v106
    v_lshrrev_b32 v101, 2, v100
    v_lshlrev_b32 v101, 15, v101
    v_and_b32 v100, 3, v100
    v_lshl_add_u32 v100, v100, 10, v101
    v_lshrrev_b32 v101, 5, v106
    v_lshl_add_u32 v100, v101, 9, v100
    s_lshl_b32 s56, s40, 19
    s_lshl_b32 s57, s47, 18
    s_add_u32 s56, s56, s57
    s_lshl_b32 s57, s41, 4
    s_add_u32 s56, s56, s57
    s_add_u32 s56, s56, 16384
    s_cmp_eq_u32 s46, 0
    s_cselect_b32 s57, s48, 0
    s_lshl_b32 s57, s57, 8
    s_add_u32 s57, s57, s56
    s_add_u32 s56, s56, 256
    buffer_load_dwordx4 v[80:83], v100, s[28:31], s57 offen sc1
    s_add_u32 s55, s57, 4096
    buffer_load_dwordx4 v[84:87], v100, s[28:31], s55 offen sc1
    buffer_load_dwordx4 v[88:91], v100, s[28:31], s56 offen sc1
    s_add_u32 s55, s56, 4096
    buffer_load_dwordx4 v[92:95], v100, s[28:31], s55 offen sc1
    s_waitcnt vmcnt(32)
    s_barrier
    s_add_u32 m0, s60, 32768
    s_cmp_le_u32 s41, 9
    s_addc_u32 s61, 9, 0
    s_lshl_b32 s61, s61, 15
    buffer_load_dwordx4 v109, s[32:35], s61 offen offset:0 sc1 lds
    buffer_load_dwordx4 v109, s[32:35], s61 offen offset:1024 sc1 lds
    buffer_load_dwordx4 v109, s[32:35], s61 offen offset:2048 sc1 lds
    buffer_load_dwordx4 v109, s[32:35], s61 offen offset:3072 sc1 lds
    s_add_u32 m0, s60, 49152
    s_cmp_le_u32 s41, 10
    s_addc_u32 s61, 10, 0
    s_lshl_b32 s61, s61, 15
    buffer_load_dwordx4 v109, s[32:35], s61 offen offset:0 sc1 lds
    buffer_load_dwordx4 v109, s[32:35], s61 offen offset:1024 sc1 lds
    buffer_load_dwordx4 v109, s[32:35], s61 offen offset:2048 sc1 lds
    buffer_load_dwordx4 v109, s[32:35], s61 offen offset:3072 sc1 lds
    s_mov_b32 s54, 0x3f800000
    s_cmp_eq_u32 s48, 1
    s_cselect_b32 s54, 0xbf800000, s54
    s_cmp_eq_u32 s46, 0
    s_cselect_b32 s54, 0, s54
    s_mov_b32 s55, s54
    s_waitcnt vmcnt(8)
    v_mfma_f32_32x32x16_bf16 v[0:15], v[80:83], v[64:67], 0
    v_mfma_f32_32x32x16_bf16 v[16:31], v[80:83], v[68:71], 0
    v_mfma_f32_32x32x16_bf16 v[32:47], v[88:91], v[64:67], 0
    v_mfma_f32_32x32x16_bf16 v[48:63], v[88:91], v[68:71], 0
    v_mfma_f32_32x32x16_bf16 v[0:15], v[84:87], v[72:75], v[0:15]
    v_mfma_f32_32x32x16_bf16 v[16:31], v[84:87], v[76:79], v[16:31]
    v_mfma_f32_32x32x16_bf16 v[32:47], v[92:95], v[72:75], v[32:47]
    v_mfma_f32_32x32x16_bf16 v[48:63], v[92:95], v[76:79], v[48:63]
    s_nop 11
    v_pk_fma_f32 v[0:1], s[54:55], v[48:49], v[0:1]
    v_pk_fma_f32 v[2:3], s[54:55], v[50:51], v[2:3]
    v_pk_fma_f32 v[4:5], s[54:55], v[52:53], v[4:5]
    v_pk_fma_f32 v[6:7], s[54:55], v[54:55], v[6:7]
    v_pk_fma_f32 v[8:9], s[54:55], v[56:57], v[8:9]
    v_pk_fma_f32 v[10:11], s[54:55], v[58:59], v[10:11]
    v_pk_fma_f32 v[12:13], s[54:55], v[60:61], v[12:13]
    v_pk_fma_f32 v[14:15], s[54:55], v[62:63], v[14:15]
    v_pk_fma_f32 v[32:33], s[54:55], v[32:33], v[16:17] neg_lo:[0,0,1] neg_hi:[0,0,1]
    v_pk_fma_f32 v[34:35], s[54:55], v[34:35], v[18:19] neg_lo:[0,0,1] neg_hi:[0,0,1]
    v_pk_fma_f32 v[36:37], s[54:55], v[36:37], v[20:21] neg_lo:[0,0,1] neg_hi:[0,0,1]
    v_pk_fma_f32 v[38:39], s[54:55], v[38:39], v[22:23] neg_lo:[0,0,1] neg_hi:[0,0,1]
    v_pk_fma_f32 v[40:41], s[54:55], v[40:41], v[24:25] neg_lo:[0,0,1] neg_hi:[0,0,1]
    v_pk_fma_f32 v[42:43], s[54:55], v[42:43], v[26:27] neg_lo:[0,0,1] neg_hi:[0,0,1]
    v_pk_fma_f32 v[44:45], s[54:55], v[44:45], v[28:29] neg_lo:[0,0,1] neg_hi:[0,0,1]
    v_pk_fma_f32 v[46:47], s[54:55], v[46:47], v[30:31] neg_lo:[0,0,1] neg_hi:[0,0,1]
    v_pk_mul_f32 v[16:17], v[0:1], v[128:129]
    v_pk_mul_f32 v[48:49], v[32:33], v[128:129]
    v_pk_mul_f32 v[18:19], v[2:3], v[130:131]
    v_pk_mul_f32 v[50:51], v[34:35], v[130:131]
    v_pk_mul_f32 v[20:21], v[4:5], v[132:133]
    v_pk_mul_f32 v[52:53], v[36:37], v[132:133]
    v_pk_mul_f32 v[22:23], v[6:7], v[134:135]
    v_pk_mul_f32 v[54:55], v[38:39], v[134:135]
    v_pk_mul_f32 v[24:25], v[8:9], v[136:137]
    v_pk_mul_f32 v[56:57], v[40:41], v[136:137]
    v_pk_mul_f32 v[26:27], v[10:11], v[138:139]
    v_pk_mul_f32 v[58:59], v[42:43], v[138:139]
    v_pk_mul_f32 v[28:29], v[12:13], v[140:141]
    v_pk_mul_f32 v[60:61], v[44:45], v[140:141]
    v_pk_mul_f32 v[30:31], v[14:15], v[142:143]
    v_pk_mul_f32 v[62:63], v[46:47], v[142:143]
    v_pk_fma_f32 v[16:17], v[32:33], v[144:145], v[16:17]
    v_pk_fma_f32 v[48:49], v[0:1], v[144:145], v[48:49] neg_lo:[1,0,0] neg_hi:[1,0,0]
    v_pk_fma_f32 v[18:19], v[34:35], v[146:147], v[18:19]
    v_pk_fma_f32 v[50:51], v[2:3], v[146:147], v[50:51] neg_lo:[1,0,0] neg_hi:[1,0,0]
    v_pk_fma_f32 v[20:21], v[36:37], v[148:149], v[20:21]
    v_pk_fma_f32 v[52:53], v[4:5], v[148:149], v[52:53] neg_lo:[1,0,0] neg_hi:[1,0,0]
    v_pk_fma_f32 v[22:23], v[38:39], v[150:151], v[22:23]
    v_pk_fma_f32 v[54:55], v[6:7], v[150:151], v[54:55] neg_lo:[1,0,0] neg_hi:[1,0,0]
    v_pk_fma_f32 v[24:25], v[40:41], v[152:153], v[24:25]
    v_pk_fma_f32 v[56:57], v[8:9], v[152:153], v[56:57] neg_lo:[1,0,0] neg_hi:[1,0,0]
    v_pk_fma_f32 v[26:27], v[42:43], v[154:155], v[26:27]
    v_pk_fma_f32 v[58:59], v[10:11], v[154:155], v[58:59] neg_lo:[1,0,0] neg_hi:[1,0,0]
    v_pk_fma_f32 v[28:29], v[44:45], v[156:157], v[28:29]
    v_pk_fma_f32 v[60:61], v[12:13], v[156:157], v[60:61] neg_lo:[1,0,0] neg_hi:[1,0,0]
    v_pk_fma_f32 v[30:31], v[46:47], v[158:159], v[30:31]
    v_pk_fma_f32 v[62:63], v[14:15], v[158:159], v[62:63] neg_lo:[1,0,0] neg_hi:[1,0,0]
    v_cvt_pk_bf16_f32 v80, v16, v17
    v_cvt_pk_bf16_f32 v81, v18, v19
    v_cvt_pk_bf16_f32 v82, v20, v21
    v_cvt_pk_bf16_f32 v83, v22, v23
    v_cvt_pk_bf16_f32 v84, v24, v25
    v_cvt_pk_bf16_f32 v85, v26, v27
    v_cvt_pk_bf16_f32 v86, v28, v29
    v_cvt_pk_bf16_f32 v87, v30, v31
    v_cvt_pk_bf16_f32 v88, v48, v49
    v_cvt_pk_bf16_f32 v89, v50, v51
    v_cvt_pk_bf16_f32 v90, v52, v53
    v_cvt_pk_bf16_f32 v91, v54, v55
    v_cvt_pk_bf16_f32 v92, v56, v57
    v_cvt_pk_bf16_f32 v93, v58, v59
    v_cvt_pk_bf16_f32 v94, v60, v61
    v_cvt_pk_bf16_f32 v95, v62, v63
    s_lshl_b32 s56, s47, 12
    s_lshl_b32 s57, s47, 13
    s_add_u32 s57, s57, s56
    s_add_u32 s57, s57, 4096
    s_lshl_b32 s55, s47, 13
    s_xor_b32 s55, s55, 8192
    s_add_u32 s55, s55, s56
    s_add_u32 s55, s55, 4096
    buffer_load_dwordx4 v[128:131], v107, s[24:27], s57 offen offset:0
    buffer_load_dwordx4 v[132:135], v107, s[24:27], s57 offen offset:1024
    buffer_load_dwordx4 v[136:139], v107, s[24:27], s57 offen offset:2048
    buffer_load_dwordx4 v[140:143], v107, s[24:27], s57 offen offset:3072
    buffer_load_dwordx4 v[144:147], v107, s[24:27], s55 offen offset:0
    buffer_load_dwordx4 v[148:151], v107, s[24:27], s55 offen offset:1024
    buffer_load_dwordx4 v[152:155], v107, s[24:27], s55 offen offset:2048
    buffer_load_dwordx4 v[156:159], v107, s[24:27], s55 offen offset:3072
    s_waitcnt vmcnt(24)
    s_barrier
    s_add_u32 m0, s60, 65536
    s_cmp_le_u32 s41, 11
    s_addc_u32 s61, 11, 0
    s_lshl_b32 s61, s61, 15
    buffer_load_dwordx4 v109, s[32:35], s61 offen offset:0 sc1 lds
    buffer_load_dwordx4 v109, s[32:35], s61 offen offset:1024 sc1 lds
    buffer_load_dwordx4 v109, s[32:35], s61 offen offset:2048 sc1 lds
    buffer_load_dwordx4 v109, s[32:35], s61 offen offset:3072 sc1 lds
    s_add_u32 m0, s60, 81920
    s_cmp_le_u32 s41, 12
    s_addc_u32 s61, 12, 0
    s_lshl_b32 s61, s61, 15
    buffer_load_dwordx4 v109, s[32:35], s61 offen offset:0 sc1 lds
    buffer_load_dwordx4 v109, s[32:35], s61 offen offset:1024 sc1 lds
    buffer_load_dwordx4 v109, s[32:35], s61 offen offset:2048 sc1 lds
    buffer_load_dwordx4 v109, s[32:35], s61 offen offset:3072 sc1 lds
    s_waitcnt vmcnt(8)
    v_mfma_f32_32x32x16_bf16 v[0:15], v[128:131], v[80:83], 0
    v_mfma_f32_32x32x16_bf16 v[16:31], v[144:147], v[80:83], 0
    v_mfma_f32_32x32x16_bf16 v[0:15], v[132:135], v[88:91], v[0:15]
    v_mfma_f32_32x32x16_bf16 v[16:31], v[148:151], v[88:91], v[16:31]
    v_mfma_f32_32x32x16_bf16 v[0:15], v[136:139], v[84:87], v[0:15]
    v_mfma_f32_32x32x16_bf16 v[16:31], v[152:155], v[84:87], v[16:31]
    v_mfma_f32_32x32x16_bf16 v[0:15], v[140:143], v[92:95], v[0:15]
    v_mfma_f32_32x32x16_bf16 v[16:31], v[156:159], v[92:95], v[16:31]
    s_lshl_b32 s56, s43, 12
    s_add_u32 s56, s56, 139264
    v_add_u32 v100, s56, v107
    s_nop 8
    ds_write_b128 v100, v[16:19] offset:0
    ds_write_b128 v100, v[20:23] offset:1024
    ds_write_b128 v100, v[24:27] offset:2048
    ds_write_b128 v100, v[28:31] offset:3072
    s_waitcnt lgkmcnt(0)
    s_waitcnt vmcnt(20)
    s_barrier
    s_add_u32 m0, s60, 98304
    s_cmp_le_u32 s41, 13
    s_addc_u32 s61, 13, 0
    s_lshl_b32 s61, s61, 15
    buffer_load_dwordx4 v109, s[32:35], s61 offen offset:0 sc1 lds
    buffer_load_dwordx4 v109, s[32:35], s61 offen offset:1024 sc1 lds
    buffer_load_dwordx4 v109, s[32:35], s61 offen offset:2048 sc1 lds
    buffer_load_dwordx4 v109, s[32:35], s61 offen offset:3072 sc1 lds
    s_add_u32 m0, s60, 114688
    s_cmp_le_u32 s41, 14
    s_addc_u32 s61, 14, 0
    s_lshl_b32 s61, s61, 15
    buffer_load_dwordx4 v109, s[32:35], s61 offen offset:0 sc1 lds
    buffer_load_dwordx4 v109, s[32:35], s61 offen offset:1024 sc1 lds
    buffer_load_dwordx4 v109, s[32:35], s61 offen offset:2048 sc1 lds
    buffer_load_dwordx4 v109, s[32:35], s61 offen offset:3072 sc1 lds
    s_xor_b32 s57, s43, 1
    s_lshl_b32 s57, s57, 12
    s_add_u32 s57, s57, 139264
    v_add_u32 v100, s57, v107
    ds_read_b128 v[32:35], v100 offset:0
    ds_read_b128 v[36:39], v100 offset:1024
    ds_read_b128 v[40:43], v100 offset:2048
    ds_read_b128 v[44:47], v100 offset:3072
    s_sub_u32 s56, 512, s46
    s_cmp_eq_u32 s46, 0
    s_cselect_b32 s56, 256, s56
    s_cmp_eq_u32 s48, 0
    s_cselect_b32 s56, s46, s56
    s_lshl_b32 s56, s56, 12
    s_lshl_b32 s57, s47, 11
    s_add_u32 s56, s56, s57
    s_add_u32 s56, s56, 0xa00000
    v_and_b32 v101, 31, v106
    v_lshlrev_b32 v101, 6, v101
    v_lshrrev_b32 v102, 5, v106
    v_lshl_add_u32 v101, v102, 5, v101
    s_waitcnt lgkmcnt(0)
    v_pk_add_f32 v[0:1], v[0:1], v[32:33]
    v_pk_add_f32 v[2:3], v[2:3], v[34:35]
    v_pk_add_f32 v[4:5], v[4:5], v[36:37]
    v_pk_add_f32 v[6:7], v[6:7], v[38:39]
    v_pk_add_f32 v[8:9], v[8:9], v[40:41]
    v_pk_add_f32 v[10:11], v[10:11], v[42:43]
    v_pk_add_f32 v[12:13], v[12:13], v[44:45]
    v_pk_add_f32 v[14:15], v[14:15], v[46:47]
    v_cvt_pk_bf16_f32 v48, v0, v1
    v_cvt_pk_bf16_f32 v49, v2, v3
    v_cvt_pk_bf16_f32 v50, v4, v5
    v_cvt_pk_bf16_f32 v51, v6, v7
    v_cvt_pk_bf16_f32 v52, v8, v9
    v_cvt_pk_bf16_f32 v53, v10, v11
    v_cvt_pk_bf16_f32 v54, v12, v13
    v_cvt_pk_bf16_f32 v55, v14, v15
    buffer_store_dwordx4 v[48:51], v101, s[28:31], s56 offen sc1
    buffer_store_dwordx4 v[52:55], v101, s[28:31], s56 offen offset:16 sc1
    s_mov_b32 s20, s14
    s_and_b32 s21, s15, 0xffff
    s_mov_b32 s22, 0x80000
    s_mov_b32 s23, 0x20000
    s_waitcnt vmcnt(0)
    s_barrier
    s_cmp_lg_u32 s42, 11
    s_cbranch_scc1 nopub_38
    v_mov_b32 v120, s45
    v_mov_b32 v121, 0
    s_mov_b64 exec, 1
    buffer_store_dword v120, v121, s[28:31], s74 offen sc1
    s_mov_b64 exec, -1
nopub_38:
    s_waitcnt vmcnt(6)
    s_barrier
    s_add_u32 m0, s60, 0
    s_add_u32 s56, s62, 0
    buffer_load_dwordx4 v111, s[20:23], s56 offen lds
    s_add_u32 m0, s60, 1024
    s_add_u32 s56, s62, 4096
    buffer_load_dwordx4 v111, s[20:23], s56 offen lds
    s_add_u32 m0, s60, 2048
    s_add_u32 s56, s62, 8192
    buffer_load_dwordx4 v111, s[20:23], s56 offen lds
    s_add_u32 m0, s60, 3072
    s_add_u32 s56, s62, 12288
    buffer_load_dwordx4 v111, s[20:23], s56 offen lds
    s_add_u32 m0, s60, 16384
    s_add_u32 s56, s62, 65536
    buffer_load_dwordx4 v111, s[20:23], s56 offen lds
    s_add_u32 m0, s60, 17408
    s_add_u32 s56, s62, 69632
    buffer_load_dwordx4 v111, s[20:23], s56 offen lds
    s_add_u32 m0, s60, 18432
    s_add_u32 s56, s62, 73728
    buffer_load_dwordx4 v111, s[20:23], s56 offen lds
    s_add_u32 m0, s60, 19456
    s_add_u32 s56, s62, 77824
    buffer_load_dwordx4 v111, s[20:23], s56 offen lds
    s_add_u32 m0, s60, 32768
    s_add_u32 s56, s62, 131072
    buffer_load_dwordx4 v111, s[20:23], s56 offen lds
    s_add_u32 m0, s60, 33792
    s_add_u32 s56, s62, 135168
    buffer_load_dwordx4 v111, s[20:23], s56 offen lds
    s_add_u32 m0, s60, 34816
    s_add_u32 s56, s62, 139264
    buffer_load_dwordx4 v111, s[20:23], s56 offen lds
    s_add_u32 m0, s60, 35840
    s_add_u32 s56, s62, 143360
    buffer_load_dwordx4 v111, s[20:23], s56 offen lds
    s_add_u32 m0, s60, 49152
    s_add_u32 s56, s62, 196608
    buffer_load_dwordx4 v111, s[20:23], s56 offen lds
    s_add_u32 m0, s60, 50176
    s_add_u32 s56, s62, 200704
    buffer_load_dwordx4 v111, s[20:23], s56 offen lds
    s_add_u32 m0, s60, 51200
    s_add_u32 s56, s62, 204800
    buffer_load_dwordx4 v111, s[20:23], s56 offen lds
    s_add_u32 m0, s60, 52224
    s_add_u32 s56, s62, 208896
    buffer_load_dwordx4 v111, s[20:23], s56 offen lds
    s_waitcnt vmcnt(18)
    s_barrier
    s_add_u32 m0, s60, 65536
    s_add_u32 s56, s62, 262144
    buffer_load_dwordx4 v111, s[20:23], s56 offen lds
    s_add_u32 m0, s60, 66560
    s_add_u32 s56, s62, 266240
    buffer_load_dwordx4 v111, s[20:23], s56 offen lds
    s_add_u32 m0, s60, 67584
    s_add_u32 s56, s62, 270336
    buffer_load_dwordx4 v111, s[20:23], s56 offen lds
    s_add_u32 m0, s60, 68608
    s_add_u32 s56, s62, 274432
    buffer_load_dwordx4 v111, s[20:23], s56 offen lds
    s_add_u32 m0, s60, 81920
    s_add_u32 s56, s62, 327680
    buffer_load_dwordx4 v111, s[20:23], s56 offen lds
    s_add_u32 m0, s60, 82944
    s_add_u32 s56, s62, 331776
    buffer_load_dwordx4 v111, s[20:23], s56 offen lds
    s_add_u32 m0, s60, 83968
    s_add_u32 s56, s62, 335872
    buffer_load_dwordx4 v111, s[20:23], s56 offen lds
    s_add_u32 m0, s60, 84992
    s_add_u32 s56, s62, 339968
    buffer_load_dwordx4 v111, s[20:23], s56 offen lds
    s_cmp_lg_u32 s42, 11
    s_cbranch_scc1 pollskip_41
    v_lshlrev_b32 v120, 4, v106
    s_mov_b32 s66, 0xffffffff
    s_mov_b32 s67, 0xffffffff
    s_mov_b32 s68, 0
    s_mov_b64 exec, s[66:67]
poll_39:
    buffer_load_dwordx4 v[122:125], v120, s[28:31], s75 offen sc1
    s_waitcnt vmcnt(0)
    v_xor_b32 v122, s45, v122
    v_xor_b32 v123, s45, v123
    v_or_b32 v122, v122, v123
    v_xor_b32 v124, s45, v124
    v_or_b32 v122, v122, v124
    v_xor_b32 v125, s45, v125
    v_or_b32 v122, v122, v125
    v_cmp_ne_u32 vcc, 0, v122
    s_nop 4
    s_cbranch_vccz pollok_40
    s_add_u32 s68, s68, 1
    s_cmp_lt_u32 s68, 16384
    s_cbranch_scc0 pollok_40
    s_sleep 1
    s_branch poll_39
pollok_40:
    s_mov_b64 exec, -1
pollskip_41:
    s_waitcnt vmcnt(0)
    s_barrier
    s_add_u32 m0, s60, 98304
    s_add_u32 s56, s62, 393216
    buffer_load_dwordx4 v111, s[20:23], s56 offen lds
    s_add_u32 m0, s60, 99328
    s_add_u32 s56, s62, 397312
    buffer_load_dwordx4 v111, s[20:23], s56 offen lds
    s_add_u32 m0, s60, 100352
    s_add_u32 s56, s62, 401408
    buffer_load_dwordx4 v111, s[20:23], s56 offen lds
    s_add_u32 m0, s60, 101376
    s_add_u32 s56, s62, 405504
    buffer_load_dwordx4 v111, s[20:23], s56 offen lds
    s_add_u32 m0, s60, 114688
    s_add_u32 s56, s62, 458752
    buffer_load_dwordx4 v111, s[20:23], s56 offen lds
    s_add_u32 m0, s60, 115712
    s_add_u32 s56, s62, 462848
    buffer_load_dwordx4 v111, s[20:23], s56 offen lds
    s_add_u32 m0, s60, 116736
    s_add_u32 s56, s62, 466944
    buffer_load_dwordx4 v111, s[20:23], s56 offen lds
    s_add_u32 m0, s60, 117760
    s_add_u32 s56, s62, 471040
    buffer_load_dwordx4 v111, s[20:23], s56 offen lds
    s_and_b32 s50, s2, 7
    s_lshr_b32 s49, s2, 3
    s_lshr_b32 s49, s49, 2
    s_lshl_b32 s50, s50, 3
    s_add_u32 s46, s50, s49
    s_lshl_b32 s55, s46, 15
    s_add_u32 s55, s55, 0x800000
    s_lshl_b32 s56, s43, 13
    s_add_u32 s55, s55, s56
    s_add_u32 s63, s56, 131072
    v_add_u32 v13, s63, v107
    s_mov_b32 m0, s63
    s_nop 0
    buffer_load_dwordx4 v107, s[28:31], s55 offen offset:0 sc1 lds
    buffer_load_dwordx4 v107, s[28:31], s55 offen offset:1024 sc1 lds
    buffer_load_dwordx4 v107, s[28:31], s55 offen offset:2048 sc1 lds
    buffer_load_dwordx4 v107, s[28:31], s55 offen offset:3072 sc1 lds
    s_add_u32 m0, s63, 4096
    s_add_u32 s57, s55, 4096
    buffer_load_dwordx4 v107, s[28:31], s57 offen offset:0 sc1 lds
    buffer_load_dwordx4 v107, s[28:31], s57 offen offset:1024 sc1 lds
    buffer_load_dwordx4 v107, s[28:31], s57 offen offset:2048 sc1 lds
    buffer_load_dwordx4 v107, s[28:31], s57 offen offset:3072 sc1 lds
    s_waitcnt vmcnt(8)
    s_barrier
    s_mov_b32 s68, 0
opoll_42:
    s_waitcnt vmcnt(0)
    ds_read_b128 v[32:35], v13 offset:0
    ds_read_b128 v[36:39], v13 offset:1024
    ds_read_b128 v[40:43], v13 offset:2048
    ds_read_b128 v[44:47], v13 offset:3072
    ds_read_b128 v[48:51], v13 offset:4096
    ds_read_b128 v[52:55], v13 offset:5120
    ds_read_b128 v[56:59], v13 offset:6144
    ds_read_b128 v[60:63], v13 offset:7168
    s_waitcnt lgkmcnt(0)
    v_max_u32 v14, v32, v33
    v_max3_u32 v14, v14, v34, v35
    v_max3_u32 v14, v14, v36, v37
    v_max3_u32 v14, v14, v38, v39
    v_max3_u32 v14, v14, v40, v41
    v_max3_u32 v14, v14, v42, v43
    v_max3_u32 v14, v14, v44, v45
    v_max3_u32 v14, v14, v46, v47
    v_max3_u32 v14, v14, v48, v49
    v_max3_u32 v14, v14, v50, v51
    v_max3_u32 v14, v14, v52, v53
    v_max3_u32 v14, v14, v54, v55
    v_max3_u32 v14, v14, v56, v57
    v_max3_u32 v14, v14, v58, v59
    v_max3_u32 v14, v14, v60, v61
    v_max3_u32 v14, v14, v62, v63
    v_cmp_eq_u32 vcc, -1, v14
    s_nop 4
    s_cbranch_vccz opoll_ok_43
    s_add_u32 s68, s68, 1
    s_cmp_lt_u32 s68, 16384
    s_cbranch_scc0 opoll_ok_43
    s_mov_b32 m0, s63
    s_nop 0
    buffer_load_dwordx4 v107, s[28:31], s55 offen offset:0 sc1 lds
    buffer_load_dwordx4 v107, s[28:31], s55 offen offset:1024 sc1 lds
    buffer_load_dwordx4 v107, s[28:31], s55 offen offset:2048 sc1 lds
    buffer_load_dwordx4 v107, s[28:31], s55 offen offset:3072 sc1 lds
    s_add_u32 m0, s63, 4096
    s_add_u32 s57, s55, 4096
    buffer_load_dwordx4 v107, s[28:31], s57 offen offset:0 sc1 lds
    buffer_load_dwordx4 v107, s[28:31], s57 offen offset:1024 sc1 lds
    buffer_load_dwordx4 v107, s[28:31], s57 offen offset:2048 sc1 lds
    buffer_load_dwordx4 v107, s[28:31], s57 offen offset:3072 sc1 lds
    s_branch opoll_42
opoll_ok_43:
    s_barrier
    s_lshl_b32 s56, s2, 4
    s_or_b32 s56, s56, s42
    s_cmp_lg_u32 s56, 11
    s_cbranch_scc1 noepoch_44
    s_mov_b32 s56, 0xe00000
    v_mov_b32 v120, s45
    v_mov_b32 v121, 0
    s_mov_b64 exec, 1
    buffer_store_dword v120, v121, s[28:31], s56 offen sc1
    s_mov_b64 exec, -1
noepoch_44:
done_1:
    s_endpgm
.p2align 8
.type fft_tbl,@object
fft_tbl:
.long 0x3f803f80,0x3f803f80,0x3f803f80,0x3f803f80,0x3f7b3f80,0x3f553f6d,0xbe48248d,0xbf0ebec4
.long 0x3f6d3f80,0x3ec43f35,0xbf6dbf80,0xbec4bf35,0x3f553f80,0xbe483ec4,0x3f0ea554,0x3f7b3f6d
.long 0x3f353f80,0xbf35248d,0x3f353f80,0xbf35248d,0x3f0e3f80,0xbf7bbec4,0xbf55248d,0xbe48bf6d
.long 0x3ec43f80,0xbf6dbf35,0xbec4bf80,0x3f6d3f35,0x3e483f80,0xbf0ebf6d,0x3f7ba554,0xbf553ec4
.long 0x248d3f80,0xa554bf80,0x248d3f80,0xa554bf80,0xbe483f80,0x3f0ebf6d,0xbf7b248d,0x3f553ec4
.long 0xbec43f80,0x3f6dbf35,0x3ec4bf80,0xbf6d3f35,0xbf0e3f80,0x3f7bbec4,0x3f55a554,0x3e48bf6d
.long 0xbf353f80,0x3f35a554,0xbf353f80,0x3f35a554,0xbf553f80,0x3e483ec4,0xbf0e248d,0xbf7b3f6d
.long 0xbf6d3f80,0xbec43f35,0x3f6dbf80,0x3ec4bf35,0xbf7b3f80,0xbf553f6d,0x3e48a554,0x3f0ebec4
.long 0xbf803f80,0xbf803f80,0xbf803f80,0xbf803f80,0xbf7b3f80,0xbf553f6d,0x3e48248d,0x3f0ebec4
.long 0xbf6d3f80,0xbec43f35,0x3f6dbf80,0x3ec4bf35,0xbf553f80,0x3e483ec4,0xbf0ea554,0xbf7b3f6d
.long 0xbf353f80,0x3f35248d,0xbf353f80,0x3f35248d,0xbf0e3f80,0x3f7bbec4,0x3f55248d,0x3e48bf6d
.long 0xbec43f80,0x3f6dbf35,0x3ec4bf80,0xbf6d3f35,0xbe483f80,0x3f0ebf6d,0xbf7ba554,0x3f553ec4
.long 0xa5543f80,0x248dbf80,0xa5543f80,0x248dbf80,0x3e483f80,0xbf0ebf6d,0x3f7b248d,0xbf553ec4
.long 0x3ec43f80,0xbf6dbf35,0xbec4bf80,0x3f6d3f35,0x3f0e3f80,0xbf7bbec4,0xbf55a554,0xbe48bf6d
.long 0x3f353f80,0xbf35a554,0x3f353f80,0xbf35a554,0x3f553f80,0xbe483ec4,0x3f0e248d,0x3f7b3f6d
.long 0x3f6d3f80,0x3ec43f35,0xbf6dbf80,0xbec4bf35,0x3f7b3f80,0x3f553f6d,0xbe48a554,0xbf0ebec4
.long 0x3f803f80,0x3f803f80,0x3f803f80,0x3f803f80,0x3f0e3f35,0x3e483ec4,0xbf55bf35,0xbf7bbf6d
.long 0xbec4248d,0xbf6dbf35,0x3ec4a554,0x3f6d3f35,0xbf7bbf35,0xbf0ebf6d,0x3e483f35,0xbf55bec4
.long 0xbf35bf80,0x3f35a554,0xbf35bf80,0x3f35a554,0x3e48bf35,0x3f553f6d,0x3f7b3f35,0xbf0e3ec4
.long 0x3f6da554,0xbec43f35,0xbf6d248d,0x3ec4bf35,0x3f553f35,0xbf7bbec4,0x3f0ebf35,0xbe483f6d
.long 0x248d3f80,0xa554bf80,0x248d3f80,0xa554bf80,0xbf553f35,0x3f7bbec4,0xbf0ebf35,0x3e483f6d
.long 0xbf6d248d,0x3ec43f35,0x3f6da554,0xbec4bf35,0xbe48bf35,0xbf553f6d,0xbf7b3f35,0x3f0e3ec4
.long 0x3f35bf80,0xbf35248d,0x3f35bf80,0xbf35248d,0x3f7bbf35,0x3f0ebf6d,0xbe483f35,0x3f55bec4
.long 0x3ec4a554,0x3f6dbf35,0xbec4248d,0xbf6d3f35,0xbf0e3f35,0xbe483ec4,0x3f55bf35,0x3f7bbf6d
.long 0xbf803f80,0xbf803f80,0xbf803f80,0xbf803f80,0xbf0e3f35,0xbe483ec4,0x3f55bf35,0x3f7bbf6d
.long 0x3ec4248d,0x3f6dbf35,0xbec4a554,0xbf6d3f35,0x3f7bbf35,0x3f0ebf6d,0xbe483f35,0x3f55bec4
.long 0x3f35bf80,0xbf35a554,0x3f35bf80,0xbf35a554,0xbe48bf35,0xbf553f6d,0xbf7b3f35,0x3f0e3ec4
.long 0xbf6da554,0x3ec43f35,0x3f6d248d,0xbec4bf35,0xbf553f35,0x3f7bbec4,0xbf0ebf35,0x3e483f6d
.long 0xa5543f80,0x248dbf80,0xa5543f80,0x248dbf80,0x3f553f35,0xbf7bbec4,0x3f0ebf35,0xbe483f6d
.long 0x3f6d248d,0xbec43f35,0xbf6da554,0x3ec4bf35,0x3e48bf35,0x3f553f6d,0x3f7b3f35,0xbf0e3ec4
.long 0xbf35bf80,0x3f35248d,0xbf35bf80,0x3f35248d,0xbf7bbf35,0xbf0ebf6d,0x3e483f35,0xbf55bec4
.long 0xbec4a554,0xbf6dbf35,0x3ec4248d,0x3f6d3f35,0x3f0e3f35,0x3e483ec4,0xbf55bf35,0xbf7bbf6d
.long 0x0,0x0,0x0,0x0,0x3e480000,0x3f0e3ec4,0x3f7b3f80,0x3f553f6d
.long 0x3ec40000,0x3f6d3f35,0xbec4250d,0xbf6dbf35,0x3f0e0000,0x3f7b3f6d,0xbf55bf80,0x3e48bec4
.long 0x3f350000,0x3f353f80,0x3f350000,0x3f353f80,0x3f550000,0x3e483f6d,0x3f0e3f80,0xbf7bbec4
.long 0x3f6d0000,0xbec43f35,0xbf6d250d,0x3ec4bf35,0x3f7b0000,0xbf553ec4,0xbe48bf80,0x3f0e3f6d
.long 0x3f800000,0xbf80250d,0x3f800000,0xbf80250d,0x3f7b0000,0xbf55bec4,0xbe483f80,0x3f0ebf6d
.long 0x3f6d0000,0xbec4bf35,0xbf6d250d,0x3ec43f35,0x3f550000,0x3e48bf6d,0x3f0ebf80,0xbf7b3ec4
.long 0x3f350000,0x3f35bf80,0x3f350000,0x3f35bf80,0x3f0e0000,0x3f7bbf6d,0xbf553f80,0x3e483ec4
.long 0x3ec40000,0x3f6dbf35,0xbec4250d,0xbf6d3f35,0x3e480000,0x3f0ebec4,0x3f7bbf80,0x3f55bf6d
.long 0x250d0000,0x250d0000,0x250d0000,0x250d0000,0xbe480000,0xbf0e3ec4,0xbf7b3f80,0xbf553f6d
.long 0xbec40000,0xbf6d3f35,0x3ec4250d,0x3f6dbf35,0xbf0e0000,0xbf7b3f6d,0x3f55bf80,0xbe48bec4
.long 0xbf350000,0xbf353f80,0xbf350000,0xbf353f80,0xbf550000,0xbe483f6d,0xbf0e3f80,0x3f7bbec4
.long 0xbf6d0000,0x3ec43f35,0x3f6d250d,0xbec4bf35,0xbf7b0000,0x3f553ec4,0x3e48bf80,0xbf0e3f6d
.long 0xbf800000,0x3f80250d,0xbf800000,0x3f80250d,0xbf7b0000,0x3f55bec4,0x3e483f80,0xbf0ebf6d
.long 0xbf6d0000,0x3ec4bf35,0x3f6d250d,0xbec43f35,0xbf550000,0xbe48bf6d,0xbf0ebf80,0x3f7b3ec4
.long 0xbf350000,0xbf35bf80,0xbf350000,0xbf35bf80,0xbf0e0000,0xbf7bbf6d,0x3f553f80,0xbe483ec4
.long 0xbec40000,0xbf6dbf35,0x3ec4250d,0x3f6d3f35,0xbe480000,0xbf0ebec4,0xbf7bbf80,0xbf55bf6d
.long 0x0,0x0,0x0,0x0,0x3f553f35,0x3f7b3f6d,0x3f0e3f35,0x3e483ec4
.long 0x3f6d3f80,0x3ec43f35,0xbf6dbf80,0xbec4bf35,0x3e483f35,0xbf55bec4,0x3f7b3f35,0x3f0e3f6d
.long 0xbf35250d,0xbf35bf80,0xbf35250d,0xbf35bf80,0xbf7bbf35,0x3f0ebec4,0x3e48bf35,0x3f553f6d
.long 0xbec4bf80,0x3f6d3f35,0x3ec43f80,0xbf6dbf35,0x3f0ebf35,0xbe483f6d,0xbf55bf35,0x3f7b3ec4
.long 0x3f800000,0xbf80250d,0x3f800000,0xbf80250d,0x3f0e3f35,0xbe48bf6d,0xbf553f35,0x3f7bbec4
.long 0xbec43f80,0x3f6dbf35,0x3ec4bf80,0xbf6d3f35,0xbf7b3f35,0x3f0e3ec4,0x3e483f35,0x3f55bf6d
.long 0xbf35250d,0xbf353f80,0xbf35250d,0xbf353f80,0x3e48bf35,0xbf553ec4,0x3f7bbf35,0x3f0ebf6d
.long 0x3f6dbf80,0x3ec4bf35,0xbf6d3f80,0xbec43f35,0x3f55bf35,0x3f7bbf6d,0x3f0ebf35,0x3e48bec4
.long 0x250d0000,0x250d0000,0x250d0000,0x250d0000,0xbf553f35,0xbf7b3f6d,0xbf0e3f35,0xbe483ec4
.long 0xbf6d3f80,0xbec43f35,0x3f6dbf80,0x3ec4bf35,0xbe483f35,0x3f55bec4,0xbf7b3f35,0xbf0e3f6d
.long 0x3f35250d,0x3f35bf80,0x3f35250d,0x3f35bf80,0x3f7bbf35,0xbf0ebec4,0xbe48bf35,0xbf553f6d
.long 0x3ec4bf80,0xbf6d3f35,0xbec43f80,0x3f6dbf35,0xbf0ebf35,0x3e483f6d,0x3f55bf35,0xbf7b3ec4
.long 0xbf800000,0x3f80250d,0xbf800000,0x3f80250d,0xbf0e3f35,0x3e48bf6d,0x3f553f35,0xbf7bbec4
.long 0x3ec43f80,0xbf6dbf35,0xbec4bf80,0x3f6d3f35,0x3f7b3f35,0xbf0e3ec4,0xbe483f35,0xbf55bf6d
.long 0x3f35250d,0x3f353f80,0x3f35250d,0x3f353f80,0xbe48bf35,0x3f553ec4,0xbf7bbf35,0xbf0ebf6d
.long 0xbf6dbf80,0xbec4bf35,0x3f6d3f80,0x3ec43f35,0xbf55bf35,0xbf7bbf6d,0xbf0ebf35,0xbe48bec4
.long 0x3f803f80,0x3f803f80,0x3f803f80,0x3f803f80,0xbf7bbf80,0xbf55bf6d,0x3e48a554,0x3f0e3ec4
.long 0x3f6d3f80,0x3ec43f35,0xbf6dbf80,0xbec4bf35,0xbf55bf80,0x3e48bec4,0xbf0e248d,0xbf7bbf6d
.long 0x3f353f80,0xbf35248d,0x3f353f80,0xbf35248d,0xbf0ebf80,0x3f7b3ec4,0x3f55a554,0x3e483f6d
.long 0x3ec43f80,0xbf6dbf35,0xbec4bf80,0x3f6d3f35,0xbe48bf80,0x3f0e3f6d,0xbf7b248d,0x3f55bec4
.long 0x248d3f80,0xa554bf80,0x248d3f80,0xa554bf80,0x3e48bf80,0xbf0e3f6d,0x3f7ba554,0xbf55bec4
.long 0xbec43f80,0x3f6dbf35,0x3ec4bf80,0xbf6d3f35,0x3f0ebf80,0xbf7b3ec4,0xbf55248d,0xbe483f6d
.long 0xbf353f80,0x3f35a554,0xbf353f80,0x3f35a554,0x3f55bf80,0xbe48bec4,0x3f0ea554,0x3f7bbf6d
.long 0xbf6d3f80,0xbec43f35,0x3f6dbf80,0x3ec4bf35,0x3f7bbf80,0x3f55bf6d,0xbe48248d,0xbf0e3ec4
.long 0xbf803f80,0xbf803f80,0xbf803f80,0xbf803f80,0x3f7bbf80,0x3f55bf6d,0xbe48a554,0xbf0e3ec4
.long 0xbf6d3f80,0xbec43f35,0x3f6dbf80,0x3ec4bf35,0x3f55bf80,0xbe48bec4,0x3f0e248d,0x3f7bbf6d
.long 0xbf353f80,0x3f35248d,0xbf353f80,0x3f35248d,0x3f0ebf80,0xbf7b3ec4,0xbf55a554,0xbe483f6d
.long 0xbec43f80,0x3f6dbf35,0x3ec4bf80,0xbf6d3f35,0x3e48bf80,0xbf0e3f6d,0x3f7b248d,0xbf55bec4
.long 0xa5543f80,0x248dbf80,0xa5543f80,0x248dbf80,0xbe48bf80,0x3f0e3f6d,0xbf7ba554,0x3f55bec4
.long 0x3ec43f80,0xbf6dbf35,0xbec4bf80,0x3f6d3f35,0xbf0ebf80,0x3f7b3ec4,0x3f55248d,0x3e483f6d
.long 0x3f353f80,0xbf35a554,0x3f353f80,0xbf35a554,0xbf55bf80,0x3e48bec4,0xbf0ea554,0xbf7bbf6d
.long 0x3f6d3f80,0x3ec43f35,0xbf6dbf80,0xbec4bf35,0xbf7bbf80,0xbf55bf6d,0x3e48248d,0x3f0e3ec4
.long 0x3f803f80,0x3f803f80,0x3f803f80,0x3f803f80,0xbf0ebf35,0xbe48bec4,0x3f553f35,0x3f7b3f6d
.long 0xbec4248d,0xbf6dbf35,0x3ec4a554,0x3f6d3f35,0x3f7b3f35,0x3f0e3f6d,0xbe48bf35,0x3f553ec4
.long 0xbf35bf80,0x3f35a554,0xbf35bf80,0x3f35a554,0xbe483f35,0xbf55bf6d,0xbf7bbf35,0x3f0ebec4
.long 0x3f6da554,0xbec43f35,0xbf6d248d,0x3ec4bf35,0xbf55bf35,0x3f7b3ec4,0xbf0e3f35,0x3e48bf6d
.long 0x248d3f80,0xa554bf80,0x248d3f80,0xa554bf80,0x3f55bf35,0xbf7b3ec4,0x3f0e3f35,0xbe48bf6d
.long 0xbf6d248d,0x3ec43f35,0x3f6da554,0xbec4bf35,0x3e483f35,0x3f55bf6d,0x3f7bbf35,0xbf0ebec4
.long 0x3f35bf80,0xbf35248d,0x3f35bf80,0xbf35248d,0xbf7b3f35,0xbf0e3f6d,0x3e48bf35,0xbf553ec4
.long 0x3ec4a554,0x3f6dbf35,0xbec4248d,0xbf6d3f35,0x3f0ebf35,0x3e48bec4,0xbf553f35,0xbf7b3f6d
.long 0xbf803f80,0xbf803f80,0xbf803f80,0xbf803f80,0x3f0ebf35,0x3e48bec4,0xbf553f35,0xbf7b3f6d
.long 0x3ec4248d,0x3f6dbf35,0xbec4a554,0xbf6d3f35,0xbf7b3f35,0xbf0e3f6d,0x3e48bf35,0xbf553ec4
.long 0x3f35bf80,0xbf35a554,0x3f35bf80,0xbf35a554,0x3e483f35,0x3f55bf6d,0x3f7bbf35,0xbf0ebec4
.long 0xbf6da554,0x3ec43f35,0x3f6d248d,0xbec4bf35,0x3f55bf35,0xbf7b3ec4,0x3f0e3f35,0xbe48bf6d
.long 0xa5543f80,0x248dbf80,0xa5543f80,0x248dbf80,0xbf55bf35,0x3f7b3ec4,0xbf0e3f35,0x3e48bf6d
.long 0x3f6d248d,0xbec43f35,0xbf6da554,0x3ec4bf35,0xbe483f35,0xbf55bf6d,0xbf7bbf35,0x3f0ebec4
.long 0xbf35bf80,0x3f35248d,0xbf35bf80,0x3f35248d,0x3f7b3f35,0x3f0e3f6d,0xbe48bf35,0x3f553ec4
.long 0xbec4a554,0xbf6dbf35,0x3ec4248d,0x3f6d3f35,0xbf0ebf35,0xbe48bec4,0x3f553f35,0x3f7b3f6d
.long 0x0,0x0,0x0,0x0,0xbe48250d,0xbf0ebec4,0xbf7bbf80,0xbf55bf6d
.long 0x3ec40000,0x3f6d3f35,0xbec4250d,0xbf6dbf35,0xbf0e250d,0xbf7bbf6d,0x3f553f80,0xbe483ec4
.long 0x3f350000,0x3f353f80,0x3f350000,0x3f353f80,0xbf55250d,0xbe48bf6d,0xbf0ebf80,0x3f7b3ec4
.long 0x3f6d0000,0xbec43f35,0xbf6d250d,0x3ec4bf35,0xbf7b250d,0x3f55bec4,0x3e483f80,0xbf0ebf6d
.long 0x3f800000,0xbf80250d,0x3f800000,0xbf80250d,0xbf7b250d,0x3f553ec4,0x3e48bf80,0xbf0e3f6d
.long 0x3f6d0000,0xbec4bf35,0xbf6d250d,0x3ec43f35,0xbf55250d,0xbe483f6d,0xbf0e3f80,0x3f7bbec4
.long 0x3f350000,0x3f35bf80,0x3f350000,0x3f35bf80,0xbf0e250d,0xbf7b3f6d,0x3f55bf80,0xbe48bec4
.long 0x3ec40000,0x3f6dbf35,0xbec4250d,0xbf6d3f35,0xbe48250d,0xbf0e3ec4,0xbf7b3f80,0xbf553f6d
.long 0x250d0000,0x250d0000,0x250d0000,0x250d0000,0x3e48250d,0x3f0ebec4,0x3f7bbf80,0x3f55bf6d
.long 0xbec40000,0xbf6d3f35,0x3ec4250d,0x3f6dbf35,0x3f0e250d,0x3f7bbf6d,0xbf553f80,0x3e483ec4
.long 0xbf350000,0xbf353f80,0xbf350000,0xbf353f80,0x3f55250d,0x3e48bf6d,0x3f0ebf80,0xbf7b3ec4
.long 0xbf6d0000,0x3ec43f35,0x3f6d250d,0xbec4bf35,0x3f7b250d,0xbf55bec4,0xbe483f80,0x3f0ebf6d
.long 0xbf800000,0x3f80250d,0xbf800000,0x3f80250d,0x3f7b250d,0xbf553ec4,0xbe48bf80,0x3f0e3f6d
.long 0xbf6d0000,0x3ec4bf35,0x3f6d250d,0xbec43f35,0x3f55250d,0x3e483f6d,0x3f0e3f80,0xbf7bbec4
.long 0xbf350000,0xbf35bf80,0xbf350000,0xbf35bf80,0x3f0e250d,0x3f7b3f6d,0xbf55bf80,0x3e48bec4
.long 0xbec40000,0xbf6dbf35,0x3ec4250d,0x3f6d3f35,0x3e48250d,0x3f0e3ec4,0x3f7b3f80,0x3f553f6d
.long 0x0,0x0,0x0,0x0,0xbf55bf35,0xbf7bbf6d,0xbf0ebf35,0xbe48bec4
.long 0x3f6d3f80,0x3ec43f35,0xbf6dbf80,0xbec4bf35,0xbe48bf35,0x3f553ec4,0xbf7bbf35,0xbf0ebf6d
.long 0xbf35250d,0xbf35bf80,0xbf35250d,0xbf35bf80,0x3f7b3f35,0xbf0e3ec4,0xbe483f35,0xbf55bf6d
.long 0xbec4bf80,0x3f6d3f35,0x3ec43f80,0xbf6dbf35,0xbf0e3f35,0x3e48bf6d,0x3f553f35,0xbf7bbec4
.long 0x3f800000,0xbf80250d,0x3f800000,0xbf80250d,0xbf0ebf35,0x3e483f6d,0x3f55bf35,0xbf7b3ec4
.long 0xbec43f80,0x3f6dbf35,0x3ec4bf80,0xbf6d3f35,0x3f7bbf35,0xbf0ebec4,0xbe48bf35,0xbf553f6d
.long 0xbf35250d,0xbf353f80,0xbf35250d,0xbf353f80,0xbe483f35,0x3f55bec4,0xbf7b3f35,0xbf0e3f6d
.long 0x3f6dbf80,0x3ec4bf35,0xbf6d3f80,0xbec43f35,0xbf553f35,0xbf7b3f6d,0xbf0e3f35,0xbe483ec4
.long 0x250d0000,0x250d0000,0x250d0000,0x250d0000,0x3f55bf35,0x3f7bbf6d,0x3f0ebf35,0x3e48bec4
.long 0xbf6d3f80,0xbec43f35,0x3f6dbf80,0x3ec4bf35,0x3e48bf35,0xbf553ec4,0x3f7bbf35,0x3f0ebf6d
.long 0x3f35250d,0x3f35bf80,0x3f35250d,0x3f35bf80,0xbf7b3f35,0x3f0e3ec4,0x3e483f35,0x3f55bf6d
.long 0x3ec4bf80,0xbf6d3f35,0xbec43f80,0x3f6dbf35,0x3f0e3f35,0xbe48bf6d,0xbf553f35,0x3f7bbec4
.long 0xbf800000,0x3f80250d,0xbf800000,0x3f80250d,0x3f0ebf35,0xbe483f6d,0xbf55bf35,0x3f7b3ec4
.long 0x3ec43f80,0xbf6dbf35,0xbec4bf80,0x3f6d3f35,0xbf7bbf35,0x3f0ebec4,0x3e48bf35,0x3f553f6d
.long 0x3f35250d,0x3f353f80,0x3f35250d,0x3f353f80,0x3e483f35,0xbf55bec4,0x3f7b3f35,0x3f0e3f6d
.long 0xbf6dbf80,0xbec4bf35,0x3f6d3f80,0x3ec43f35,0x3f553f35,0x3f7b3f6d,0x3f0e3f35,0x3e483ec4
.long 0x3f803f80,0x3f803f80,0x3f803f80,0x3f803f80,0x3f7b3f80,0x3f553f6d,0xbe48248d,0xbf0ebec4
.long 0x3f6d3f80,0x3ec43f35,0xbf6dbf80,0xbec4bf35,0x3f553f80,0xbe483ec4,0x3f0ea554,0x3f7b3f6d
.long 0xbf803f80,0xbf803f80,0xbf803f80,0xbf803f80,0xbf7b3f80,0xbf553f6d,0x3e48248d,0x3f0ebec4
.long 0xbf6d3f80,0xbec43f35,0x3f6dbf80,0x3ec4bf35,0xbf553f80,0x3e483ec4,0xbf0ea554,0xbf7b3f6d
.long 0x3f353f80,0xbf35248d,0x3f353f80,0xbf35248d,0x3f0e3f80,0xbf7bbec4,0xbf55248d,0xbe48bf6d
.long 0x3ec43f80,0xbf6dbf35,0xbec4bf80,0x3f6d3f35,0x3e483f80,0xbf0ebf6d,0x3f7ba554,0xbf553ec4
.long 0xbf353f80,0x3f35248d,0xbf353f80,0x3f35248d,0xbf0e3f80,0x3f7bbec4,0x3f55248d,0x3e48bf6d
.long 0xbec43f80,0x3f6dbf35,0x3ec4bf80,0xbf6d3f35,0xbe483f80,0x3f0ebf6d,0xbf7ba554,0x3f553ec4
.long 0x248d3f80,0xa554bf80,0x248d3f80,0xa554bf80,0xbe483f80,0x3f0ebf6d,0xbf7b248d,0x3f553ec4
.long 0xbec43f80,0x3f6dbf35,0x3ec4bf80,0xbf6d3f35,0xbf0e3f80,0x3f7bbec4,0x3f55a554,0x3e48bf6d
.long 0xa5543f80,0x248dbf80,0xa5543f80,0x248dbf80,0x3e483f80,0xbf0ebf6d,0x3f7b248d,0xbf553ec4
.long 0x3ec43f80,0xbf6dbf35,0xbec4bf80,0x3f6d3f35,0x3f0e3f80,0xbf7bbec4,0xbf55a554,0xbe48bf6d
.long 0xbf353f80,0x3f35a554,0xbf353f80,0x3f35a554,0xbf553f80,0x3e483ec4,0xbf0e248d,0xbf7b3f6d
.long 0xbf6d3f80,0xbec43f35,0x3f6dbf80,0x3ec4bf35,0xbf7b3f80,0xbf553f6d,0x3e48a554,0x3f0ebec4
.long 0x3f353f80,0xbf35a554,0x3f353f80,0xbf35a554,0x3f553f80,0xbe483ec4,0x3f0e248d,0x3f7b3f6d
.long 0x3f6d3f80,0x3ec43f35,0xbf6dbf80,0xbec4bf35,0x3f7b3f80,0x3f553f6d,0xbe48a554,0xbf0ebec4
.long 0x3f803f80,0x3f803f80,0x3f803f80,0x3f803f80,0x3f0e3f35,0x3e483ec4,0xbf55bf35,0xbf7bbf6d
.long 0xbec4248d,0xbf6dbf35,0x3ec4a554,0x3f6d3f35,0xbf7bbf35,0xbf0ebf6d,0x3e483f35,0xbf55bec4
.long 0xbf803f80,0xbf803f80,0xbf803f80,0xbf803f80,0xbf0e3f35,0xbe483ec4,0x3f55bf35,0x3f7bbf6d
.long 0x3ec4248d,0x3f6dbf35,0xbec4a554,0xbf6d3f35,0x3f7bbf35,0x3f0ebf6d,0xbe483f35,0x3f55bec4
.long 0xbf35bf80,0x3f35a554,0xbf35bf80,0x3f35a554,0x3e48bf35,0x3f553f6d,0x3f7b3f35,0xbf0e3ec4
.long 0x3f6da554,0xbec43f35,0xbf6d248d,0x3ec4bf35,0x3f553f35,0xbf7bbec4,0x3f0ebf35,0xbe483f6d
.long 0x3f35bf80,0xbf35a554,0x3f35bf80,0xbf35a554,0xbe48bf35,0xbf553f6d,0xbf7b3f35,0x3f0e3ec4
.long 0xbf6da554,0x3ec43f35,0x3f6d248d,0xbec4bf35,0xbf553f35,0x3f7bbec4,0xbf0ebf35,0x3e483f6d
.long 0x248d3f80,0xa554bf80,0x248d3f80,0xa554bf80,0xbf553f35,0x3f7bbec4,0xbf0ebf35,0x3e483f6d
.long 0xbf6d248d,0x3ec43f35,0x3f6da554,0xbec4bf35,0xbe48bf35,0xbf553f6d,0xbf7b3f35,0x3f0e3ec4
.long 0xa5543f80,0x248dbf80,0xa5543f80,0x248dbf80,0x3f553f35,0xbf7bbec4,0x3f0ebf35,0xbe483f6d
.long 0x3f6d248d,0xbec43f35,0xbf6da554,0x3ec4bf35,0x3e48bf35,0x3f553f6d,0x3f7b3f35,0xbf0e3ec4
.long 0x3f35bf80,0xbf35248d,0x3f35bf80,0xbf35248d,0x3f7bbf35,0x3f0ebf6d,0xbe483f35,0x3f55bec4
.long 0x3ec4a554,0x3f6dbf35,0xbec4248d,0xbf6d3f35,0xbf0e3f35,0xbe483ec4,0x3f55bf35,0x3f7bbf6d
.long 0xbf35bf80,0x3f35248d,0xbf35bf80,0x3f35248d,0xbf7bbf35,0xbf0ebf6d,0x3e483f35,0xbf55bec4
.long 0xbec4a554,0xbf6dbf35,0x3ec4248d,0x3f6d3f35,0x3f0e3f35,0x3e483ec4,0xbf55bf35,0xbf7bbf6d
.long 0x0,0x0,0x0,0x0,0x3e480000,0x3f0e3ec4,0x3f7b3f80,0x3f553f6d
.long 0x3ec40000,0x3f6d3f35,0xbec4250d,0xbf6dbf35,0x3f0e0000,0x3f7b3f6d,0xbf55bf80,0x3e48bec4
.long 0x250d0000,0x250d0000,0x250d0000,0x250d0000,0xbe480000,0xbf0e3ec4,0xbf7b3f80,0xbf553f6d
.long 0xbec40000,0xbf6d3f35,0x3ec4250d,0x3f6dbf35,0xbf0e0000,0xbf7b3f6d,0x3f55bf80,0xbe48bec4
.long 0x3f350000,0x3f353f80,0x3f350000,0x3f353f80,0x3f550000,0x3e483f6d,0x3f0e3f80,0xbf7bbec4
.long 0x3f6d0000,0xbec43f35,0xbf6d250d,0x3ec4bf35,0x3f7b0000,0xbf553ec4,0xbe48bf80,0x3f0e3f6d
.long 0xbf350000,0xbf353f80,0xbf350000,0xbf353f80,0xbf550000,0xbe483f6d,0xbf0e3f80,0x3f7bbec4
.long 0xbf6d0000,0x3ec43f35,0x3f6d250d,0xbec4bf35,0xbf7b0000,0x3f553ec4,0x3e48bf80,0xbf0e3f6d
.long 0x3f800000,0xbf80250d,0x3f800000,0xbf80250d,0x3f7b0000,0xbf55bec4,0xbe483f80,0x3f0ebf6d
.long 0x3f6d0000,0xbec4bf35,0xbf6d250d,0x3ec43f35,0x3f550000,0x3e48bf6d,0x3f0ebf80,0xbf7b3ec4
.long 0xbf800000,0x3f80250d,0xbf800000,0x3f80250d,0xbf7b0000,0x3f55bec4,0x3e483f80,0xbf0ebf6d
.long 0xbf6d0000,0x3ec4bf35,0x3f6d250d,0xbec43f35,0xbf550000,0xbe48bf6d,0xbf0ebf80,0x3f7b3ec4
.long 0x3f350000,0x3f35bf80,0x3f350000,0x3f35bf80,0x3f0e0000,0x3f7bbf6d,0xbf553f80,0x3e483ec4
.long 0x3ec40000,0x3f6dbf35,0xbec4250d,0xbf6d3f35,0x3e480000,0x3f0ebec4,0x3f7bbf80,0x3f55bf6d
.long 0xbf350000,0xbf35bf80,0xbf350000,0xbf35bf80,0xbf0e0000,0xbf7bbf6d,0x3f553f80,0xbe483ec4
.long 0xbec40000,0xbf6dbf35,0x3ec4250d,0x3f6d3f35,0xbe480000,0xbf0ebec4,0xbf7bbf80,0xbf55bf6d
.long 0x0,0x0,0x0,0x0,0x3f553f35,0x3f7b3f6d,0x3f0e3f35,0x3e483ec4
.long 0x3f6d3f80,0x3ec43f35,0xbf6dbf80,0xbec4bf35,0x3e483f35,0xbf55bec4,0x3f7b3f35,0x3f0e3f6d
.long 0x250d0000,0x250d0000,0x250d0000,0x250d0000,0xbf553f35,0xbf7b3f6d,0xbf0e3f35,0xbe483ec4
.long 0xbf6d3f80,0xbec43f35,0x3f6dbf80,0x3ec4bf35,0xbe483f35,0x3f55bec4,0xbf7b3f35,0xbf0e3f6d
.long 0xbf35250d,0xbf35bf80,0xbf35250d,0xbf35bf80,0xbf7bbf35,0x3f0ebec4,0x3e48bf35,0x3f553f6d
.long 0xbec4bf80,0x3f6d3f35,0x3ec43f80,0xbf6dbf35,0x3f0ebf35,0xbe483f6d,0xbf55bf35,0x3f7b3ec4
.long 0x3f35250d,0x3f35bf80,0x3f35250d,0x3f35bf80,0x3f7bbf35,0xbf0ebec4,0xbe48bf35,0xbf553f6d
.long 0x3ec4bf80,0xbf6d3f35,0xbec43f80,0x3f6dbf35,0xbf0ebf35,0x3e483f6d,0x3f55bf35,0xbf7b3ec4
.long 0x3f800000,0xbf80250d,0x3f800000,0xbf80250d,0x3f0e3f35,0xbe48bf6d,0xbf553f35,0x3f7bbec4
.long 0xbec43f80,0x3f6dbf35,0x3ec4bf80,0xbf6d3f35,0xbf7b3f35,0x3f0e3ec4,0x3e483f35,0x3f55bf6d
.long 0xbf800000,0x3f80250d,0xbf800000,0x3f80250d,0xbf0e3f35,0x3e48bf6d,0x3f553f35,0xbf7bbec4
.long 0x3ec43f80,0xbf6dbf35,0xbec4bf80,0x3f6d3f35,0x3f7b3f35,0xbf0e3ec4,0xbe483f35,0xbf55bf6d
.long 0xbf35250d,0xbf353f80,0xbf35250d,0xbf353f80,0x3e48bf35,0xbf553ec4,0x3f7bbf35,0x3f0ebf6d
.long 0x3f6dbf80,0x3ec4bf35,0xbf6d3f80,0xbec43f35,0x3f55bf35,0x3f7bbf6d,0x3f0ebf35,0x3e48bec4
.long 0x3f35250d,0x3f353f80,0x3f35250d,0x3f353f80,0xbe48bf35,0x3f553ec4,0xbf7bbf35,0xbf0ebf6d
.long 0xbf6dbf80,0xbec4bf35,0x3f6d3f80,0x3ec43f35,0xbf55bf35,0xbf7bbf6d,0xbf0ebf35,0xbe48bec4
.long 0x3f803f80,0x3f803f80,0x3f803f80,0x3f803f80,0xbf7bbf80,0xbf55bf6d,0x3e48a554,0x3f0e3ec4
.long 0x3f6d3f80,0x3ec43f35,0xbf6dbf80,0xbec4bf35,0xbf55bf80,0x3e48bec4,0xbf0e248d,0xbf7bbf6d
.long 0xbf803f80,0xbf803f80,0xbf803f80,0xbf803f80,0x3f7bbf80,0x3f55bf6d,0xbe48a554,0xbf0e3ec4
.long 0xbf6d3f80,0xbec43f35,0x3f6dbf80,0x3ec4bf35,0x3f55bf80,0xbe48bec4,0x3f0e248d,0x3f7bbf6d
.long 0x3f353f80,0xbf35248d,0x3f353f80,0xbf35248d,0xbf0ebf80,0x3f7b3ec4,0x3f55a554,0x3e483f6d
.long 0x3ec43f80,0xbf6dbf35,0xbec4bf80,0x3f6d3f35,0xbe48bf80,0x3f0e3f6d,0xbf7b248d,0x3f55bec4
.long 0xbf353f80,0x3f35248d,0xbf353f80,0x3f35248d,0x3f0ebf80,0xbf7b3ec4,0xbf55a554,0xbe483f6d
.long 0xbec43f80,0x3f6dbf35,0x3ec4bf80,0xbf6d3f35,0x3e48bf80,0xbf0e3f6d,0x3f7b248d,0xbf55bec4
.long 0x248d3f80,0xa554bf80,0x248d3f80,0xa554bf80,0x3e48bf80,0xbf0e3f6d,0x3f7ba554,0xbf55bec4
.long 0xbec43f80,0x3f6dbf35,0x3ec4bf80,0xbf6d3f35,0x3f0ebf80,0xbf7b3ec4,0xbf55248d,0xbe483f6d
.long 0xa5543f80,0x248dbf80,0xa5543f80,0x248dbf80,0xbe48bf80,0x3f0e3f6d,0xbf7ba554,0x3f55bec4
.long 0x3ec43f80,0xbf6dbf35,0xbec4bf80,0x3f6d3f35,0xbf0ebf80,0x3f7b3ec4,0x3f55248d,0x3e483f6d
.long 0xbf353f80,0x3f35a554,0xbf353f80,0x3f35a554,0x3f55bf80,0xbe48bec4,0x3f0ea554,0x3f7bbf6d
.long 0xbf6d3f80,0xbec43f35,0x3f6dbf80,0x3ec4bf35,0x3f7bbf80,0x3f55bf6d,0xbe48248d,0xbf0e3ec4
.long 0x3f353f80,0xbf35a554,0x3f353f80,0xbf35a554,0xbf55bf80,0x3e48bec4,0xbf0ea554,0xbf7bbf6d
.long 0x3f6d3f80,0x3ec43f35,0xbf6dbf80,0xbec4bf35,0xbf7bbf80,0xbf55bf6d,0x3e48248d,0x3f0e3ec4
.long 0x3f803f80,0x3f803f80,0x3f803f80,0x3f803f80,0xbf0ebf35,0xbe48bec4,0x3f553f35,0x3f7b3f6d
.long 0xbec4248d,0xbf6dbf35,0x3ec4a554,0x3f6d3f35,0x3f7b3f35,0x3f0e3f6d,0xbe48bf35,0x3f553ec4
.long 0xbf803f80,0xbf803f80,0xbf803f80,0xbf803f80,0x3f0ebf35,0x3e48bec4,0xbf553f35,0xbf7b3f6d
.long 0x3ec4248d,0x3f6dbf35,0xbec4a554,0xbf6d3f35,0xbf7b3f35,0xbf0e3f6d,0x3e48bf35,0xbf553ec4
.long 0xbf35bf80,0x3f35a554,0xbf35bf80,0x3f35a554,0xbe483f35,0xbf55bf6d,0xbf7bbf35,0x3f0ebec4
.long 0x3f6da554,0xbec43f35,0xbf6d248d,0x3ec4bf35,0xbf55bf35,0x3f7b3ec4,0xbf0e3f35,0x3e48bf6d
.long 0x3f35bf80,0xbf35a554,0x3f35bf80,0xbf35a554,0x3e483f35,0x3f55bf6d,0x3f7bbf35,0xbf0ebec4
.long 0xbf6da554,0x3ec43f35,0x3f6d248d,0xbec4bf35,0x3f55bf35,0xbf7b3ec4,0x3f0e3f35,0xbe48bf6d
.long 0x248d3f80,0xa554bf80,0x248d3f80,0xa554bf80,0x3f55bf35,0xbf7b3ec4,0x3f0e3f35,0xbe48bf6d
.long 0xbf6d248d,0x3ec43f35,0x3f6da554,0xbec4bf35,0x3e483f35,0x3f55bf6d,0x3f7bbf35,0xbf0ebec4
.long 0xa5543f80,0x248dbf80,0xa5543f80,0x248dbf80,0xbf55bf35,0x3f7b3ec4,0xbf0e3f35,0x3e48bf6d
.long 0x3f6d248d,0xbec43f35,0xbf6da554,0x3ec4bf35,0xbe483f35,0xbf55bf6d,0xbf7bbf35,0x3f0ebec4
.long 0x3f35bf80,0xbf35248d,0x3f35bf80,0xbf35248d,0xbf7b3f35,0xbf0e3f6d,0x3e48bf35,0xbf553ec4
.long 0x3ec4a554,0x3f6dbf35,0xbec4248d,0xbf6d3f35,0x3f0ebf35,0x3e48bec4,0xbf553f35,0xbf7b3f6d
.long 0xbf35bf80,0x3f35248d,0xbf35bf80,0x3f35248d,0x3f7b3f35,0x3f0e3f6d,0xbe48bf35,0x3f553ec4
.long 0xbec4a554,0xbf6dbf35,0x3ec4248d,0x3f6d3f35,0xbf0ebf35,0xbe48bec4,0x3f553f35,0x3f7b3f6d
.long 0x0,0x0,0x0,0x0,0xbe48250d,0xbf0ebec4,0xbf7bbf80,0xbf55bf6d
.long 0x3ec40000,0x3f6d3f35,0xbec4250d,0xbf6dbf35,0xbf0e250d,0xbf7bbf6d,0x3f553f80,0xbe483ec4
.long 0x250d0000,0x250d0000,0x250d0000,0x250d0000,0x3e48250d,0x3f0ebec4,0x3f7bbf80,0x3f55bf6d
.long 0xbec40000,0xbf6d3f35,0x3ec4250d,0x3f6dbf35,0x3f0e250d,0x3f7bbf6d,0xbf553f80,0x3e483ec4
.long 0x3f350000,0x3f353f80,0x3f350000,0x3f353f80,0xbf55250d,0xbe48bf6d,0xbf0ebf80,0x3f7b3ec4
.long 0x3f6d0000,0xbec43f35,0xbf6d250d,0x3ec4bf35,0xbf7b250d,0x3f55bec4,0x3e483f80,0xbf0ebf6d
.long 0xbf350000,0xbf353f80,0xbf350000,0xbf353f80,0x3f55250d,0x3e48bf6d,0x3f0ebf80,0xbf7b3ec4
.long 0xbf6d0000,0x3ec43f35,0x3f6d250d,0xbec4bf35,0x3f7b250d,0xbf55bec4,0xbe483f80,0x3f0ebf6d
.long 0x3f800000,0xbf80250d,0x3f800000,0xbf80250d,0xbf7b250d,0x3f553ec4,0x3e48bf80,0xbf0e3f6d
.long 0x3f6d0000,0xbec4bf35,0xbf6d250d,0x3ec43f35,0xbf55250d,0xbe483f6d,0xbf0e3f80,0x3f7bbec4
.long 0xbf800000,0x3f80250d,0xbf800000,0x3f80250d,0x3f7b250d,0xbf553ec4,0xbe48bf80,0x3f0e3f6d
.long 0xbf6d0000,0x3ec4bf35,0x3f6d250d,0xbec43f35,0x3f55250d,0x3e483f6d,0x3f0e3f80,0xbf7bbec4
.long 0x3f350000,0x3f35bf80,0x3f350000,0x3f35bf80,0xbf0e250d,0xbf7b3f6d,0x3f55bf80,0xbe48bec4
.long 0x3ec40000,0x3f6dbf35,0xbec4250d,0xbf6d3f35,0xbe48250d,0xbf0e3ec4,0xbf7b3f80,0xbf553f6d
.long 0xbf350000,0xbf35bf80,0xbf350000,0xbf35bf80,0x3f0e250d,0x3f7b3f6d,0xbf55bf80,0x3e48bec4
.long 0xbec40000,0xbf6dbf35,0x3ec4250d,0x3f6d3f35,0x3e48250d,0x3f0e3ec4,0x3f7b3f80,0x3f553f6d
.long 0x0,0x0,0x0,0x0,0xbf55bf35,0xbf7bbf6d,0xbf0ebf35,0xbe48bec4
.long 0x3f6d3f80,0x3ec43f35,0xbf6dbf80,0xbec4bf35,0xbe48bf35,0x3f553ec4,0xbf7bbf35,0xbf0ebf6d
.long 0x250d0000,0x250d0000,0x250d0000,0x250d0000,0x3f55bf35,0x3f7bbf6d,0x3f0ebf35,0x3e48bec4
.long 0xbf6d3f80,0xbec43f35,0x3f6dbf80,0x3ec4bf35,0x3e48bf35,0xbf553ec4,0x3f7bbf35,0x3f0ebf6d
.long 0xbf35250d,0xbf35bf80,0xbf35250d,0xbf35bf80,0x3f7b3f35,0xbf0e3ec4,0xbe483f35,0xbf55bf6d
.long 0xbec4bf80,0x3f6d3f35,0x3ec43f80,0xbf6dbf35,0xbf0e3f35,0x3e48bf6d,0x3f553f35,0xbf7bbec4
.long 0x3f35250d,0x3f35bf80,0x3f35250d,0x3f35bf80,0xbf7b3f35,0x3f0e3ec4,0x3e483f35,0x3f55bf6d
.long 0x3ec4bf80,0xbf6d3f35,0xbec43f80,0x3f6dbf35,0x3f0e3f35,0xbe48bf6d,0xbf553f35,0x3f7bbec4
.long 0x3f800000,0xbf80250d,0x3f800000,0xbf80250d,0xbf0ebf35,0x3e483f6d,0x3f55bf35,0xbf7b3ec4
.long 0xbec43f80,0x3f6dbf35,0x3ec4bf80,0xbf6d3f35,0x3f7bbf35,0xbf0ebec4,0xbe48bf35,0xbf553f6d
.long 0xbf800000,0x3f80250d,0xbf800000,0x3f80250d,0x3f0ebf35,0xbe483f6d,0xbf55bf35,0x3f7b3ec4
.long 0x3ec43f80,0xbf6dbf35,0xbec4bf80,0x3f6d3f35,0xbf7bbf35,0x3f0ebec4,0x3e48bf35,0x3f553f6d
.long 0xbf35250d,0xbf353f80,0xbf35250d,0xbf353f80,0xbe483f35,0x3f55bec4,0xbf7b3f35,0xbf0e3f6d
.long 0x3f6dbf80,0x3ec4bf35,0xbf6d3f80,0xbec43f35,0xbf553f35,0xbf7b3f6d,0xbf0e3f35,0xbe483ec4
.long 0x3f35250d,0x3f353f80,0x3f35250d,0x3f353f80,0x3e483f35,0xbf55bec4,0x3f7b3f35,0x3f0e3f6d
.long 0xbf6dbf80,0xbec4bf35,0x3f6d3f80,0x3ec43f35,0x3f553f35,0x3f7b3f6d,0x3f0e3f35,0x3e483ec4
.long 0x3f803f80,0x3f803f80,0x3f803f80,0x3f803f80,0x3f7b3f80,0x3f553f6d,0xbe48248d,0xbf0ebec4
.long 0x3f6d3f80,0x3ec43f35,0xbf6dbf80,0xbec4bf35,0x3f553f80,0xbe483ec4,0x3f0ea554,0x3f7b3f6d
.long 0xbf803f80,0xbf803f80,0xbf803f80,0xbf803f80,0xbf7b3f80,0xbf553f6d,0x3e48248d,0x3f0ebec4
.long 0xbf6d3f80,0xbec43f35,0x3f6dbf80,0x3ec4bf35,0xbf553f80,0x3e483ec4,0xbf0ea554,0xbf7b3f6d
.long 0x3f353f80,0xbf35248d,0x3f353f80,0xbf35248d,0x3f0e3f80,0xbf7bbec4,0xbf55248d,0xbe48bf6d
.long 0x3ec43f80,0xbf6dbf35,0xbec4bf80,0x3f6d3f35,0x3e483f80,0xbf0ebf6d,0x3f7ba554,0xbf553ec4
.long 0xbf353f80,0x3f35248d,0xbf353f80,0x3f35248d,0xbf0e3f80,0x3f7bbec4,0x3f55248d,0x3e48bf6d
.long 0xbec43f80,0x3f6dbf35,0x3ec4bf80,0xbf6d3f35,0xbe483f80,0x3f0ebf6d,0xbf7ba554,0x3f553ec4
.long 0x248d3f80,0xa554bf80,0x248d3f80,0xa554bf80,0xbe483f80,0x3f0ebf6d,0xbf7b248d,0x3f553ec4
.long 0xbec43f80,0x3f6dbf35,0x3ec4bf80,0xbf6d3f35,0xbf0e3f80,0x3f7bbec4,0x3f55a554,0x3e48bf6d
.long 0xa5543f80,0x248dbf80,0xa5543f80,0x248dbf80,0x3e483f80,0xbf0ebf6d,0x3f7b248d,0xbf553ec4
.long 0x3ec43f80,0xbf6dbf35,0xbec4bf80,0x3f6d3f35,0x3f0e3f80,0xbf7bbec4,0xbf55a554,0xbe48bf6d
.long 0xbf353f80,0x3f35a554,0xbf353f80,0x3f35a554,0xbf553f80,0x3e483ec4,0xbf0e248d,0xbf7b3f6d
.long 0xbf6d3f80,0xbec43f35,0x3f6dbf80,0x3ec4bf35,0xbf7b3f80,0xbf553f6d,0x3e48a554,0x3f0ebec4
.long 0x3f353f80,0xbf35a554,0x3f353f80,0xbf35a554,0x3f553f80,0xbe483ec4,0x3f0e248d,0x3f7b3f6d
.long 0x3f6d3f80,0x3ec43f35,0xbf6dbf80,0xbec4bf35,0x3f7b3f80,0x3f553f6d,0xbe48a554,0xbf0ebec4
.long 0x3f803f80,0x3f803f80,0x3f803f80,0x3f803f80,0x3f0e3f35,0x3e483ec4,0xbf55bf35,0xbf7bbf6d
.long 0xbec4248d,0xbf6dbf35,0x3ec4a554,0x3f6d3f35,0xbf7bbf35,0xbf0ebf6d,0x3e483f35,0xbf55bec4
.long 0xbf803f80,0xbf803f80,0xbf803f80,0xbf803f80,0xbf0e3f35,0xbe483ec4,0x3f55bf35,0x3f7bbf6d
.long 0x3ec4248d,0x3f6dbf35,0xbec4a554,0xbf6d3f35,0x3f7bbf35,0x3f0ebf6d,0xbe483f35,0x3f55bec4
.long 0xbf35bf80,0x3f35a554,0xbf35bf80,0x3f35a554,0x3e48bf35,0x3f553f6d,0x3f7b3f35,0xbf0e3ec4
.long 0x3f6da554,0xbec43f35,0xbf6d248d,0x3ec4bf35,0x3f553f35,0xbf7bbec4,0x3f0ebf35,0xbe483f6d
.long 0x3f35bf80,0xbf35a554,0x3f35bf80,0xbf35a554,0xbe48bf35,0xbf553f6d,0xbf7b3f35,0x3f0e3ec4
.long 0xbf6da554,0x3ec43f35,0x3f6d248d,0xbec4bf35,0xbf553f35,0x3f7bbec4,0xbf0ebf35,0x3e483f6d
.long 0x248d3f80,0xa554bf80,0x248d3f80,0xa554bf80,0xbf553f35,0x3f7bbec4,0xbf0ebf35,0x3e483f6d
.long 0xbf6d248d,0x3ec43f35,0x3f6da554,0xbec4bf35,0xbe48bf35,0xbf553f6d,0xbf7b3f35,0x3f0e3ec4
.long 0xa5543f80,0x248dbf80,0xa5543f80,0x248dbf80,0x3f553f35,0xbf7bbec4,0x3f0ebf35,0xbe483f6d
.long 0x3f6d248d,0xbec43f35,0xbf6da554,0x3ec4bf35,0x3e48bf35,0x3f553f6d,0x3f7b3f35,0xbf0e3ec4
.long 0x3f35bf80,0xbf35248d,0x3f35bf80,0xbf35248d,0x3f7bbf35,0x3f0ebf6d,0xbe483f35,0x3f55bec4
.long 0x3ec4a554,0x3f6dbf35,0xbec4248d,0xbf6d3f35,0xbf0e3f35,0xbe483ec4,0x3f55bf35,0x3f7bbf6d
.long 0xbf35bf80,0x3f35248d,0xbf35bf80,0x3f35248d,0xbf7bbf35,0xbf0ebf6d,0x3e483f35,0xbf55bec4
.long 0xbec4a554,0xbf6dbf35,0x3ec4248d,0x3f6d3f35,0x3f0e3f35,0x3e483ec4,0xbf55bf35,0xbf7bbf6d
.long 0x0,0x0,0x0,0x0,0x3e480000,0x3f0e3ec4,0x3f7b3f80,0x3f553f6d
.long 0x3ec40000,0x3f6d3f35,0xbec4250d,0xbf6dbf35,0x3f0e0000,0x3f7b3f6d,0xbf55bf80,0x3e48bec4
.long 0x250d0000,0x250d0000,0x250d0000,0x250d0000,0xbe480000,0xbf0e3ec4,0xbf7b3f80,0xbf553f6d
.long 0xbec40000,0xbf6d3f35,0x3ec4250d,0x3f6dbf35,0xbf0e0000,0xbf7b3f6d,0x3f55bf80,0xbe48bec4
.long 0x3f350000,0x3f353f80,0x3f350000,0x3f353f80,0x3f550000,0x3e483f6d,0x3f0e3f80,0xbf7bbec4
.long 0x3f6d0000,0xbec43f35,0xbf6d250d,0x3ec4bf35,0x3f7b0000,0xbf553ec4,0xbe48bf80,0x3f0e3f6d
.long 0xbf350000,0xbf353f80,0xbf350000,0xbf353f80,0xbf550000,0xbe483f6d,0xbf0e3f80,0x3f7bbec4
.long 0xbf6d0000,0x3ec43f35,0x3f6d250d,0xbec4bf35,0xbf7b0000,0x3f553ec4,0x3e48bf80,0xbf0e3f6d
.long 0x3f800000,0xbf80250d,0x3f800000,0xbf80250d,0x3f7b0000,0xbf55bec4,0xbe483f80,0x3f0ebf6d
.long 0x3f6d0000,0xbec4bf35,0xbf6d250d,0x3ec43f35,0x3f550000,0x3e48bf6d,0x3f0ebf80,0xbf7b3ec4
.long 0xbf800000,0x3f80250d,0xbf800000,0x3f80250d,0xbf7b0000,0x3f55bec4,0x3e483f80,0xbf0ebf6d
.long 0xbf6d0000,0x3ec4bf35,0x3f6d250d,0xbec43f35,0xbf550000,0xbe48bf6d,0xbf0ebf80,0x3f7b3ec4
.long 0x3f350000,0x3f35bf80,0x3f350000,0x3f35bf80,0x3f0e0000,0x3f7bbf6d,0xbf553f80,0x3e483ec4
.long 0x3ec40000,0x3f6dbf35,0xbec4250d,0xbf6d3f35,0x3e480000,0x3f0ebec4,0x3f7bbf80,0x3f55bf6d
.long 0xbf350000,0xbf35bf80,0xbf350000,0xbf35bf80,0xbf0e0000,0xbf7bbf6d,0x3f553f80,0xbe483ec4
.long 0xbec40000,0xbf6dbf35,0x3ec4250d,0x3f6d3f35,0xbe480000,0xbf0ebec4,0xbf7bbf80,0xbf55bf6d
.long 0x0,0x0,0x0,0x0,0x3f553f35,0x3f7b3f6d,0x3f0e3f35,0x3e483ec4
.long 0x3f6d3f80,0x3ec43f35,0xbf6dbf80,0xbec4bf35,0x3e483f35,0xbf55bec4,0x3f7b3f35,0x3f0e3f6d
.long 0x250d0000,0x250d0000,0x250d0000,0x250d0000,0xbf553f35,0xbf7b3f6d,0xbf0e3f35,0xbe483ec4
.long 0xbf6d3f80,0xbec43f35,0x3f6dbf80,0x3ec4bf35,0xbe483f35,0x3f55bec4,0xbf7b3f35,0xbf0e3f6d
.long 0xbf35250d,0xbf35bf80,0xbf35250d,0xbf35bf80,0xbf7bbf35,0x3f0ebec4,0x3e48bf35,0x3f553f6d
.long 0xbec4bf80,0x3f6d3f35,0x3ec43f80,0xbf6dbf35,0x3f0ebf35,0xbe483f6d,0xbf55bf35,0x3f7b3ec4
.long 0x3f35250d,0x3f35bf80,0x3f35250d,0x3f35bf80,0x3f7bbf35,0xbf0ebec4,0xbe48bf35,0xbf553f6d
.long 0x3ec4bf80,0xbf6d3f35,0xbec43f80,0x3f6dbf35,0xbf0ebf35,0x3e483f6d,0x3f55bf35,0xbf7b3ec4
.long 0x3f800000,0xbf80250d,0x3f800000,0xbf80250d,0x3f0e3f35,0xbe48bf6d,0xbf553f35,0x3f7bbec4
.long 0xbec43f80,0x3f6dbf35,0x3ec4bf80,0xbf6d3f35,0xbf7b3f35,0x3f0e3ec4,0x3e483f35,0x3f55bf6d
.long 0xbf800000,0x3f80250d,0xbf800000,0x3f80250d,0xbf0e3f35,0x3e48bf6d,0x3f553f35,0xbf7bbec4
.long 0x3ec43f80,0xbf6dbf35,0xbec4bf80,0x3f6d3f35,0x3f7b3f35,0xbf0e3ec4,0xbe483f35,0xbf55bf6d
.long 0xbf35250d,0xbf353f80,0xbf35250d,0xbf353f80,0x3e48bf35,0xbf553ec4,0x3f7bbf35,0x3f0ebf6d
.long 0x3f6dbf80,0x3ec4bf35,0xbf6d3f80,0xbec43f35,0x3f55bf35,0x3f7bbf6d,0x3f0ebf35,0x3e48bec4
.long 0x3f35250d,0x3f353f80,0x3f35250d,0x3f353f80,0xbe48bf35,0x3f553ec4,0xbf7bbf35,0xbf0ebf6d
.long 0xbf6dbf80,0xbec4bf35,0x3f6d3f80,0x3ec43f35,0xbf55bf35,0xbf7bbf6d,0xbf0ebf35,0xbe48bec4
.long 0x3f803f80,0x3f803f80,0x3f803f80,0x3f803f80,0xbf7bbf80,0xbf55bf6d,0x3e48a554,0x3f0e3ec4
.long 0x3f6d3f80,0x3ec43f35,0xbf6dbf80,0xbec4bf35,0xbf55bf80,0x3e48bec4,0xbf0e248d,0xbf7bbf6d
.long 0xbf803f80,0xbf803f80,0xbf803f80,0xbf803f80,0x3f7bbf80,0x3f55bf6d,0xbe48a554,0xbf0e3ec4
.long 0xbf6d3f80,0xbec43f35,0x3f6dbf80,0x3ec4bf35,0x3f55bf80,0xbe48bec4,0x3f0e248d,0x3f7bbf6d
.long 0x3f353f80,0xbf35248d,0x3f353f80,0xbf35248d,0xbf0ebf80,0x3f7b3ec4,0x3f55a554,0x3e483f6d
.long 0x3ec43f80,0xbf6dbf35,0xbec4bf80,0x3f6d3f35,0xbe48bf80,0x3f0e3f6d,0xbf7b248d,0x3f55bec4
.long 0xbf353f80,0x3f35248d,0xbf353f80,0x3f35248d,0x3f0ebf80,0xbf7b3ec4,0xbf55a554,0xbe483f6d
.long 0xbec43f80,0x3f6dbf35,0x3ec4bf80,0xbf6d3f35,0x3e48bf80,0xbf0e3f6d,0x3f7b248d,0xbf55bec4
.long 0x248d3f80,0xa554bf80,0x248d3f80,0xa554bf80,0x3e48bf80,0xbf0e3f6d,0x3f7ba554,0xbf55bec4
.long 0xbec43f80,0x3f6dbf35,0x3ec4bf80,0xbf6d3f35,0x3f0ebf80,0xbf7b3ec4,0xbf55248d,0xbe483f6d
.long 0xa5543f80,0x248dbf80,0xa5543f80,0x248dbf80,0xbe48bf80,0x3f0e3f6d,0xbf7ba554,0x3f55bec4
.long 0x3ec43f80,0xbf6dbf35,0xbec4bf80,0x3f6d3f35,0xbf0ebf80,0x3f7b3ec4,0x3f55248d,0x3e483f6d
.long 0xbf353f80,0x3f35a554,0xbf353f80,0x3f35a554,0x3f55bf80,0xbe48bec4,0x3f0ea554,0x3f7bbf6d
.long 0xbf6d3f80,0xbec43f35,0x3f6dbf80,0x3ec4bf35,0x3f7bbf80,0x3f55bf6d,0xbe48248d,0xbf0e3ec4
.long 0x3f353f80,0xbf35a554,0x3f353f80,0xbf35a554,0xbf55bf80,0x3e48bec4,0xbf0ea554,0xbf7bbf6d
.long 0x3f6d3f80,0x3ec43f35,0xbf6dbf80,0xbec4bf35,0xbf7bbf80,0xbf55bf6d,0x3e48248d,0x3f0e3ec4
.long 0x3f803f80,0x3f803f80,0x3f803f80,0x3f803f80,0xbf0ebf35,0xbe48bec4,0x3f553f35,0x3f7b3f6d
.long 0xbec4248d,0xbf6dbf35,0x3ec4a554,0x3f6d3f35,0x3f7b3f35,0x3f0e3f6d,0xbe48bf35,0x3f553ec4
.long 0xbf803f80,0xbf803f80,0xbf803f80,0xbf803f80,0x3f0ebf35,0x3e48bec4,0xbf553f35,0xbf7b3f6d
.long 0x3ec4248d,0x3f6dbf35,0xbec4a554,0xbf6d3f35,0xbf7b3f35,0xbf0e3f6d,0x3e48bf35,0xbf553ec4
.long 0xbf35bf80,0x3f35a554,0xbf35bf80,0x3f35a554,0xbe483f35,0xbf55bf6d,0xbf7bbf35,0x3f0ebec4
.long 0x3f6da554,0xbec43f35,0xbf6d248d,0x3ec4bf35,0xbf55bf35,0x3f7b3ec4,0xbf0e3f35,0x3e48bf6d
.long 0x3f35bf80,0xbf35a554,0x3f35bf80,0xbf35a554,0x3e483f35,0x3f55bf6d,0x3f7bbf35,0xbf0ebec4
.long 0xbf6da554,0x3ec43f35,0x3f6d248d,0xbec4bf35,0x3f55bf35,0xbf7b3ec4,0x3f0e3f35,0xbe48bf6d
.long 0x248d3f80,0xa554bf80,0x248d3f80,0xa554bf80,0x3f55bf35,0xbf7b3ec4,0x3f0e3f35,0xbe48bf6d
.long 0xbf6d248d,0x3ec43f35,0x3f6da554,0xbec4bf35,0x3e483f35,0x3f55bf6d,0x3f7bbf35,0xbf0ebec4
.long 0xa5543f80,0x248dbf80,0xa5543f80,0x248dbf80,0xbf55bf35,0x3f7b3ec4,0xbf0e3f35,0x3e48bf6d
.long 0x3f6d248d,0xbec43f35,0xbf6da554,0x3ec4bf35,0xbe483f35,0xbf55bf6d,0xbf7bbf35,0x3f0ebec4
.long 0x3f35bf80,0xbf35248d,0x3f35bf80,0xbf35248d,0xbf7b3f35,0xbf0e3f6d,0x3e48bf35,0xbf553ec4
.long 0x3ec4a554,0x3f6dbf35,0xbec4248d,0xbf6d3f35,0x3f0ebf35,0x3e48bec4,0xbf553f35,0xbf7b3f6d
.long 0xbf35bf80,0x3f35248d,0xbf35bf80,0x3f35248d,0x3f7b3f35,0x3f0e3f6d,0xbe48bf35,0x3f553ec4
.long 0xbec4a554,0xbf6dbf35,0x3ec4248d,0x3f6d3f35,0xbf0ebf35,0xbe48bec4,0x3f553f35,0x3f7b3f6d
.long 0x0,0x0,0x0,0x0,0xbe48250d,0xbf0ebec4,0xbf7bbf80,0xbf55bf6d
.long 0x3ec40000,0x3f6d3f35,0xbec4250d,0xbf6dbf35,0xbf0e250d,0xbf7bbf6d,0x3f553f80,0xbe483ec4
.long 0x250d0000,0x250d0000,0x250d0000,0x250d0000,0x3e48250d,0x3f0ebec4,0x3f7bbf80,0x3f55bf6d
.long 0xbec40000,0xbf6d3f35,0x3ec4250d,0x3f6dbf35,0x3f0e250d,0x3f7bbf6d,0xbf553f80,0x3e483ec4
.long 0x3f350000,0x3f353f80,0x3f350000,0x3f353f80,0xbf55250d,0xbe48bf6d,0xbf0ebf80,0x3f7b3ec4
.long 0x3f6d0000,0xbec43f35,0xbf6d250d,0x3ec4bf35,0xbf7b250d,0x3f55bec4,0x3e483f80,0xbf0ebf6d
.long 0xbf350000,0xbf353f80,0xbf350000,0xbf353f80,0x3f55250d,0x3e48bf6d,0x3f0ebf80,0xbf7b3ec4
.long 0xbf6d0000,0x3ec43f35,0x3f6d250d,0xbec4bf35,0x3f7b250d,0xbf55bec4,0xbe483f80,0x3f0ebf6d
.long 0x3f800000,0xbf80250d,0x3f800000,0xbf80250d,0xbf7b250d,0x3f553ec4,0x3e48bf80,0xbf0e3f6d
.long 0x3f6d0000,0xbec4bf35,0xbf6d250d,0x3ec43f35,0xbf55250d,0xbe483f6d,0xbf0e3f80,0x3f7bbec4
.long 0xbf800000,0x3f80250d,0xbf800000,0x3f80250d,0x3f7b250d,0xbf553ec4,0xbe48bf80,0x3f0e3f6d
.long 0xbf6d0000,0x3ec4bf35,0x3f6d250d,0xbec43f35,0x3f55250d,0x3e483f6d,0x3f0e3f80,0xbf7bbec4
.long 0x3f350000,0x3f35bf80,0x3f350000,0x3f35bf80,0xbf0e250d,0xbf7b3f6d,0x3f55bf80,0xbe48bec4
.long 0x3ec40000,0x3f6dbf35,0xbec4250d,0xbf6d3f35,0xbe48250d,0xbf0e3ec4,0xbf7b3f80,0xbf553f6d
.long 0xbf350000,0xbf35bf80,0xbf350000,0xbf35bf80,0x3f0e250d,0x3f7b3f6d,0xbf55bf80,0x3e48bec4
.long 0xbec40000,0xbf6dbf35,0x3ec4250d,0x3f6d3f35,0x3e48250d,0x3f0e3ec4,0x3f7b3f80,0x3f553f6d
.long 0x0,0x0,0x0,0x0,0xbf55bf35,0xbf7bbf6d,0xbf0ebf35,0xbe48bec4
.long 0x3f6d3f80,0x3ec43f35,0xbf6dbf80,0xbec4bf35,0xbe48bf35,0x3f553ec4,0xbf7bbf35,0xbf0ebf6d
.long 0x250d0000,0x250d0000,0x250d0000,0x250d0000,0x3f55bf35,0x3f7bbf6d,0x3f0ebf35,0x3e48bec4
.long 0xbf6d3f80,0xbec43f35,0x3f6dbf80,0x3ec4bf35,0x3e48bf35,0xbf553ec4,0x3f7bbf35,0x3f0ebf6d
.long 0xbf35250d,0xbf35bf80,0xbf35250d,0xbf35bf80,0x3f7b3f35,0xbf0e3ec4,0xbe483f35,0xbf55bf6d
.long 0xbec4bf80,0x3f6d3f35,0x3ec43f80,0xbf6dbf35,0xbf0e3f35,0x3e48bf6d,0x3f553f35,0xbf7bbec4
.long 0x3f35250d,0x3f35bf80,0x3f35250d,0x3f35bf80,0xbf7b3f35,0x3f0e3ec4,0x3e483f35,0x3f55bf6d
.long 0x3ec4bf80,0xbf6d3f35,0xbec43f80,0x3f6dbf35,0x3f0e3f35,0xbe48bf6d,0xbf553f35,0x3f7bbec4
.long 0x3f800000,0xbf80250d,0x3f800000,0xbf80250d,0xbf0ebf35,0x3e483f6d,0x3f55bf35,0xbf7b3ec4
.long 0xbec43f80,0x3f6dbf35,0x3ec4bf80,0xbf6d3f35,0x3f7bbf35,0xbf0ebec4,0xbe48bf35,0xbf553f6d
.long 0xbf800000,0x3f80250d,0xbf800000,0x3f80250d,0x3f0ebf35,0xbe483f6d,0xbf55bf35,0x3f7b3ec4
.long 0x3ec43f80,0xbf6dbf35,0xbec4bf80,0x3f6d3f35,0xbf7bbf35,0x3f0ebec4,0x3e48bf35,0x3f553f6d
.long 0xbf35250d,0xbf353f80,0xbf35250d,0xbf353f80,0xbe483f35,0x3f55bec4,0xbf7b3f35,0xbf0e3f6d
.long 0x3f6dbf80,0x3ec4bf35,0xbf6d3f80,0xbec43f35,0xbf553f35,0xbf7b3f6d,0xbf0e3f35,0xbe483ec4
.long 0x3f35250d,0x3f353f80,0x3f35250d,0x3f353f80,0x3e483f35,0xbf55bec4,0x3f7b3f35,0x3f0e3f6d
.long 0xbf6dbf80,0xbec4bf35,0x3f6d3f80,0x3ec43f35,0x3f553f35,0x3f7b3f6d,0x3f0e3f35,0x3e483ec4
.long 0x3f7f3f80,0x3f753f7b,0x3f223f35,0x3ef13f0e,0x3f753f80,0x3f223f55,0xbf62bf35,0xbf7fbf7b
.long 0x3f623f80,0x3dc93f0e,0xbe95bf35,0x3f223e48,0x3f463f80,0xbef13e48,0x3f7f3f35,0x3e953f55
.long 0xbf7f3f80,0xbf753f7b,0xbf223f35,0xbef13f0e,0xbf753f80,0xbf223f55,0x3f62bf35,0x3f7fbf7b
.long 0xbf623f80,0xbdc93f0e,0x3e95bf35,0xbf223e48,0xbf463f80,0x3ef13e48,0xbf7f3f35,0xbe953f55
.long 0x3f223f80,0xbf62be48,0xbdc93f35,0xbf75bf55,0x3ef13f80,0xbf7fbf0e,0xbf75bf35,0x3f46be48
.long 0x3e953f80,0xbf46bf55,0x3ef1bf35,0x3dc93f7b,0x3dc93f80,0xbe95bf7b,0x3f463f35,0xbf62bf0e
.long 0xbf223f80,0x3f62be48,0x3dc93f35,0x3f75bf55,0xbef13f80,0x3f7fbf0e,0x3f75bf35,0xbf46be48
.long 0xbe953f80,0x3f46bf55,0xbef1bf35,0xbdc93f7b,0xbdc93f80,0x3e95bf7b,0xbf463f35,0x3f62bf0e
.long 0xbdc93f80,0x3e95bf7b,0xbf463f35,0x3f62bf0e,0xbe953f80,0x3f46bf55,0xbef1bf35,0xbdc93f7b
.long 0xbef13f80,0x3f7fbf0e,0x3f75bf35,0xbf46be48,0xbf223f80,0x3f62be48,0x3dc93f35,0x3f75bf55
.long 0x3dc93f80,0xbe95bf7b,0x3f463f35,0xbf62bf0e,0x3e953f80,0xbf46bf55,0x3ef1bf35,0x3dc93f7b
.long 0x3ef13f80,0xbf7fbf0e,0xbf75bf35,0x3f46be48,0x3f223f80,0xbf62be48,0xbdc93f35,0xbf75bf55
.long 0xbf463f80,0x3ef13e48,0xbf7f3f35,0xbe953f55,0xbf623f80,0xbdc93f0e,0x3e95bf35,0xbf223e48
.long 0xbf753f80,0xbf223f55,0x3f62bf35,0x3f7fbf7b,0xbf7f3f80,0xbf753f7b,0xbf223f35,0xbef13f0e
.long 0x3f463f80,0xbef13e48,0x3f7f3f35,0x3e953f55,0x3f623f80,0x3dc93f0e,0xbe95bf35,0x3f223e48
.long 0x3f753f80,0x3f223f55,0xbf62bf35,0xbf7fbf7b,0x3f7f3f80,0x3f753f7b,0x3f223f35,0x3ef13f0e
.long 0x3f623f6d,0x3f463f55,0x3e953ec4,0x3dc93e48,0x3dc93ec4,0xbef1be48,0xbf46bf6d,0xbe95bf0e
.long 0xbf46bec4,0xbf75bf7b,0x3f7f3f6d,0x3ef13f55,0xbf75bf6d,0x3dc9bf0e,0xbf62bec4,0xbf22bf7b
.long 0xbf623f6d,0xbf463f55,0xbe953ec4,0xbdc93e48,0xbdc93ec4,0x3ef1be48,0x3f46bf6d,0x3e95bf0e
.long 0x3f46bec4,0x3f75bf7b,0xbf7f3f6d,0xbef13f55,0x3f75bf6d,0xbdc9bf0e,0x3f62bec4,0x3f22bf7b
.long 0xbe95bf6d,0x3f7f3f0e,0x3ef1bec4,0x3f463f7b,0x3f22bec4,0x3e953f7b,0x3dc93f6d,0xbf62bf55
.long 0x3f7f3ec4,0xbf623e48,0xbf22bf6d,0x3f753f0e,0x3ef13f6d,0xbf22bf55,0x3f753ec4,0xbf7fbe48
.long 0x3e95bf6d,0xbf7f3f0e,0xbef1bec4,0xbf463f7b,0xbf22bec4,0xbe953f7b,0xbdc93f6d,0x3f62bf55
.long 0xbf7f3ec4,0x3f623e48,0x3f22bf6d,0xbf753f0e,0xbef13f6d,0x3f22bf55,0xbf753ec4,0x3f7fbe48
.long 0xbef13f6d,0x3f22bf55,0xbf753ec4,0x3f7fbe48,0xbf7f3ec4,0x3f623e48,0x3f22bf6d,0xbf753f0e
.long 0xbf22bec4,0xbe953f7b,0xbdc93f6d,0x3f62bf55,0x3e95bf6d,0xbf7f3f0e,0xbef1bec4,0xbf463f7b
.long 0x3ef13f6d,0xbf22bf55,0x3f753ec4,0xbf7fbe48,0x3f7f3ec4,0xbf623e48,0xbf22bf6d,0x3f753f0e
.long 0x3f22bec4,0x3e953f7b,0x3dc93f6d,0xbf62bf55,0xbe95bf6d,0x3f7f3f0e,0x3ef1bec4,0x3f463f7b
.long 0x3f75bf6d,0xbdc9bf0e,0x3f62bec4,0x3f22bf7b,0x3f46bec4,0x3f75bf7b,0xbf7f3f6d,0xbef13f55
.long 0xbdc93ec4,0x3ef1be48,0x3f46bf6d,0x3e95bf0e,0xbf623f6d,0xbf463f55,0xbe953ec4,0xbdc93e48
.long 0xbf75bf6d,0x3dc9bf0e,0xbf62bec4,0xbf22bf7b,0xbf46bec4,0xbf75bf7b,0x3f7f3f6d,0x3ef13f55
.long 0x3dc93ec4,0xbef1be48,0xbf46bf6d,0xbe95bf0e,0x3f623f6d,0x3f463f55,0x3e953ec4,0x3dc93e48
.long 0x3dc90000,0x3e953e48,0x3f463f35,0x3f623f55,0x3e950000,0x3f463f0e,0x3ef13f35,0xbdc93e48
.long 0x3ef10000,0x3f7f3f55,0xbf75bf35,0xbf46bf7b,0x3f220000,0x3f623f7b,0xbdc9bf35,0x3f753f0e
.long 0xbdc90000,0xbe953e48,0xbf463f35,0xbf623f55,0xbe950000,0xbf463f0e,0xbef13f35,0x3dc93e48
.long 0xbef10000,0xbf7f3f55,0x3f75bf35,0x3f46bf7b,0xbf220000,0xbf623f7b,0x3dc9bf35,0xbf753f0e
.long 0x3f460000,0x3ef13f7b,0x3f7f3f35,0xbe953f0e,0x3f620000,0xbdc93f55,0xbe953f35,0xbf22bf7b
.long 0x3f750000,0xbf223f0e,0xbf62bf35,0x3f7f3e48,0x3f7f0000,0xbf753e48,0x3f22bf35,0xbef13f55
.long 0xbf460000,0xbef13f7b,0xbf7f3f35,0x3e953f0e,0xbf620000,0x3dc93f55,0x3e953f35,0x3f22bf7b
.long 0xbf750000,0x3f223f0e,0x3f62bf35,0xbf7f3e48,0xbf7f0000,0x3f753e48,0xbf22bf35,0x3ef13f55
.long 0x3f7f0000,0xbf75be48,0x3f223f35,0xbef1bf55,0x3f750000,0xbf22bf0e,0xbf623f35,0x3f7fbe48
.long 0x3f620000,0xbdc9bf55,0xbe95bf35,0xbf223f7b,0x3f460000,0x3ef1bf7b,0x3f7fbf35,0xbe95bf0e
.long 0xbf7f0000,0x3f75be48,0xbf223f35,0x3ef1bf55,0xbf750000,0x3f22bf0e,0x3f623f35,0xbf7fbe48
.long 0xbf620000,0x3dc9bf55,0x3e95bf35,0x3f223f7b,0xbf460000,0xbef1bf7b,0xbf7fbf35,0x3e95bf0e
.long 0x3f220000,0x3f62bf7b,0xbdc93f35,0x3f75bf0e,0x3ef10000,0x3f7fbf55,0xbf753f35,0xbf463f7b
.long 0x3e950000,0x3f46bf0e,0x3ef1bf35,0xbdc9be48,0x3dc90000,0x3e95be48,0x3f46bf35,0x3f62bf55
.long 0xbf220000,0xbf62bf7b,0x3dc93f35,0xbf75bf0e,0xbef10000,0xbf7fbf55,0x3f753f35,0x3f463f7b
.long 0xbe950000,0xbf46bf0e,0xbef1bf35,0x3dc9be48,0xbdc90000,0xbe95be48,0xbf46bf35,0xbf62bf55
.long 0x3ef13ec4,0x3f223f0e,0x3f753f6d,0x3f7f3f7b,0x3f7f3f6d,0x3f623f7b,0xbf22bec4,0xbf75bf55
.long 0x3f223f6d,0xbe953e48,0x3dc9bec4,0x3f623f0e,0xbe953ec4,0xbf7fbf55,0x3ef13f6d,0xbf46be48
.long 0xbef13ec4,0xbf223f0e,0xbf753f6d,0xbf7f3f7b,0xbf7f3f6d,0xbf623f7b,0x3f22bec4,0x3f75bf55
.long 0xbf223f6d,0x3e953e48,0xbdc9bec4,0xbf623f0e,0x3e953ec4,0x3f7fbf55,0xbef13f6d,0x3f46be48
.long 0xbf75bec4,0xbdc9bf55,0xbf62bf6d,0x3f22be48,0xbf46bf6d,0x3f753e48,0x3f7f3ec4,0xbef13f0e
.long 0x3dc9bf6d,0x3ef13f7b,0xbf463ec4,0x3e95bf55,0x3f62bec4,0xbf463f0e,0x3e95bf6d,0xbdc93f7b
.long 0x3f75bec4,0x3dc9bf55,0x3f62bf6d,0xbf22be48,0x3f46bf6d,0xbf753e48,0xbf7f3ec4,0x3ef13f0e
.long 0xbdc9bf6d,0xbef13f7b,0x3f463ec4,0xbe95bf55,0xbf62bec4,0x3f463f0e,0xbe95bf6d,0x3dc93f7b
.long 0x3f623ec4,0xbf46bf0e,0x3e953f6d,0xbdc9bf7b,0x3dc93f6d,0x3ef1bf7b,0xbf46bec4,0x3e953f55
.long 0xbf463f6d,0x3f75be48,0x3f7fbec4,0xbef1bf0e,0xbf753ec4,0xbdc93f55,0xbf623f6d,0x3f223e48
.long 0xbf623ec4,0x3f46bf0e,0xbe953f6d,0x3dc9bf7b,0xbdc93f6d,0xbef1bf7b,0x3f46bec4,0xbe953f55
.long 0x3f463f6d,0xbf75be48,0xbf7fbec4,0x3ef1bf0e,0x3f753ec4,0x3dc93f55,0x3f623f6d,0xbf223e48
.long 0xbe95bec4,0xbf7f3f55,0x3ef1bf6d,0xbf463e48,0x3f22bf6d,0xbe95be48,0x3dc93ec4,0x3f62bf0e
.long 0x3f7fbf6d,0x3f62bf7b,0xbf223ec4,0xbf753f55,0x3ef1bec4,0x3f22bf0e,0x3f75bf6d,0x3f7fbf7b
.long 0x3e95bec4,0x3f7f3f55,0xbef1bf6d,0x3f463e48,0xbf22bf6d,0x3e95be48,0xbdc93ec4,0xbf62bf0e
.long 0xbf7fbf6d,0xbf62bf7b,0x3f223ec4,0x3f753f55,0xbef1bec4,0xbf22bf0e,0xbf75bf6d,0xbf7fbf7b
.long 0xbdc9248d,0xbe95be48,0xbf46bf35,0xbf62bf55,0x3e95a554,0x3f463f0e,0x3ef13f35,0xbdc93e48
.long 0xbef1248d,0xbf7fbf55,0x3f753f35,0x3f463f7b,0x3f22a554,0x3f623f7b,0xbdc9bf35,0x3f753f0e
.long 0x3dc9248d,0x3e95be48,0x3f46bf35,0x3f62bf55,0xbe95a554,0xbf463f0e,0xbef13f35,0x3dc93e48
.long 0x3ef1248d,0x3f7fbf55,0xbf753f35,0xbf463f7b,0xbf22a554,0xbf623f7b,0x3dc9bf35,0xbf753f0e
.long 0xbf46248d,0xbef1bf7b,0xbf7fbf35,0x3e95bf0e,0x3f62a554,0xbdc93f55,0xbe953f35,0xbf22bf7b
.long 0xbf75248d,0x3f22bf0e,0x3f623f35,0xbf7fbe48,0x3f7fa554,0xbf753e48,0x3f22bf35,0xbef13f55
.long 0x3f46248d,0x3ef1bf7b,0x3f7fbf35,0xbe95bf0e,0xbf62a554,0x3dc93f55,0x3e953f35,0x3f22bf7b
.long 0x3f75248d,0xbf22bf0e,0xbf623f35,0x3f7fbe48,0xbf7fa554,0x3f753e48,0xbf22bf35,0x3ef13f55
.long 0xbf7f248d,0x3f753e48,0xbf22bf35,0x3ef13f55,0x3f75a554,0xbf22bf0e,0xbf623f35,0x3f7fbe48
.long 0xbf62248d,0x3dc93f55,0x3e953f35,0x3f22bf7b,0x3f46a554,0x3ef1bf7b,0x3f7fbf35,0xbe95bf0e
.long 0x3f7f248d,0xbf753e48,0x3f22bf35,0xbef13f55,0xbf75a554,0x3f22bf0e,0x3f623f35,0xbf7fbe48
.long 0x3f62248d,0xbdc93f55,0xbe953f35,0xbf22bf7b,0xbf46a554,0xbef1bf7b,0xbf7fbf35,0x3e95bf0e
.long 0xbf22248d,0xbf623f7b,0x3dc9bf35,0xbf753f0e,0x3ef1a554,0x3f7fbf55,0xbf753f35,0xbf463f7b
.long 0xbe95248d,0xbf463f0e,0xbef13f35,0x3dc93e48,0x3dc9a554,0x3e95be48,0x3f46bf35,0x3f62bf55
.long 0x3f22248d,0x3f623f7b,0xbdc9bf35,0x3f753f0e,0xbef1a554,0xbf7fbf55,0x3f753f35,0x3f463f7b
.long 0x3e95248d,0x3f463f0e,0x3ef13f35,0xbdc93e48,0xbdc9a554,0xbe95be48,0xbf46bf35,0xbf62bf55
.long 0xbef1bec4,0xbf22bf0e,0xbf75bf6d,0xbf7fbf7b,0x3f7f3f6d,0x3f623f7b,0xbf22bec4,0xbf75bf55
.long 0xbf22bf6d,0x3e95be48,0xbdc93ec4,0xbf62bf0e,0xbe953ec4,0xbf7fbf55,0x3ef13f6d,0xbf46be48
.long 0x3ef1bec4,0x3f22bf0e,0x3f75bf6d,0x3f7fbf7b,0xbf7f3f6d,0xbf623f7b,0x3f22bec4,0x3f75bf55
.long 0x3f22bf6d,0xbe95be48,0x3dc93ec4,0x3f62bf0e,0x3e953ec4,0x3f7fbf55,0xbef13f6d,0x3f46be48
.long 0x3f753ec4,0x3dc93f55,0x3f623f6d,0xbf223e48,0xbf46bf6d,0x3f753e48,0x3f7f3ec4,0xbef13f0e
.long 0xbdc93f6d,0xbef1bf7b,0x3f46bec4,0xbe953f55,0x3f62bec4,0xbf463f0e,0x3e95bf6d,0xbdc93f7b
.long 0xbf753ec4,0xbdc93f55,0xbf623f6d,0x3f223e48,0x3f46bf6d,0xbf753e48,0xbf7f3ec4,0x3ef13f0e
.long 0x3dc93f6d,0x3ef1bf7b,0xbf46bec4,0x3e953f55,0xbf62bec4,0x3f463f0e,0xbe95bf6d,0x3dc93f7b
.long 0xbf62bec4,0x3f463f0e,0xbe95bf6d,0x3dc93f7b,0x3dc93f6d,0x3ef1bf7b,0xbf46bec4,0x3e953f55
.long 0x3f46bf6d,0xbf753e48,0xbf7f3ec4,0x3ef13f0e,0xbf753ec4,0xbdc93f55,0xbf623f6d,0x3f223e48
.long 0x3f62bec4,0xbf463f0e,0x3e95bf6d,0xbdc93f7b,0xbdc93f6d,0xbef1bf7b,0x3f46bec4,0xbe953f55
.long 0xbf46bf6d,0x3f753e48,0x3f7f3ec4,0xbef13f0e,0x3f753ec4,0x3dc93f55,0x3f623f6d,0xbf223e48
.long 0x3e953ec4,0x3f7fbf55,0xbef13f6d,0x3f46be48,0x3f22bf6d,0xbe95be48,0x3dc93ec4,0x3f62bf0e
.long 0xbf7f3f6d,0xbf623f7b,0x3f22bec4,0x3f75bf55,0x3ef1bec4,0x3f22bf0e,0x3f75bf6d,0x3f7fbf7b
.long 0xbe953ec4,0xbf7fbf55,0x3ef13f6d,0xbf46be48,0xbf22bf6d,0x3e95be48,0xbdc93ec4,0xbf62bf0e
.long 0x3f7f3f6d,0x3f623f7b,0xbf22bec4,0xbf75bf55,0xbef1bec4,0xbf22bf0e,0xbf75bf6d,0xbf7fbf7b
.long 0x3f7f3f80,0x3f753f7b,0x3f223f35,0x3ef13f0e,0xbf75bf80,0xbf22bf55,0x3f623f35,0x3f7f3f7b
.long 0x3f623f80,0x3dc93f0e,0xbe95bf35,0x3f223e48,0xbf46bf80,0x3ef1be48,0xbf7fbf35,0xbe95bf55
.long 0xbf7f3f80,0xbf753f7b,0xbf223f35,0xbef13f0e,0x3f75bf80,0x3f22bf55,0xbf623f35,0xbf7f3f7b
.long 0xbf623f80,0xbdc93f0e,0x3e95bf35,0xbf223e48,0x3f46bf80,0xbef1be48,0x3f7fbf35,0x3e95bf55
.long 0x3f223f80,0xbf62be48,0xbdc93f35,0xbf75bf55,0xbef1bf80,0x3f7f3f0e,0x3f753f35,0xbf463e48
.long 0x3e953f80,0xbf46bf55,0x3ef1bf35,0x3dc93f7b,0xbdc9bf80,0x3e953f7b,0xbf46bf35,0x3f623f0e
.long 0xbf223f80,0x3f62be48,0x3dc93f35,0x3f75bf55,0x3ef1bf80,0xbf7f3f0e,0xbf753f35,0x3f463e48
.long 0xbe953f80,0x3f46bf55,0xbef1bf35,0xbdc93f7b,0x3dc9bf80,0xbe953f7b,0x3f46bf35,0xbf623f0e
.long 0xbdc93f80,0x3e95bf7b,0xbf463f35,0x3f62bf0e,0x3e95bf80,0xbf463f55,0x3ef13f35,0x3dc9bf7b
.long 0xbef13f80,0x3f7fbf0e,0x3f75bf35,0xbf46be48,0x3f22bf80,0xbf623e48,0xbdc9bf35,0xbf753f55
.long 0x3dc93f80,0xbe95bf7b,0x3f463f35,0xbf62bf0e,0xbe95bf80,0x3f463f55,0xbef13f35,0xbdc9bf7b
.long 0x3ef13f80,0xbf7fbf0e,0xbf75bf35,0x3f46be48,0xbf22bf80,0x3f623e48,0x3dc9bf35,0x3f753f55
.long 0xbf463f80,0x3ef13e48,0xbf7f3f35,0xbe953f55,0x3f62bf80,0x3dc9bf0e,0xbe953f35,0x3f22be48
.long 0xbf753f80,0xbf223f55,0x3f62bf35,0x3f7fbf7b,0x3f7fbf80,0x3f75bf7b,0x3f22bf35,0x3ef1bf0e
.long 0x3f463f80,0xbef13e48,0x3f7f3f35,0x3e953f55,0xbf62bf80,0xbdc9bf0e,0x3e953f35,0xbf22be48
.long 0x3f753f80,0x3f223f55,0xbf62bf35,0xbf7fbf7b,0xbf7fbf80,0xbf75bf7b,0xbf22bf35,0xbef1bf0e
.long 0x3f623f6d,0x3f463f55,0x3e953ec4,0x3dc93e48,0xbdc9bec4,0x3ef13e48,0x3f463f6d,0x3e953f0e
.long 0xbf46bec4,0xbf75bf7b,0x3f7f3f6d,0x3ef13f55,0x3f753f6d,0xbdc93f0e,0x3f623ec4,0x3f223f7b
.long 0xbf623f6d,0xbf463f55,0xbe953ec4,0xbdc93e48,0x3dc9bec4,0xbef13e48,0xbf463f6d,0xbe953f0e
.long 0x3f46bec4,0x3f75bf7b,0xbf7f3f6d,0xbef13f55,0xbf753f6d,0x3dc93f0e,0xbf623ec4,0xbf223f7b
.long 0xbe95bf6d,0x3f7f3f0e,0x3ef1bec4,0x3f463f7b,0xbf223ec4,0xbe95bf7b,0xbdc9bf6d,0x3f623f55
.long 0x3f7f3ec4,0xbf623e48,0xbf22bf6d,0x3f753f0e,0xbef1bf6d,0x3f223f55,0xbf75bec4,0x3f7f3e48
.long 0x3e95bf6d,0xbf7f3f0e,0xbef1bec4,0xbf463f7b,0x3f223ec4,0x3e95bf7b,0x3dc9bf6d,0xbf623f55
.long 0xbf7f3ec4,0x3f623e48,0x3f22bf6d,0xbf753f0e,0x3ef1bf6d,0xbf223f55,0x3f75bec4,0xbf7f3e48
.long 0xbef13f6d,0x3f22bf55,0xbf753ec4,0x3f7fbe48,0x3f7fbec4,0xbf62be48,0xbf223f6d,0x3f75bf0e
.long 0xbf22bec4,0xbe953f7b,0xbdc93f6d,0x3f62bf55,0xbe953f6d,0x3f7fbf0e,0x3ef13ec4,0x3f46bf7b
.long 0x3ef13f6d,0xbf22bf55,0x3f753ec4,0xbf7fbe48,0xbf7fbec4,0x3f62be48,0x3f223f6d,0xbf75bf0e
.long 0x3f22bec4,0x3e953f7b,0x3dc93f6d,0xbf62bf55,0x3e953f6d,0xbf7fbf0e,0xbef13ec4,0xbf46bf7b
.long 0x3f75bf6d,0xbdc9bf0e,0x3f62bec4,0x3f22bf7b,0xbf463ec4,0xbf753f7b,0x3f7fbf6d,0x3ef1bf55
.long 0xbdc93ec4,0x3ef1be48,0x3f46bf6d,0x3e95bf0e,0x3f62bf6d,0x3f46bf55,0x3e95bec4,0x3dc9be48
.long 0xbf75bf6d,0x3dc9bf0e,0xbf62bec4,0xbf22bf7b,0x3f463ec4,0x3f753f7b,0xbf7fbf6d,0xbef1bf55
.long 0x3dc93ec4,0xbef1be48,0xbf46bf6d,0xbe95bf0e,0xbf62bf6d,0xbf46bf55,0xbe95bec4,0xbdc9be48
.long 0xbf7fbf80,0xbf75bf7b,0xbf22bf35,0xbef1bf0e,0xbf75bf80,0xbf22bf55,0x3f623f35,0x3f7f3f7b
.long 0xbf62bf80,0xbdc9bf0e,0x3e953f35,0xbf22be48,0xbf46bf80,0x3ef1be48,0xbf7fbf35,0xbe95bf55
.long 0x3f7fbf80,0x3f75bf7b,0x3f22bf35,0x3ef1bf0e,0x3f75bf80,0x3f22bf55,0xbf623f35,0xbf7f3f7b
.long 0x3f62bf80,0x3dc9bf0e,0xbe953f35,0x3f22be48,0x3f46bf80,0xbef1be48,0x3f7fbf35,0x3e95bf55
.long 0xbf22bf80,0x3f623e48,0x3dc9bf35,0x3f753f55,0xbef1bf80,0x3f7f3f0e,0x3f753f35,0xbf463e48
.long 0xbe95bf80,0x3f463f55,0xbef13f35,0xbdc9bf7b,0xbdc9bf80,0x3e953f7b,0xbf46bf35,0x3f623f0e
.long 0x3f22bf80,0xbf623e48,0xbdc9bf35,0xbf753f55,0x3ef1bf80,0xbf7f3f0e,0xbf753f35,0x3f463e48
.long 0x3e95bf80,0xbf463f55,0x3ef13f35,0x3dc9bf7b,0x3dc9bf80,0xbe953f7b,0x3f46bf35,0xbf623f0e
.long 0x3dc9bf80,0xbe953f7b,0x3f46bf35,0xbf623f0e,0x3e95bf80,0xbf463f55,0x3ef13f35,0x3dc9bf7b
.long 0x3ef1bf80,0xbf7f3f0e,0xbf753f35,0x3f463e48,0x3f22bf80,0xbf623e48,0xbdc9bf35,0xbf753f55
.long 0xbdc9bf80,0x3e953f7b,0xbf46bf35,0x3f623f0e,0xbe95bf80,0x3f463f55,0xbef13f35,0xbdc9bf7b
.long 0xbef1bf80,0x3f7f3f0e,0x3f753f35,0xbf463e48,0xbf22bf80,0x3f623e48,0x3dc9bf35,0x3f753f55
.long 0x3f46bf80,0xbef1be48,0x3f7fbf35,0x3e95bf55,0x3f62bf80,0x3dc9bf0e,0xbe953f35,0x3f22be48
.long 0x3f75bf80,0x3f22bf55,0xbf623f35,0xbf7f3f7b,0x3f7fbf80,0x3f75bf7b,0x3f22bf35,0x3ef1bf0e
.long 0xbf46bf80,0x3ef1be48,0xbf7fbf35,0xbe95bf55,0xbf62bf80,0xbdc9bf0e,0x3e953f35,0xbf22be48
.long 0xbf75bf80,0xbf22bf55,0x3f623f35,0x3f7f3f7b,0xbf7fbf80,0xbf75bf7b,0xbf22bf35,0xbef1bf0e
.long 0xbf62bf6d,0xbf46bf55,0xbe95bec4,0xbdc9be48,0xbdc9bec4,0x3ef13e48,0x3f463f6d,0x3e953f0e
.long 0x3f463ec4,0x3f753f7b,0xbf7fbf6d,0xbef1bf55,0x3f753f6d,0xbdc93f0e,0x3f623ec4,0x3f223f7b
.long 0x3f62bf6d,0x3f46bf55,0x3e95bec4,0x3dc9be48,0x3dc9bec4,0xbef13e48,0xbf463f6d,0xbe953f0e
.long 0xbf463ec4,0xbf753f7b,0x3f7fbf6d,0x3ef1bf55,0xbf753f6d,0x3dc93f0e,0xbf623ec4,0xbf223f7b
.long 0x3e953f6d,0xbf7fbf0e,0xbef13ec4,0xbf46bf7b,0xbf223ec4,0xbe95bf7b,0xbdc9bf6d,0x3f623f55
.long 0xbf7fbec4,0x3f62be48,0x3f223f6d,0xbf75bf0e,0xbef1bf6d,0x3f223f55,0xbf75bec4,0x3f7f3e48
.long 0xbe953f6d,0x3f7fbf0e,0x3ef13ec4,0x3f46bf7b,0x3f223ec4,0x3e95bf7b,0x3dc9bf6d,0xbf623f55
.long 0x3f7fbec4,0xbf62be48,0xbf223f6d,0x3f75bf0e,0x3ef1bf6d,0xbf223f55,0x3f75bec4,0xbf7f3e48
.long 0x3ef1bf6d,0xbf223f55,0x3f75bec4,0xbf7f3e48,0x3f7fbec4,0xbf62be48,0xbf223f6d,0x3f75bf0e
.long 0x3f223ec4,0x3e95bf7b,0x3dc9bf6d,0xbf623f55,0xbe953f6d,0x3f7fbf0e,0x3ef13ec4,0x3f46bf7b
.long 0xbef1bf6d,0x3f223f55,0xbf75bec4,0x3f7f3e48,0xbf7fbec4,0x3f62be48,0x3f223f6d,0xbf75bf0e
.long 0xbf223ec4,0xbe95bf7b,0xbdc9bf6d,0x3f623f55,0x3e953f6d,0xbf7fbf0e,0xbef13ec4,0xbf46bf7b
.long 0xbf753f6d,0x3dc93f0e,0xbf623ec4,0xbf223f7b,0xbf463ec4,0xbf753f7b,0x3f7fbf6d,0x3ef1bf55
.long 0x3dc9bec4,0xbef13e48,0xbf463f6d,0xbe953f0e,0x3f62bf6d,0x3f46bf55,0x3e95bec4,0x3dc9be48
.long 0x3f753f6d,0xbdc93f0e,0x3f623ec4,0x3f223f7b,0x3f463ec4,0x3f753f7b,0xbf7fbf6d,0xbef1bf55
.long 0xbdc9bec4,0x3ef13e48,0x3f463f6d,0x3e953f0e,0xbf62bf6d,0xbf46bf55,0xbe95bec4,0xbdc9be48
.long 0xbdc9250d,0xbe95be48,0xbf46bf35,0xbf62bf55,0xbe95250d,0xbf46bf0e,0xbef1bf35,0x3dc9be48
.long 0xbef1250d,0xbf7fbf55,0x3f753f35,0x3f463f7b,0xbf22250d,0xbf62bf7b,0x3dc93f35,0xbf75bf0e
.long 0x3dc9250d,0x3e95be48,0x3f46bf35,0x3f62bf55,0x3e95250d,0x3f46bf0e,0x3ef1bf35,0xbdc9be48
.long 0x3ef1250d,0x3f7fbf55,0xbf753f35,0xbf463f7b,0x3f22250d,0x3f62bf7b,0xbdc93f35,0x3f75bf0e
.long 0xbf46250d,0xbef1bf7b,0xbf7fbf35,0x3e95bf0e,0xbf62250d,0x3dc9bf55,0x3e95bf35,0x3f223f7b
.long 0xbf75250d,0x3f22bf0e,0x3f623f35,0xbf7fbe48,0xbf7f250d,0x3f75be48,0xbf223f35,0x3ef1bf55
.long 0x3f46250d,0x3ef1bf7b,0x3f7fbf35,0xbe95bf0e,0x3f62250d,0xbdc9bf55,0xbe95bf35,0xbf223f7b
.long 0x3f75250d,0xbf22bf0e,0xbf623f35,0x3f7fbe48,0x3f7f250d,0xbf75be48,0x3f223f35,0xbef1bf55
.long 0xbf7f250d,0x3f753e48,0xbf22bf35,0x3ef13f55,0xbf75250d,0x3f223f0e,0x3f62bf35,0xbf7f3e48
.long 0xbf62250d,0x3dc93f55,0x3e953f35,0x3f22bf7b,0xbf46250d,0xbef13f7b,0xbf7f3f35,0x3e953f0e
.long 0x3f7f250d,0xbf753e48,0x3f22bf35,0xbef13f55,0x3f75250d,0xbf223f0e,0xbf62bf35,0x3f7f3e48
.long 0x3f62250d,0xbdc93f55,0xbe953f35,0xbf22bf7b,0x3f46250d,0x3ef13f7b,0x3f7f3f35,0xbe953f0e
.long 0xbf22250d,0xbf623f7b,0x3dc9bf35,0xbf753f0e,0xbef1250d,0xbf7f3f55,0x3f75bf35,0x3f46bf7b
.long 0xbe95250d,0xbf463f0e,0xbef13f35,0x3dc93e48,0xbdc9250d,0xbe953e48,0xbf463f35,0xbf623f55
.long 0x3f22250d,0x3f623f7b,0xbdc9bf35,0x3f753f0e,0x3ef1250d,0x3f7f3f55,0xbf75bf35,0xbf46bf7b
.long 0x3e95250d,0x3f463f0e,0x3ef13f35,0xbdc93e48,0x3dc9250d,0x3e953e48,0x3f463f35,0x3f623f55
.long 0xbef1bec4,0xbf22bf0e,0xbf75bf6d,0xbf7fbf7b,0xbf7fbf6d,0xbf62bf7b,0x3f223ec4,0x3f753f55
.long 0xbf22bf6d,0x3e95be48,0xbdc93ec4,0xbf62bf0e,0x3e95bec4,0x3f7f3f55,0xbef1bf6d,0x3f463e48
.long 0x3ef1bec4,0x3f22bf0e,0x3f75bf6d,0x3f7fbf7b,0x3f7fbf6d,0x3f62bf7b,0xbf223ec4,0xbf753f55
.long 0x3f22bf6d,0xbe95be48,0x3dc93ec4,0x3f62bf0e,0xbe95bec4,0xbf7f3f55,0x3ef1bf6d,0xbf463e48
.long 0x3f753ec4,0x3dc93f55,0x3f623f6d,0xbf223e48,0x3f463f6d,0xbf75be48,0xbf7fbec4,0x3ef1bf0e
.long 0xbdc93f6d,0xbef1bf7b,0x3f46bec4,0xbe953f55,0xbf623ec4,0x3f46bf0e,0xbe953f6d,0x3dc9bf7b
.long 0xbf753ec4,0xbdc93f55,0xbf623f6d,0x3f223e48,0xbf463f6d,0x3f75be48,0x3f7fbec4,0xbef1bf0e
.long 0x3dc93f6d,0x3ef1bf7b,0xbf46bec4,0x3e953f55,0x3f623ec4,0xbf46bf0e,0x3e953f6d,0xbdc9bf7b
.long 0xbf62bec4,0x3f463f0e,0xbe95bf6d,0x3dc93f7b,0xbdc9bf6d,0xbef13f7b,0x3f463ec4,0xbe95bf55
.long 0x3f46bf6d,0xbf753e48,0xbf7f3ec4,0x3ef13f0e,0x3f75bec4,0x3dc9bf55,0x3f62bf6d,0xbf22be48
.long 0x3f62bec4,0xbf463f0e,0x3e95bf6d,0xbdc93f7b,0x3dc9bf6d,0x3ef13f7b,0xbf463ec4,0x3e95bf55
.long 0xbf46bf6d,0x3f753e48,0x3f7f3ec4,0xbef13f0e,0xbf75bec4,0xbdc9bf55,0xbf62bf6d,0x3f22be48
.long 0x3e953ec4,0x3f7fbf55,0xbef13f6d,0x3f46be48,0xbf223f6d,0x3e953e48,0xbdc9bec4,0xbf623f0e
.long 0xbf7f3f6d,0xbf623f7b,0x3f22bec4,0x3f75bf55,0xbef13ec4,0xbf223f0e,0xbf753f6d,0xbf7f3f7b
.long 0xbe953ec4,0xbf7fbf55,0x3ef13f6d,0xbf46be48,0x3f223f6d,0xbe953e48,0x3dc9bec4,0x3f623f0e
.long 0x3f7f3f6d,0x3f623f7b,0xbf22bec4,0xbf75bf55,0x3ef13ec4,0x3f223f0e,0x3f753f6d,0x3f7f3f7b
.long 0x3dc9a554,0x3e953e48,0x3f463f35,0x3f623f55,0xbe95248d,0xbf46bf0e,0xbef1bf35,0x3dc9be48
.long 0x3ef1a554,0x3f7f3f55,0xbf75bf35,0xbf46bf7b,0xbf22248d,0xbf62bf7b,0x3dc93f35,0xbf75bf0e
.long 0xbdc9a554,0xbe953e48,0xbf463f35,0xbf623f55,0x3e95248d,0x3f46bf0e,0x3ef1bf35,0xbdc9be48
.long 0xbef1a554,0xbf7f3f55,0x3f75bf35,0x3f46bf7b,0x3f22248d,0x3f62bf7b,0xbdc93f35,0x3f75bf0e
.long 0x3f46a554,0x3ef13f7b,0x3f7f3f35,0xbe953f0e,0xbf62248d,0x3dc9bf55,0x3e95bf35,0x3f223f7b
.long 0x3f75a554,0xbf223f0e,0xbf62bf35,0x3f7f3e48,0xbf7f248d,0x3f75be48,0xbf223f35,0x3ef1bf55
.long 0xbf46a554,0xbef13f7b,0xbf7f3f35,0x3e953f0e,0x3f62248d,0xbdc9bf55,0xbe95bf35,0xbf223f7b
.long 0xbf75a554,0x3f223f0e,0x3f62bf35,0xbf7f3e48,0x3f7f248d,0xbf75be48,0x3f223f35,0xbef1bf55
.long 0x3f7fa554,0xbf75be48,0x3f223f35,0xbef1bf55,0xbf75248d,0x3f223f0e,0x3f62bf35,0xbf7f3e48
.long 0x3f62a554,0xbdc9bf55,0xbe95bf35,0xbf223f7b,0xbf46248d,0xbef13f7b,0xbf7f3f35,0x3e953f0e
.long 0xbf7fa554,0x3f75be48,0xbf223f35,0x3ef1bf55,0x3f75248d,0xbf223f0e,0xbf62bf35,0x3f7f3e48
.long 0xbf62a554,0x3dc9bf55,0x3e95bf35,0x3f223f7b,0x3f46248d,0x3ef13f7b,0x3f7f3f35,0xbe953f0e
.long 0x3f22a554,0x3f62bf7b,0xbdc93f35,0x3f75bf0e,0xbef1248d,0xbf7f3f55,0x3f75bf35,0x3f46bf7b
.long 0x3e95a554,0x3f46bf0e,0x3ef1bf35,0xbdc9be48,0xbdc9248d,0xbe953e48,0xbf463f35,0xbf623f55
.long 0xbf22a554,0xbf62bf7b,0x3dc93f35,0xbf75bf0e,0x3ef1248d,0x3f7f3f55,0xbf75bf35,0xbf46bf7b
.long 0xbe95a554,0xbf46bf0e,0xbef1bf35,0x3dc9be48,0x3dc9248d,0x3e953e48,0x3f463f35,0x3f623f55
.long 0x3ef13ec4,0x3f223f0e,0x3f753f6d,0x3f7f3f7b,0xbf7fbf6d,0xbf62bf7b,0x3f223ec4,0x3f753f55
.long 0x3f223f6d,0xbe953e48,0x3dc9bec4,0x3f623f0e,0x3e95bec4,0x3f7f3f55,0xbef1bf6d,0x3f463e48
.long 0xbef13ec4,0xbf223f0e,0xbf753f6d,0xbf7f3f7b,0x3f7fbf6d,0x3f62bf7b,0xbf223ec4,0xbf753f55
.long 0xbf223f6d,0x3e953e48,0xbdc9bec4,0xbf623f0e,0xbe95bec4,0xbf7f3f55,0x3ef1bf6d,0xbf463e48
.long 0xbf75bec4,0xbdc9bf55,0xbf62bf6d,0x3f22be48,0x3f463f6d,0xbf75be48,0xbf7fbec4,0x3ef1bf0e
.long 0x3dc9bf6d,0x3ef13f7b,0xbf463ec4,0x3e95bf55,0xbf623ec4,0x3f46bf0e,0xbe953f6d,0x3dc9bf7b
.long 0x3f75bec4,0x3dc9bf55,0x3f62bf6d,0xbf22be48,0xbf463f6d,0x3f75be48,0x3f7fbec4,0xbef1bf0e
.long 0xbdc9bf6d,0xbef13f7b,0x3f463ec4,0xbe95bf55,0x3f623ec4,0xbf46bf0e,0x3e953f6d,0xbdc9bf7b
.long 0x3f623ec4,0xbf46bf0e,0x3e953f6d,0xbdc9bf7b,0xbdc9bf6d,0xbef13f7b,0x3f463ec4,0xbe95bf55
.long 0xbf463f6d,0x3f75be48,0x3f7fbec4,0xbef1bf0e,0x3f75bec4,0x3dc9bf55,0x3f62bf6d,0xbf22be48
.long 0xbf623ec4,0x3f46bf0e,0xbe953f6d,0x3dc9bf7b,0x3dc9bf6d,0x3ef13f7b,0xbf463ec4,0x3e95bf55
.long 0x3f463f6d,0xbf75be48,0xbf7fbec4,0x3ef1bf0e,0xbf75bec4,0xbdc9bf55,0xbf62bf6d,0x3f22be48
.long 0xbe95bec4,0xbf7f3f55,0x3ef1bf6d,0xbf463e48,0xbf223f6d,0x3e953e48,0xbdc9bec4,0xbf623f0e
.long 0x3f7fbf6d,0x3f62bf7b,0xbf223ec4,0xbf753f55,0xbef13ec4,0xbf223f0e,0xbf753f6d,0xbf7f3f7b
.long 0x3e95bec4,0x3f7f3f55,0xbef1bf6d,0x3f463e48,0x3f223f6d,0xbe953e48,0x3dc9bec4,0x3f623f0e
.long 0xbf7fbf6d,0xbf62bf7b,0x3f223ec4,0x3f753f55,0x3ef13ec4,0x3f223f0e,0x3f753f6d,0x3f7f3f7b
.long 0xbf7fbf80,0xbf75bf7b,0xbf22bf35,0xbef1bf0e,0x3f753f80,0x3f223f55,0xbf62bf35,0xbf7fbf7b
.long 0xbf62bf80,0xbdc9bf0e,0x3e953f35,0xbf22be48,0x3f463f80,0xbef13e48,0x3f7f3f35,0x3e953f55
.long 0x3f7fbf80,0x3f75bf7b,0x3f22bf35,0x3ef1bf0e,0xbf753f80,0xbf223f55,0x3f62bf35,0x3f7fbf7b
.long 0x3f62bf80,0x3dc9bf0e,0xbe953f35,0x3f22be48,0xbf463f80,0x3ef13e48,0xbf7f3f35,0xbe953f55
.long 0xbf22bf80,0x3f623e48,0x3dc9bf35,0x3f753f55,0x3ef13f80,0xbf7fbf0e,0xbf75bf35,0x3f46be48
.long 0xbe95bf80,0x3f463f55,0xbef13f35,0xbdc9bf7b,0x3dc93f80,0xbe95bf7b,0x3f463f35,0xbf62bf0e
.long 0x3f22bf80,0xbf623e48,0xbdc9bf35,0xbf753f55,0xbef13f80,0x3f7fbf0e,0x3f75bf35,0xbf46be48
.long 0x3e95bf80,0xbf463f55,0x3ef13f35,0x3dc9bf7b,0xbdc93f80,0x3e95bf7b,0xbf463f35,0x3f62bf0e
.long 0x3dc9bf80,0xbe953f7b,0x3f46bf35,0xbf623f0e,0xbe953f80,0x3f46bf55,0xbef1bf35,0xbdc93f7b
.long 0x3ef1bf80,0xbf7f3f0e,0xbf753f35,0x3f463e48,0xbf223f80,0x3f62be48,0x3dc93f35,0x3f75bf55
.long 0xbdc9bf80,0x3e953f7b,0xbf46bf35,0x3f623f0e,0x3e953f80,0xbf46bf55,0x3ef1bf35,0x3dc93f7b
.long 0xbef1bf80,0x3f7f3f0e,0x3f753f35,0xbf463e48,0x3f223f80,0xbf62be48,0xbdc93f35,0xbf75bf55
.long 0x3f46bf80,0xbef1be48,0x3f7fbf35,0x3e95bf55,0xbf623f80,0xbdc93f0e,0x3e95bf35,0xbf223e48
.long 0x3f75bf80,0x3f22bf55,0xbf623f35,0xbf7f3f7b,0xbf7f3f80,0xbf753f7b,0xbf223f35,0xbef13f0e
.long 0xbf46bf80,0x3ef1be48,0xbf7fbf35,0xbe95bf55,0x3f623f80,0x3dc93f0e,0xbe95bf35,0x3f223e48
.long 0xbf75bf80,0xbf22bf55,0x3f623f35,0x3f7f3f7b,0x3f7f3f80,0x3f753f7b,0x3f223f35,0x3ef13f0e
.long 0xbf62bf6d,0xbf46bf55,0xbe95bec4,0xbdc9be48,0x3dc93ec4,0xbef1be48,0xbf46bf6d,0xbe95bf0e
.long 0x3f463ec4,0x3f753f7b,0xbf7fbf6d,0xbef1bf55,0xbf75bf6d,0x3dc9bf0e,0xbf62bec4,0xbf22bf7b
.long 0x3f62bf6d,0x3f46bf55,0x3e95bec4,0x3dc9be48,0xbdc93ec4,0x3ef1be48,0x3f46bf6d,0x3e95bf0e
.long 0xbf463ec4,0xbf753f7b,0x3f7fbf6d,0x3ef1bf55,0x3f75bf6d,0xbdc9bf0e,0x3f62bec4,0x3f22bf7b
.long 0x3e953f6d,0xbf7fbf0e,0xbef13ec4,0xbf46bf7b,0x3f22bec4,0x3e953f7b,0x3dc93f6d,0xbf62bf55
.long 0xbf7fbec4,0x3f62be48,0x3f223f6d,0xbf75bf0e,0x3ef13f6d,0xbf22bf55,0x3f753ec4,0xbf7fbe48
.long 0xbe953f6d,0x3f7fbf0e,0x3ef13ec4,0x3f46bf7b,0xbf22bec4,0xbe953f7b,0xbdc93f6d,0x3f62bf55
.long 0x3f7fbec4,0xbf62be48,0xbf223f6d,0x3f75bf0e,0xbef13f6d,0x3f22bf55,0xbf753ec4,0x3f7fbe48
.long 0x3ef1bf6d,0xbf223f55,0x3f75bec4,0xbf7f3e48,0xbf7f3ec4,0x3f623e48,0x3f22bf6d,0xbf753f0e
.long 0x3f223ec4,0x3e95bf7b,0x3dc9bf6d,0xbf623f55,0x3e95bf6d,0xbf7f3f0e,0xbef1bec4,0xbf463f7b
.long 0xbef1bf6d,0x3f223f55,0xbf75bec4,0x3f7f3e48,0x3f7f3ec4,0xbf623e48,0xbf22bf6d,0x3f753f0e
.long 0xbf223ec4,0xbe95bf7b,0xbdc9bf6d,0x3f623f55,0xbe95bf6d,0x3f7f3f0e,0x3ef1bec4,0x3f463f7b
.long 0xbf753f6d,0x3dc93f0e,0xbf623ec4,0xbf223f7b,0x3f46bec4,0x3f75bf7b,0xbf7f3f6d,0xbef13f55
.long 0x3dc9bec4,0xbef13e48,0xbf463f6d,0xbe953f0e,0xbf623f6d,0xbf463f55,0xbe953ec4,0xbdc93e48
.long 0x3f753f6d,0xbdc93f0e,0x3f623ec4,0x3f223f7b,0xbf46bec4,0xbf75bf7b,0x3f7f3f6d,0x3ef13f55
.long 0xbdc9bec4,0x3ef13e48,0x3f463f6d,0x3e953f0e,0x3f623f6d,0x3f463f55,0x3e953ec4,0x3dc93e48
.long 0x3f800000,0x3f800000,0x3f800000,0x3f800000,0x3f800000,0x3f7fffb1,0x3f7ffec4,0x3f7ffd39
.long 0x3f800000,0x3f7ffec4,0x3f7ffb11,0x3f7ff4e6,0x3f800000,0x3f7ffd39,0x3f7ff4e6,0x3f7fe705
.long 0x3f800000,0x3f7ffb11,0x3f7fec43,0x3f7fd397,0x3f800000,0x3f7ff84a,0x3f7fe129,0x3f7fba9e
.long 0x3f800000,0x3f7ff4e6,0x3f7fd397,0x3f7f9c18,0x3f800000,0x3f7ff0e3,0x3f7fc38f,0x3f7f7808
.long 0x3f800000,0x3f7fec43,0x3f7fb10f,0x3f7f4e6d,0x3f800000,0x3f7fe705,0x3f7f9c18,0x3f7f1f49
.long 0x3f800000,0x3f7fe129,0x3f7f84ab,0x3f7eea9d,0x3f800000,0x3f7fdaaf,0x3f7f6ac7,0x3f7eb069
.long 0x3f800000,0x3f7fd397,0x3f7f4e6d,0x3f7e70b0,0x3f800000,0x3f7fcbe2,0x3f7f2f9d,0x3f7e2b72
.long 0x3f800000,0x3f7fc38f,0x3f7f0e58,0x3f7de0b1,0x3f800000,0x3f7fba9e,0x3f7eea9d,0x3f7d906e
.long 0x3f800000,0x3f7fb10f,0x3f7ec46d,0x3f7d3aac,0x3f800000,0x3f7fa6e3,0x3f7e9bc9,0x3f7cdf6c
.long 0x3f800000,0x3f7f9c18,0x3f7e70b0,0x3f7c7eb0,0x3f800000,0x3f7f90b1,0x3f7e4323,0x3f7c187a
.long 0x3f800000,0x3f7f84ab,0x3f7e1324,0x3f7baccd,0x3f800000,0x3f7f7808,0x3f7de0b1,0x3f7b3bab
.long 0x3f800000,0x3f7f6ac7,0x3f7dabcc,0x3f7ac516,0x3f800000,0x3f7f5ce9,0x3f7d7474,0x3f7a4910
.long 0x3f800000,0x3f7f4e6d,0x3f7d3aac,0x3f79c79d,0x3f800000,0x3f7f3f54,0x3f7cfe73,0x3f7940c0
.long 0x3f800000,0x3f7f2f9d,0x3f7cbfc9,0x3f78b47b,0x3f800000,0x3f7f1f49,0x3f7c7eb0,0x3f7822d1
.long 0x3f800000,0x3f7f0e58,0x3f7c3b28,0x3f778bc5,0x3f800000,0x3f7efcc9,0x3f7bf531,0x3f76ef5b
.long 0x3f800000,0x3f7eea9d,0x3f7baccd,0x3f764d97,0x3f800000,0x3f7ed7d4,0x3f7b61fc,0x3f75a67b
.long 0x3f800000,0x3f800000,0x3f800000,0x3f800000,0x3f7ffb11,0x3f7ff84a,0x3f7ff4e6,0x3f7ff0e3
.long 0x3f7fec43,0x3f7fe129,0x3f7fd397,0x3f7fc38f,0x3f7fd397,0x3f7fba9e,0x3f7f9c18,0x3f7f7808
.long 0x3f7fb10f,0x3f7f84ab,0x3f7f4e6d,0x3f7f0e58,0x3f7f84ab,0x3f7f3f54,0x3f7eea9d,0x3f7e868b
.long 0x3f7f4e6d,0x3f7eea9d,0x3f7e70b0,0x3f7de0b1,0x3f7f0e58,0x3f7e868b,0x3f7de0b1,0x3f7d1cdd
.long 0x3f7ec46d,0x3f7e1324,0x3f7d3aac,0x3f7c3b28,0x3f7e70b0,0x3f7d906e,0x3f7c7eb0,0x3f7b3bab
.long 0x3f7e1324,0x3f7cfe73,0x3f7baccd,0x3f7a1e84,0x3f7dabcc,0x3f7c5d3a,0x3f7ac516,0x3f78e3d6
.long 0x3f7d3aac,0x3f7baccd,0x3f79c79d,0x3f778bc5,0x3f7cbfc9,0x3f7aed37,0x3f78b47b,0x3f76167a
.long 0x3f7c3b28,0x3f7a1e84,0x3f778bc5,0x3f748422,0x3f7baccd,0x3f7940c0,0x3f764d97,0x3f72d4eb
.long 0x3f7b14be,0x3f7853f8,0x3f74fa0b,0x3f710908,0x3f7a7302,0x3f77583a,0x3f73913f,0x3f6f20b0
.long 0x3f79c79d,0x3f764d97,0x3f721352,0x3f6d1c1d,0x3f791298,0x3f75341d,0x3f708066,0x3f6afb8c
.long 0x3f7853f8,0x3f740bdd,0x3f6ed89e,0x3f68bf3c,0x3f778bc5,0x3f72d4eb,0x3f6d1c1d,0x3f666771
.long 0x3f76ba07,0x3f718f57,0x3f6b4b0c,0x3f63f473,0x3f75dec6,0x3f703b37,0x3f696591,0x3f61668a
.long 0x3f74fa0b,0x3f6ed89e,0x3f676bd8,0x3f5ebe05,0x3f740bdd,0x3f6d67a1,0x3f655e0b,0x3f5bfb34
.long 0x3f731447,0x3f6be858,0x3f633c5a,0x3f591e6a,0x3f721352,0x3f6a5ad9,0x3f6106f2,0x3f5627fe
.long 0x3f710908,0x3f68bf3c,0x3f5ebe05,0x3f531849,0x3f6ff573,0x3f671599,0x3f5c61c7,0x3f4fefa8
.long 0x3f6ed89e,0x3f655e0b,0x3f59f26a,0x3f4cae79,0x3f6db293,0x3f6398ac,0x3f577026,0x3f495521
.long 0x3f800000,0x3f800000,0x3f800000,0x3f800000,0x3f7fec43,0x3f7fe705,0x3f7fe129,0x3f7fdaaf
.long 0x3f7fb10f,0x3f7f9c18,0x3f7f84ab,0x3f7f6ac7,0x3f7f4e6d,0x3f7f1f49,0x3f7eea9d,0x3f7eb069
.long 0x3f7ec46d,0x3f7e70b0,0x3f7e1324,0x3f7dabcc,0x3f7e1324,0x3f7d906e,0x3f7cfe73,0x3f7c5d3a
.long 0x3f7d3aac,0x3f7c7eb0,0x3f7baccd,0x3f7ac516,0x3f7c3b28,0x3f7b3bab,0x3f7a1e84,0x3f78e3d6
.long 0x3f7b14be,0x3f79c79d,0x3f7853f8,0x3f76ba07,0x3f79c79d,0x3f7822d1,0x3f764d97,0x3f74484b
.long 0x3f7853f8,0x3f764d97,0x3f740bdd,0x3f718f57,0x3f76ba07,0x3f74484b,0x3f718f57,0x3f6e8ff8
.long 0x3f74fa0b,0x3f721352,0x3f6ed89e,0x3f6b4b0c,0x3f731447,0x3f6faf1b,0x3f6be858,0x3f67c187
.long 0x3f710908,0x3f6d1c1d,0x3f68bf3c,0x3f63f473,0x3f6ed89e,0x3f6a5ad9,0x3f655e0b,0x3f5fe4e9
.long 0x3f6c835e,0x3f676bd8,0x3f61c598,0x3f5b941a,0x3f6a09a7,0x3f644fac,0x3f5df6be,0x3f570348
.long 0x3f676bd8,0x3f6106f2,0x3f59f26a,0x3f5233c6,0x3f64aa59,0x3f5d924d,0x3f55b993,0x3f4d26fd
.long 0x3f61c598,0x3f59f26a,0x3f514d3d,0x3f47de65,0x3f5ebe05,0x3f5627fe,0x3f4cae79,0x3f425b89
.long 0x3f5b941a,0x3f5233c6,0x3f47de65,0x3f3ca003,0x3f584853,0x3f4e1689,0x3f42de29,0x3f36ad7f
.long 0x3f54db31,0x3f49d112,0x3f3daef9,0x3f3085bb,0x3f514d3d,0x3f456439,0x3f385216,0x3f2a2a80
.long 0x3f4d9f02,0x3f40d0da,0x3f32c8c9,0x3f239da9,0x3f49d112,0x3f3c17d9,0x3f2d1469,0x3f1ce11f
.long 0x3f45e403,0x3f373a23,0x3f273656,0x3f15f6d9,0x3f41d870,0x3f3238aa,0x3f212ff9,0x3f0ee0db
.long 0x3f3daef9,0x3f2d1469,0x3f1b02c6,0x3f07a136,0x3f396842,0x3f27ce61,0x3f14b039,0x3f003a06
.long 0x3f800000,0x3f800000,0x3f800000,0x3f800000,0x3f7fd397,0x3f7fcbe2,0x3f7fc38f,0x3f7fba9e
.long 0x3f7f4e6d,0x3f7f2f9d,0x3f7f0e58,0x3f7eea9d,0x3f7e70b0,0x3f7e2b72,0x3f7de0b1,0x3f7d906e
.long 0x3f7d3aac,0x3f7cbfc9,0x3f7c3b28,0x3f7baccd,0x3f7baccd,0x3f7aed37,0x3f7a1e84,0x3f7940c0
.long 0x3f79c79d,0x3f78b47b,0x3f778bc5,0x3f764d97,0x3f778bc5,0x3f76167a,0x3f748422,0x3f72d4eb
.long 0x3f74fa0b,0x3f731447,0x3f710908,0x3f6ed89e,0x3f721352,0x3f6faf1b,0x3f6d1c1d,0x3f6a5ad9
.long 0x3f6ed89e,0x3f6be858,0x3f68bf3c,0x3f655e0b,0x3f6b4b0c,0x3f67c187,0x3f63f473,0x3f5fe4e9
.long 0x3f676bd8,0x3f633c5a,0x3f5ebe05,0x3f59f26a,0x3f633c5a,0x3f5e5aa6,0x3f591e6a,0x3f5389c7
.long 0x3f5ebe05,0x3f591e6a,0x3f531849,0x3f4cae79,0x3f59f26a,0x3f5389c7,0x3f4cae79,0x3f456439
.long 0x3f54db31,0x3f4d9f02,0x3f45e403,0x3f3daef9,0x3f4f7a1f,0x3f476085,0x3f3ebc1b,0x3f3592e7
.long 0x3f49d112,0x3f40d0da,0x3f373a23,0x3f2d1469,0x3f43e200,0x3f39f2ac,0x3f2f61a5,0x3f24381a
.long 0x3f3daef9,0x3f32c8c9,0x3f273656,0x3f1b02c6,0x3f373a23,0x3f2b561b,0x3f1ebc12,0x3f11796b
.long 0x3f3085bb,0x3f239da9,0x3f15f6d9,0x3f07a136,0x3f299415,0x3f1ba299,0x3f0cead0,0x3efafef7
.long 0x3f226799,0x3f13682a,0x3f039c3d,0x3ee63375,0x3f1b02c6,0x3f0af1b7,0x3ef41f07,0x3ed0eb2a
.long 0x3f13682a,0x3f0242b1,0x3ee0924f,0x3ebb31a0,0x3f0b9a6b,0x3ef2bd43,0x3ecc9b8b,0x3ea5129f
.long 0x3f039c3d,0x3ee0924f,0x3eb8442a,0x3e8e9a22,0x3ef6e0cb,0x3ece0bea,0x3ea395c5,0x3e6fa8b2
.long 0x3ee63375,0x3ebb31a0,0x3e8e9a22,0x3e419b37,0x3ed53641,0x3ea80b1f,0x3e72b651,0x3e1324ca
.long 0x3f800000,0x3f800000,0x3f800000,0x3f800000,0x3f7fb10f,0x3f7fa6e3,0x3f7f9c18,0x3f7f90b1
.long 0x3f7ec46d,0x3f7e9bc9,0x3f7e70b0,0x3f7e4323,0x3f7d3aac,0x3f7cdf6c,0x3f7c7eb0,0x3f7c187a
.long 0x3f7b14be,0x3f7a7302,0x3f79c79d,0x3f791298,0x3f7853f8,0x3f77583a,0x3f764d97,0x3f75341d
.long 0x3f74fa0b,0x3f73913f,0x3f721352,0x3f708066,0x3f710908,0x3f6f20b0,0x3f6d1c1d,0x3f6afb8c
.long 0x3f6c835e,0x3f6a09a7,0x3f676bd8,0x3f64aa59,0x3f676bd8,0x3f644fac,0x3f6106f2,0x3f5d924d
.long 0x3f61c598,0x3f5df6be,0x3f59f26a,0x3f55b993,0x3f5b941a,0x3f570348,0x3f5233c6,0x3f4d26fd
.long 0x3f54db31,0x3f4f7a1f,0x3f49d112,0x3f43e200,0x3f4d9f02,0x3f476085,0x3f40d0da,0x3f39f2ac
.long 0x3f45e403,0x3f3ebc1b,0x3f373a23,0x3f2f61a5,0x3f3daef9,0x3f3592e7,0x3f2d1469,0x3f24381a
.long 0x3f3504f3,0x3f2beb4a,0x3f226799,0x3f187fc0,0x3f2beb4a,0x3f21cbfb,0x3f173c07,0x3f0c42c9
.long 0x3f226799,0x3f173c07,0x3f0b9a6b,0x3eff17b2,0x3f187fc0,0x3f0c42c9,0x3eff17b2,0x3ee4cbfe
.long 0x3f0e39da,0x3f00e7e4,0x3ee63375,0x3ec9b953,0x3f039c3d,0x3eea6681,0x3ecc9b8b,0x3eadf73c
.long 0x3ef15aea,0x3ed25a09,0x3eb263ef,0x3e919ddd,0x3edae880,0x3eb9bb1e,0x3e97a117,0x3e698bba
.long 0x3ec3ef15,0x3ea09ae5,0x3e78cfcc,0x3e2f10a2,0x3eac7cd4,0x3e870ada,0x3e419b37,0x3de7fa9a
.long 0x3e94a031,0x3e5a3997,0x3e09cf86,0x3d621469,0x3e78cfcc,0x3e25c58c,0x3da3308c,0xbb490fc6
.long 0x3e47c5c2,0x3de1bc2e,0x3cc90ab0,0xbd7b2b74,0x3e164083,0x3d6ea038,0xbcfb49ba,0xbdf475c0
.long 0x3dc8bd36,0x3bc90f88,0xbdafb680,0xbe354098,0x3d48fb30,0xbd3c6dd5,0xbe1008b7,0xbe6fa8b2
.long 0x3f800000,0x3f800000,0x3f800000,0x3f800000,0x3f7f84ab,0x3f7f7808,0x3f7f6ac7,0x3f7f5ce9
.long 0x3f7e1324,0x3f7de0b1,0x3f7dabcc,0x3f7d7474,0x3f7baccd,0x3f7b3bab,0x3f7ac516,0x3f7a4910
.long 0x3f7853f8,0x3f778bc5,0x3f76ba07,0x3f75dec6,0x3f740bdd,0x3f72d4eb,0x3f718f57,0x3f703b37
.long 0x3f6ed89e,0x3f6d1c1d,0x3f6b4b0c,0x3f696591,0x3f68bf3c,0x3f666771,0x3f63f473,0x3f61668a
.long 0x3f61c598,0x3f5ebe05,0x3f5b941a,0x3f584853,0x3f59f26a,0x3f5627fe,0x3f5233c6,0x3f4e1689
.long 0x3f514d3d,0x3f4cae79,0x3f47de65,0x3f42de29,0x3f47de65,0x3f425b89,0x3f3ca003,0x3f36ad7f
.long 0x3f3daef9,0x3f373a23,0x3f3085bb,0x3f299415,0x3f32c8c9,0x3f2b561b,0x3f239da9,0x3f1ba299
.long 0x3f273656,0x3f1ebc12,0x3f15f6d9,0x3f0cead0,0x3f1b02c6,0x3f11796b,0x3f07a136,0x3efafef7
.long 0x3f0e39da,0x3f039c3d,0x3ef15aea,0x3edae880,0x3f00e7e4,0x3eea6681,0x3ed25a09,0x3eb9bb1e
.long 0x3ee63375,0x3ecc9b8b,0x3eb263ef,0x3e97a117,0x3ec9b953,0x3eadf73c,0x3e919ddd,0x3e698bba
.long 0x3eac7cd4,0x3e8e9a22,0x3e605c13,0x3e22abb6,0x3e8e9a22,0x3e5d4b1a,0x3e1c76de,0x3db5f8da
.long 0x3e605c13,0x3e1c76de,0x3dafb680,0x3c96c9b6,0x3e22abb6,0x3db5f8da,0x3c96c9b6,0xbd55880e
.long 0x3dc8bd36,0x3cc90ab0,0xbd48fb30,0xbdfab273,0x3d16c32c,0xbd2351cb,0xbdee3876,0xbe44b0b9
.long 0xbcc90ab0,0xbdd53db9,0xbe3b6ecf,0xbe8586ce,0xbdafb680,0xbe2bf804,0xbe7ee6e1,0xbea80b1f
.long 0xbe164083,0xbe6c9a7f,0xbea09ae5,0xbec9b953,0xbe541501,0xbe9620d2,0xbec1071e,0xbeea6681
.long 0xbe888e93,0xbeb554ec,0xbee0924f,0xbf04f484,0xbea68f12,0xbed3c867,0xbeff17b2,0xbf140c5f
.long 0x3f800000,0x3f800000,0x3f800000,0x3f800000,0x3f7f4e6d,0x3f7f3f54,0x3f7f2f9d,0x3f7f1f49
.long 0x3f7d3aac,0x3f7cfe73,0x3f7cbfc9,0x3f7c7eb0,0x3f79c79d,0x3f7940c0,0x3f78b47b,0x3f7822d1
.long 0x3f74fa0b,0x3f740bdd,0x3f731447,0x3f721352,0x3f6ed89e,0x3f6d67a1,0x3f6be858,0x3f6a5ad9
.long 0x3f676bd8,0x3f655e0b,0x3f633c5a,0x3f6106f2,0x3f5ebe05,0x3f5bfb34,0x3f591e6a,0x3f5627fe
.long 0x3f54db31,0x3f514d3d,0x3f4d9f02,0x3f49d112,0x3f49d112,0x3f456439,0x3f40d0da,0x3f3c17d9
.long 0x3f3daef9,0x3f385216,0x3f32c8c9,0x3f2d1469,0x3f3085bb,0x3f2a2a80,0x3f239da9,0x3f1ce11f
.long 0x3f226799,0x3f1b02c6,0x3f13682a,0x3f0b9a6b,0x3f13682a,0x3f0af1b7,0x3f0242b1,0x3ef2bd43
.long 0x3f039c3d,0x3ef41f07,0x3ee0924f,0x3ecc9b8b,0x3ee63375,0x3ed0eb2a,0x3ebb31a0,0x3ea5129f
.long 0x3ec3ef15,0x3eac7cd4,0x3e94a031,0x3e78cfcc,0x3ea09ae5,0x3e870ada,0x3e5a3997,0x3e25c58c
.long 0x3e78cfcc,0x3e419b37,0x3e09cf86,0x3da3308c,0x3e2f10a2,0x3de7fa9a,0x3d621469,0xbb490fc6
.long 0x3dc8bd36,0x3d16c32c,0xbcc90ab0,0xbdafb680,0x3cc90ab0,0xbd2351cb,0xbdd53db9,0xbe2bf804
.long 0xbd48fb30,0xbdee3876,0xbe3b6ecf,0xbe7ee6e1,0xbdfab273,0xbe44b0b9,0xbe8586ce,0xbea80b1f
.long 0xbe47c5c2,0xbe888e93,0xbeac7cd4,0xbecf7bca,0xbe888e93,0xbeadf73c,0xbed25a09,0xbef58035
.long 0xbeac7cd4,0xbed25a09,0xbef6e0cb,0xbf0cead0,0xbecf7bca,0xbef58035,0xbf0cead0,0xbf1e1e22
.long 0xbef15aea,0xbf0b9a6b,0xbf1d7fd1,0xbf2e3bde,0xbf08f59b,0xbf1ba299,0xbf2d1469,0xbf3d27b8
.long 0xbf187fc0,0xbf2ac082,0xbf3b8f3b,0xbf4ac77f,0xbf273656,0xbf38dd65,0xbf48d8b3,0xbf570348
.long 0x3f800000,0x3f800000,0x3f800000,0x3f800000,0x3f7f0e58,0x3f7efcc9,0x3f7eea9d,0x3f7ed7d4
.long 0x3f7c3b28,0x3f7bf531,0x3f7baccd,0x3f7b61fc,0x3f778bc5,0x3f76ef5b,0x3f764d97,0x3f75a67b
.long 0x3f710908,0x3f6ff573,0x3f6ed89e,0x3f6db293,0x3f68bf3c,0x3f671599,0x3f655e0b,0x3f6398ac
.long 0x3f5ebe05,0x3f5c61c7,0x3f59f26a,0x3f577026,0x3f531849,0x3f4fefa8,0x3f4cae79,0x3f495521
.long 0x3f45e403,0x3f41d870,0x3f3daef9,0x3f396842,0x3f373a23,0x3f3238aa,0x3f2d1469,0x3f27ce61
.long 0x3f273656,0x3f212ff9,0x3f1b02c6,0x3f14b039,0x3f15f6d9,0x3f0ee0db,0x3f07a136,0x3f003a06
.long 0x3f039c3d,0x3ef6e0cb,0x3ee63375,0x3ed53641,0x3ee0924f,0x3ece0bea,0x3ebb31a0,0x3ea80b1f
.long 0x3eb8442a,0x3ea395c5,0x3e8e9a22,0x3e72b651,0x3e8e9a22,0x3e6fa8b2,0x3e419b37,0x3e1324ca
.long 0x3e47c5c2,0x3e164083,0x3dc8bd36,0x3d48fb30,0x3de1bc2e,0x3d6ea038,0x3bc90f88,0xbd3c6dd5
.long 0x3cc90ab0,0xbcfb49ba,0xbdafb680,0xbe1008b7,0xbd7b2b74,0xbdf475c0,0xbe354098,0xbe6fa8b2
.long 0xbe164083,0xbe541501,0xbe888e93,0xbea68f12,0xbe6c9a7f,0xbe9620d2,0xbeb554ec,0xbed3c867
.long 0xbea09ae5,0xbec1071e,0xbee0924f,0xbeff17b2,0xbec9b953,0xbeea6681,0xbf04f484,0xbf140c5f
.long 0xbef15aea,0xbf08f59b,0xbf187fc0,0xbf273656,0xbf0b9a6b,0xbf1ba299,0xbf2ac082,0xbf38dd65
.long 0xbf1d7fd1,0xbf2d1469,0xbf3b8f3b,0xbf48d8b3,0xbf2e3bde,0xbf3d27b8,0xbf4ac77f,0xbf570348
.long 0xbf3daef9,0xbf4bbbf8,0xbf584853,0xbf633c5a,0xbf4bbbf8,0xbf58b3a1,0xbf63f473,0xbf6d67a1
.long 0xbf584853,0xbf63f473,0xbf6db293,0xbf756d97,0xbf633c5a,0xbf6d67a1,0xbf756d97,0xbf7b3bab
.long 0x0,0x0,0x0,0x0,0x0,0x3b490fc6,0x3bc90f88,0x3c16cb58
.long 0x0,0x3bc90f88,0x3c490e90,0x3c96c9b6,0x0,0x3c16cb58,0x3c96c9b6,0x3ce22a7a
.long 0x0,0x3c490e90,0x3cc90ab0,0x3d16c32c,0x0,0x3c7b514b,0x3cfb49ba,0x3d3c6dd5
.long 0x0,0x3c96c9b6,0x3d16c32c,0x3d621469,0x0,0x3cafea69,0x3d2fe007,0x3d83db0a
.long 0x0,0x3cc90ab0,0x3d48fb30,0x3d96a905,0x0,0x3ce22a7a,0x3d621469,0x3da973ba
.long 0x0,0x3cfb49ba,0x3d7b2b74,0x3dbc3ac3,0x0,0x3d0a342f,0x3d8a200a,0x3dcefdb7
.long 0x0,0x3d16c32c,0x3d96a905,0x3de1bc2e,0x0,0x3d2351cb,0x3da3308c,0x3df475c0
.long 0x0,0x3d2fe007,0x3dafb680,0x3e039502,0x0,0x3d3c6dd5,0x3dbc3ac3,0x3e0cec4a
.long 0x0,0x3d48fb30,0x3dc8bd36,0x3e164083,0x0,0x3d55880e,0x3dd53db9,0x3e1f917b
.long 0x0,0x3d621469,0x3de1bc2e,0x3e28defc,0x0,0x3d6ea038,0x3dee3876,0x3e3228d4
.long 0x0,0x3d7b2b74,0x3dfab273,0x3e3b6ecf,0x0,0x3d83db0a,0x3e039502,0x3e44b0b9
.long 0x0,0x3d8a200a,0x3e09cf86,0x3e4dee60,0x0,0x3d9064b4,0x3e1008b7,0x3e57278f
.long 0x0,0x3d96a905,0x3e164083,0x3e605c13,0x0,0x3d9cecf9,0x3e1c76de,0x3e698bba
.long 0x0,0x3da3308c,0x3e22abb6,0x3e72b651,0x0,0x3da973ba,0x3e28defc,0x3e7bdba4
.long 0x0,0x3dafb680,0x3e2f10a2,0x3e827dc0,0x0,0x3db5f8da,0x3e354098,0x3e870ada
.long 0x0,0x3dbc3ac3,0x3e3b6ecf,0x3e8b9507,0x0,0x3dc27c39,0x3e419b37,0x3e901c2c
.long 0x0,0x0,0x0,0x0,0x3c490e90,0x3c7b514b,0x3c96c9b6,0x3cafea69
.long 0x3cc90ab0,0x3cfb49ba,0x3d16c32c,0x3d2fe007,0x3d16c32c,0x3d3c6dd5,0x3d621469,0x3d83db0a
.long 0x3d48fb30,0x3d7b2b74,0x3d96a905,0x3dafb680,0x3d7b2b74,0x3d9cecf9,0x3dbc3ac3,0x3ddb7d37
.long 0x3d96a905,0x3dbc3ac3,0x3de1bc2e,0x3e039502,0x3dafb680,0x3ddb7d37,0x3e039502,0x3e195be0
.long 0x3dc8bd36,0x3dfab273,0x3e164083,0x3e2f10a2,0x3de1bc2e,0x3e0cec4a,0x3e28defc,0x3e44b0b9
.long 0x3dfab273,0x3e1c76de,0x3e3b6ecf,0x3e5a3997,0x3e09cf86,0x3e2bf804,0x3e4dee60,0x3e6fa8b2
.long 0x3e164083,0x3e3b6ecf,0x3e605c13,0x3e827dc0,0x3e22abb6,0x3e4ada4f,0x3e72b651,0x3e8d17c0
.long 0x3e2f10a2,0x3e5a3997,0x3e827dc0,0x3e97a117,0x3e3b6ecf,0x3e698bba,0x3e8b9507,0x3ea21887
.long 0x3e47c5c2,0x3e78cfcc,0x3e94a031,0x3eac7cd4,0x3e541501,0x3e840270,0x3e9d9e78,0x3eb6ccc3
.long 0x3e605c13,0x3e8b9507,0x3ea68f12,0x3ec1071e,0x3e6c9a7f,0x3e931f35,0x3eaf713a,0x3ecb2aae
.long 0x3e78cfcc,0x3e9aa086,0x3eb8442a,0x3ed53641,0x3e827dc0,0x3ea21887,0x3ec1071e,0x3edf28a9
.long 0x3e888e93,0x3ea986c4,0x3ec9b953,0x3ee900b7,0x3e8e9a22,0x3eb0eacb,0x3ed25a09,0x3ef2bd43
.long 0x3e94a031,0x3eb8442a,0x3edae880,0x3efc5d27,0x3e9aa086,0x3ebf926f,0x3ee363fa,0x3f02ef9f
.long 0x3ea09ae5,0x3ec6d529,0x3eebcbbb,0x3f07a136,0x3ea68f12,0x3ece0bea,0x3ef41f07,0x3f0c42c9
.long 0x3eac7cd4,0x3ed53641,0x3efc5d27,0x3f10d3cd,0x3eb263ef,0x3edc53c1,0x3f0242b1,0x3f1553b7
.long 0x3eb8442a,0x3ee363fa,0x3f064b82,0x3f19c200,0x3ebe1d4a,0x3eea6681,0x3f0a48ad,0x3f1e1e22
.long 0x0,0x0,0x0,0x0,0x3cc90ab0,0x3ce22a7a,0x3cfb49ba,0x3d0a342f
.long 0x3d48fb30,0x3d621469,0x3d7b2b74,0x3d8a200a,0x3d96a905,0x3da973ba,0x3dbc3ac3,0x3dcefdb7
.long 0x3dc8bd36,0x3de1bc2e,0x3dfab273,0x3e09cf86,0x3dfab273,0x3e0cec4a,0x3e1c76de,0x3e2bf804
.long 0x3e164083,0x3e28defc,0x3e3b6ecf,0x3e4dee60,0x3e2f10a2,0x3e44b0b9,0x3e5a3997,0x3e6fa8b2
.long 0x3e47c5c2,0x3e605c13,0x3e78cfcc,0x3e888e93,0x3e605c13,0x3e7bdba4,0x3e8b9507,0x3e9920fe
.long 0x3e78cfcc,0x3e8b9507,0x3e9aa086,0x3ea986c4,0x3e888e93,0x3e9920fe,0x3ea986c4,0x3eb9bb1e
.long 0x3e94a031,0x3ea68f12,0x3eb8442a,0x3ec9b953,0x3ea09ae5,0x3eb3dca5,0x3ec6d529,0x3ed97cb9
.long 0x3eac7cd4,0x3ec1071e,0x3ed53641,0x3ee900b7,0x3eb8442a,0x3ece0bea,0x3ee363fa,0x3ef840c8
.long 0x3ec3ef15,0x3edae880,0x3ef15aea,0x3f039c3d,0x3ecf7bca,0x3ee79a5d,0x3eff17b2,0x3f0af1b7
.long 0x3edae880,0x3ef41f07,0x3f064b82,0x3f121eb0,0x3ee63375,0x3f003a06,0x3f0cead0,0x3f19210f
.long 0x3ef15aea,0x3f064b82,0x3f13682a,0x3f1ff6cb,0x3efc5d27,0x3f0c42c9,0x3f19c200,0x3f269de3
.long 0x3f039c3d,0x3f121eb0,0x3f1ff6cb,0x3f2d1469,0x3f08f59b,0x3f17de12,0x3f26050a,0x3f33587a
.long 0x3f0e39da,0x3f1d7fd1,0x3f2beb4a,0x3f396842,0x3f13682a,0x3f2302d3,0x3f31a81d,0x3f3f41fc
.long 0x3f187fc0,0x3f286605,0x3f373a23,0x3f44e3f5,0x3f1d7fd1,0x3f2da859,0x3f3ca003,0x3f4a4c87
.long 0x3f226799,0x3f32c8c9,0x3f41d870,0x3f4f7a1f,0x3f273656,0x3f37c655,0x3f46e22a,0x3f546b3b
.long 0x3f2beb4a,0x3f3ca003,0x3f4bbbf8,0x3f591e6a,0x3f3085bb,0x3f4154e1,0x3f5064af,0x3f5d924d
.long 0x0,0x0,0x0,0x0,0x3d16c32c,0x3d2351cb,0x3d2fe007,0x3d3c6dd5
.long 0x3d96a905,0x3da3308c,0x3dafb680,0x3dbc3ac3,0x3de1bc2e,0x3df475c0,0x3e039502,0x3e0cec4a
.long 0x3e164083,0x3e22abb6,0x3e2f10a2,0x3e3b6ecf,0x3e3b6ecf,0x3e4ada4f,0x3e5a3997,0x3e698bba
.long 0x3e605c13,0x3e72b651,0x3e827dc0,0x3e8b9507,0x3e827dc0,0x3e8d17c0,0x3e97a117,0x3ea21887
.long 0x3e94a031,0x3ea09ae5,0x3eac7cd4,0x3eb8442a,0x3ea68f12,0x3eb3dca5,0x3ec1071e,0x3ece0bea
.long 0x3eb8442a,0x3ec6d529,0x3ed53641,0x3ee363fa,0x3ec9b953,0x3ed97cb9,0x3ee900b7,0x3ef840c8
.long 0x3edae880,0x3eebcbbb,0x3efc5d27,0x3f064b82,0x3eebcbbb,0x3efdbabb,0x3f07a136,0x3f102dd5
.long 0x3efc5d27,0x3f07a136,0x3f10d3cd,0x3f19c200,0x3f064b82,0x3f102dd5,0x3f19c200,0x3f2302d3
.long 0x3f0e39da,0x3f187fc0,0x3f226799,0x3f2beb4a,0x3f15f6d9,0x3f209393,0x3f2ac082,0x3f34768f
.long 0x3f1d7fd1,0x3f286605,0x3f32c8c9,0x3f3ca003,0x3f24d225,0x3f2ff3e6,0x3f3a7ca4,0x3f446337
.long 0x3f2beb4a,0x3f373a23,0x3f41d870,0x3f4bbbf8,0x3f32c8c9,0x3f3e35c5,0x3f48d8b3,0x3f52a649
.long 0x3f396842,0x3f44e3f5,0x3f4f7a1f,0x3f591e6a,0x3f3fc767,0x3f4b41fa,0x3f55b993,0x3f5f20db
.long 0x3f45e403,0x3f514d3d,0x3f5b941a,0x3f64aa59,0x3f4bbbf8,0x3f570348,0x3f6106f2,0x3f69b7e4
.long 0x3f514d3d,0x3f5c61c7,0x3f660f88,0x3f6e46be,0x3f5695e5,0x3f61668a,0x3f6aab7b,0x3f725470
.long 0x3f5b941a,0x3f660f88,0x3f6ed89e,0x3f75dec6,0x3f604621,0x3f6a5ad9,0x3f7294f8,0x3f78e3d6
.long 0x3f64aa59,0x3f6e46be,0x3f75dec6,0x3f7b61fc,0x3f68bf3c,0x3f71d19f,0x3f78b47b,0x3f7d57de
.long 0x0,0x0,0x0,0x0,0x3d48fb30,0x3d55880e,0x3d621469,0x3d6ea038
.long 0x3dc8bd36,0x3dd53db9,0x3de1bc2e,0x3dee3876,0x3e164083,0x3e1f917b,0x3e28defc,0x3e3228d4
.long 0x3e47c5c2,0x3e541501,0x3e605c13,0x3e6c9a7f,0x3e78cfcc,0x3e840270,0x3e8b9507,0x3e931f35
.long 0x3e94a031,0x3e9d9e78,0x3ea68f12,0x3eaf713a,0x3eac7cd4,0x3eb6ccc3,0x3ec1071e,0x3ecb2aae
.long 0x3ec3ef15,0x3ecf7bca,0x3edae880,0x3ee63375,0x3edae880,0x3ee79a5d,0x3ef41f07,0x3f003a06
.long 0x3ef15aea,0x3eff17b2,0x3f064b82,0x3f0cead0,0x3f039c3d,0x3f0af1b7,0x3f121eb0,0x3f19210f
.long 0x3f0e39da,0x3f15f6d9,0x3f1d7fd1,0x3f24d225,0x3f187fc0,0x3f209393,0x3f286605,0x3f2ff3e6
.long 0x3f226799,0x3f2ac082,0x3f32c8c9,0x3f3a7ca4,0x3f2beb4a,0x3f34768f,0x3f3ca003,0x3f446337
.long 0x3f3504f3,0x3f3daef9,0x3f45e403,0x3f4d9f02,0x3f3daef9,0x3f466354,0x3f4e8d90,0x3f5627fe
.long 0x3f45e403,0x3f4e8d90,0x3f5695e5,0x3f5df6be,0x3f4d9f02,0x3f5627fe,0x3f5df6be,0x3f650479
.long 0x3f54db31,0x3f5d2d53,0x3f64aa59,0x3f6b4b0c,0x3f5b941a,0x3f6398ac,0x3f6aab7b,0x3f70c501
.long 0x3f61c598,0x3f696591,0x3f6ff573,0x3f756d97,0x3f676bd8,0x3f6e8ff8,0x3f748422,0x3f7940c0
.long 0x3f6c835e,0x3f731447,0x3f7853f8,0x3f7c3b28,0x3f710908,0x3f76ef5b,0x3f7b61fc,0x3f7e5a38
.long 0x3f74fa0b,0x3f7a1e84,0x3f7dabcc,0x3f7f9c18,0x3f7853f8,0x3f7c9f8a,0x3f7f2f9d,0x3f7fffb1
.long 0x3f7b14be,0x3f7e70b0,0x3f7fec43,0x3f7f84ab,0x3f7d3aac,0x3f7f90b1,0x3f7fe129,0x3f7e2b72
.long 0x3f7ec46d,0x3f7ffec4,0x3f7f0e58,0x3f7bf531,0x3f7fb10f,0x3f7fba9e,0x3f7d7474,0x3f78e3d6
.long 0x0,0x0,0x0,0x0,0x3d7b2b74,0x3d83db0a,0x3d8a200a,0x3d9064b4
.long 0x3dfab273,0x3e039502,0x3e09cf86,0x3e1008b7,0x3e3b6ecf,0x3e44b0b9,0x3e4dee60,0x3e57278f
.long 0x3e78cfcc,0x3e827dc0,0x3e888e93,0x3e8e9a22,0x3e9aa086,0x3ea21887,0x3ea986c4,0x3eb0eacb
.long 0x3eb8442a,0x3ec1071e,0x3ec9b953,0x3ed25a09,0x3ed53641,0x3edf28a9,0x3ee900b7,0x3ef2bd43
.long 0x3ef15aea,0x3efc5d27,0x3f039c3d,0x3f08f59b,0x3f064b82,0x3f0c42c9,0x3f121eb0,0x3f17de12
.long 0x3f13682a,0x3f19c200,0x3f1ff6cb,0x3f26050a,0x3f1ff6cb,0x3f269de3,0x3f2d1469,0x3f33587a
.long 0x3f2beb4a,0x3f32c8c9,0x3f396842,0x3f3fc767,0x3f373a23,0x3f3e35c5,0x3f44e3f5,0x3f4b41fa
.long 0x3f41d870,0x3f48d8b3,0x3f4f7a1f,0x3f55b993,0x3f4bbbf8,0x3f52a649,0x3f591e6a,0x3f5f20db
.long 0x3f54db31,0x3f5b941a,0x3f61c598,0x3f676bd8,0x3f5d2d53,0x3f6398ac,0x3f696591,0x3f6e8ff8
.long 0x3f64aa59,0x3f6aab7b,0x3f6ff573,0x3f748422,0x3f6b4b0c,0x3f70c501,0x3f756d97,0x3f7940c0
.long 0x3f710908,0x3f75dec6,0x3f79c79d,0x3f7cbfc9,0x3f75dec6,0x3f79f35e,0x3f7cfe73,0x3f7efcc9
.long 0x3f79c79d,0x3f7cfe73,0x3f7f0e58,0x3f7ff4e6,0x3f7cbfc9,0x3f7efcc9,0x3f7ff4e6,0x3f7fa6e3
.long 0x3f7ec46d,0x3f7fec43,0x3f7fb10f,0x3f7e1324,0x3f7fd397,0x3f7fcbe2,0x3f7e4323,0x3f7b3bab
.long 0x3f7fec43,0x3f7e9bc9,0x3f7baccd,0x3f772417,0x3f7f0e58,0x3f7c5d3a,0x3f77f110,0x3f71d19f
.long 0x3f7d3aac,0x3f791298,0x3f731447,0x3f6b4b0c,0x3f7a7302,0x3f74bf62,0x3f6d1c1d,0x3f6398ac
.long 0x3f76ba07,0x3f6f6830,0x3f660f88,0x3f5ac450,0x3f721352,0x3f6912ae,0x3f5df6be,0x3f50d937
.long 0x0,0x0,0x0,0x0,0x3d96a905,0x3d9cecf9,0x3da3308c,0x3da973ba
.long 0x3e164083,0x3e1c76de,0x3e22abb6,0x3e28defc,0x3e605c13,0x3e698bba,0x3e72b651,0x3e7bdba4
.long 0x3e94a031,0x3e9aa086,0x3ea09ae5,0x3ea68f12,0x3eb8442a,0x3ebf926f,0x3ec6d529,0x3ece0bea
.long 0x3edae880,0x3ee363fa,0x3eebcbbb,0x3ef41f07,0x3efc5d27,0x3f02ef9f,0x3f07a136,0x3f0c42c9
.long 0x3f0e39da,0x3f13682a,0x3f187fc0,0x3f1d7fd1,0x3f1d7fd1,0x3f2302d3,0x3f286605,0x3f2da859
.long 0x3f2beb4a,0x3f31a81d,0x3f373a23,0x3f3ca003,0x3f396842,0x3f3f41fc,0x3f44e3f5,0x3f4a4c87
.long 0x3f45e403,0x3f4bbbf8,0x3f514d3d,0x3f5695e5,0x3f514d3d,0x3f570348,0x3f5c61c7,0x3f61668a
.long 0x3f5b941a,0x3f6106f2,0x3f660f88,0x3f6aab7b,0x3f64aa59,0x3f69b7e4,0x3f6e46be,0x3f725470
.long 0x3f6c835e,0x3f710908,0x3f74fa0b,0x3f7853f8,0x3f731447,0x3f76ef5b,0x3f7a1e84,0x3f7c9f8a
.long 0x3f7853f8,0x3f7b61fc,0x3f7dabcc,0x3f7f2f9d,0x3f7c3b28,0x3f7e5a38,0x3f7f9c18,0x3f7fffb1
.long 0x3f7ec46d,0x3f7fd397,0x3f7fec43,0x3f7f0e58,0x3f7fec43,0x3f7fcbe2,0x3f7e9bc9,0x3f7c5d3a
.long 0x3f7fb10f,0x3f7e4323,0x3f7baccd,0x3f77f110,0x3f7e1324,0x3f7b3bab,0x3f772417,0x3f71d19f
.long 0x3f7b14be,0x3f76ba07,0x3f710908,0x3f6a09a7,0x3f76ba07,0x3f70c501,0x3f696591,0x3f60a6cf
.long 0x3f710908,0x3f696591,0x3f604621,0x3f55b993,0x3f6a09a7,0x3f60a6cf,0x3f55b993,0x3f495521
.long 0x3f61c598,0x3f5695e5,0x3f49d112,0x3f3b8f3b,0x3f584853,0x3f4b41fa,0x3f3ca003,0x3f2c800f
.long 0x3f4d9f02,0x3f3ebc1b,0x3f2e3bde,0x3f1c420c,0x3f41d870,0x3f311722,0x3f1ebc12,0x3f0af1b7
.long 0x0,0x0,0x0,0x0,0x3dafb680,0x3db5f8da,0x3dbc3ac3,0x3dc27c39
.long 0x3e2f10a2,0x3e354098,0x3e3b6ecf,0x3e419b37,0x3e827dc0,0x3e870ada,0x3e8b9507,0x3e901c2c
.long 0x3eac7cd4,0x3eb263ef,0x3eb8442a,0x3ebe1d4a,0x3ed53641,0x3edc53c1,0x3ee363fa,0x3eea6681
.long 0x3efc5d27,0x3f0242b1,0x3f064b82,0x3f0a48ad,0x3f10d3cd,0x3f1553b7,0x3f19c200,0x3f1e1e22
.long 0x3f226799,0x3f273656,0x3f2beb4a,0x3f3085bb,0x3f32c8c9,0x3f37c655,0x3f3ca003,0x3f4154e1
.long 0x3f41d870,0x3f46e22a,0x3f4bbbf8,0x3f5064af,0x3f4f7a1f,0x3f546b3b,0x3f591e6a,0x3f5d924d
.long 0x3f5b941a,0x3f604621,0x3f64aa59,0x3f68bf3c,0x3f660f88,0x3f6a5ad9,0x3f6e46be,0x3f71d19f
.long 0x3f6ed89e,0x3f7294f8,0x3f75dec6,0x3f78b47b,0x3f75dec6,0x3f78e3d6,0x3f7b61fc,0x3f7d57de
.long 0x3f7b14be,0x3f7d3aac,0x3f7ec46d,0x3f7fb10f,0x3f7e70b0,0x3f7f90b1,0x3f7ffec4,0x3f7fba9e
.long 0x3f7fec43,0x3f7fe129,0x3f7f0e58,0x3f7d7474,0x3f7f84ab,0x3f7e2b72,0x3f7bf531,0x3f78e3d6
.long 0x3f7d3aac,0x3f7a7302,0x3f76ba07,0x3f721352,0x3f791298,0x3f74bf62,0x3f6f6830,0x3f6912ae
.long 0x3f731447,0x3f6d1c1d,0x3f660f88,0x3f5df6be,0x3f6b4b0c,0x3f6398ac,0x3f5ac450,0x3f50d937
.long 0x3f61c598,0x3f584853,0x3f4d9f02,0x3f41d870,0x3f5695e5,0x3f4b41fa,0x3f3ebc1b,0x3f311722
.long 0x3f49d112,0x3f3ca003,0x3f2e3bde,0x3f1ebc12,0x3f3b8f3b,0x3f2c800f,0x3f1c420c,0x3f0af1b7
.long 0x3f2beb4a,0x3f1b02c6,0x3f08f59b,0x3eebcbbb,0x3f1b02c6,0x3f084b92,0x3ee900b7,0x3ebf926f
.long 0x3f08f59b,0x3ee900b7,0x3ebe1d4a,0x3e919ddd,0x3eebcbbb,0x3ebf926f,0x3e919ddd,0x3e44b0b9
.long 0x3f800000,0x3f800000,0x3f800000,0x3f800000,0x3f7ec46d,0x3f7eb069,0x3f7e9bc9,0x3f7e868b
.long 0x3f7b14be,0x3f7ac516,0x3f7a7302,0x3f7a1e84,0x3f74fa0b,0x3f74484b,0x3f73913f,0x3f72d4eb
.long 0x3f6c835e,0x3f6b4b0c,0x3f6a09a7,0x3f68bf3c,0x3f61c598,0x3f5fe4e9,0x3f5df6be,0x3f5bfb34
.long 0x3f54db31,0x3f5233c6,0x3f4f7a1f,0x3f4cae79,0x3f45e403,0x3f425b89,0x3f3ebc1b,0x3f3b0629
.long 0x3f3504f3,0x3f3085bb,0x3f2beb4a,0x3f273656,0x3f226799,0x3f1ce11f,0x3f173c07,0x3f11796b
.long 0x3f0e39da,0x3f07a136,0x3f00e7e4,0x3ef41f07,0x3ef15aea,0x3ee1fb6a,0x3ed25a09,0x3ec27b55
.long 0x3ec3ef15,0x3eb263ef,0x3ea09ae5,0x3e8e9a22,0x3e94a031,0x3e80f8c0,0x3e5a3997,0x3e3228d4
.long 0x3e47c5c2,0x3e1c76de,0x3de1bc2e,0x3d8a200a,0x3dc8bd36,0x3d55880e,0x3bc90f88,0xbd2351cb
.long 0x248d3132,0xbd48fb30,0xbdc8bd36,0xbe164083,0xbdc8bd36,0xbe195be0,0xbe4dee60,0xbe80f8c0
.long 0xbe47c5c2,0xbe7ee6e1,0xbe9aa086,0xbeb554ec,0xbe94a031,0xbeb0eacb,0xbecc9b8b,0xbee79a5d
.long 0xbec3ef15,0xbee0924f,0xbefc5d27,0xbf0b9a6b,0xbef15aea,0xbf06f686,0xbf14b039,0xbf21cbfb
.long 0xbf0e39da,0xbf1c420c,0xbf299415,0xbf36206c,0xbf226799,0xbf2ff3e6,0xbf3ca003,0xbf485bca
.long 0xbf3504f3,0xbf41d870,0xbf4d9f02,0xbf584853,0xbf45e403,0xbf51c0c2,0xbf5c61c7,0xbf65b710
.long 0xbf54db31,0xbf5f8327,0xbf68bf3c,0xbf708066,0xbf61c598,0xbf6afb8c,0xbf7294f8,0xbf788486
.long 0xbf6c835e,0xbf740bdd,0xbf79c79d,0xbf7dabcc,0xbf74fa0b,0xbf7a9c59,0xbf7e4323,0xbf7fe705
.long 0xbf7b14be,0xbf7e9bc9,0xbf7ffb11,0xbf7f2f9d,0xbf7ec46d,0xbf7fffb1,0xbf7eea9d,0xbf7b87b2
.long 0x3f800000,0x3f800000,0x3f800000,0x3f800000,0x3f7e70b0,0x3f7e5a38,0x3f7e4323,0x3f7e2b72
.long 0x3f79c79d,0x3f796e4e,0x3f791298,0x3f78b47b,0x3f721352,0x3f714c7a,0x3f708066,0x3f6faf1b
.long 0x3f676bd8,0x3f660f88,0x3f64aa59,0x3f633c5a,0x3f59f26a,0x3f57dc7f,0x3f55b993,0x3f5389c7
.long 0x3f49d112,0x3f46e22a,0x3f43e200,0x3f40d0da,0x3f373a23,0x3f33587a,0x3f2f61a5,0x3f2b561b
.long 0x3f226799,0x3f1d7fd1,0x3f187fc0,0x3f13682a,0x3f0b9a6b,0x3f05a02c,0x3eff17b2,0x3ef2bd43
.long 0x3ee63375,0x3ed8106b,0x3ec9b953,0x3ebb31a0,0x3eb263ef,0x3ea21887,0x3e919ddd,0x3e80f8c0
.long 0x3e78cfcc,0x3e541501,0x3e2f10a2,0x3e09cf86,0x3e09cf86,0x3dc27c39,0x3d621469,0x3c7b514b
.long 0x3cc90ab0,0xbc96c9b6,0xbd7b2b74,0xbdd53db9,0xbdafb680,0xbe06b26e,0xbe354098,0xbe636c83
.long 0xbe47c5c2,0xbe78cfcc,0xbe94a031,0xbeac7cd4,0xbe9aa086,0xbeb3dca5,0xbecc9b8b,0xbee4cbfe
.long 0xbecf7bca,0xbee900b7,0xbf00e7e4,0xbf0cead0,0xbf00e7e4,0xbf0d9281,0xbf19c200,0xbf256bcb
.long 0xbf187fc0,0xbf24d225,0xbf3085bb,0xbf3b8f3b,0xbf2e3bde,0xbf39f2ac,0xbf44e3f5,0xbf4f0417
.long 0xbf41d870,0xbf4cae79,0xbf5695e5,0xbf5f8327,0xbf531849,0xbf5cc7d1,0xbf655e0b,0xbf6cd007
.long 0xbf61c598,0xbf6a09a7,0xbf710908,0xbf76ba07,0xbf6db293,0xbf74484b,0xbf796e4e,0xbf7d1cdd
.long 0xbf76ba07,0xbf7b61fc,0xbf7e70b0,0xbf7fe129,0xbf7cbfc9,0xbf7f3f54,0xbf7ffec4,0xbf7efcc9
.long 0xbf7fb10f,0xbf7fd397,0xbf7e1324,0xbf7a7302,0xbf7f84ab,0xbf7d1cdd,0xbf78b47b,0xbf725470
.long 0xbf7c3b28,0xbf772417,0xbf6ff573,0xbf66becc,0xbf75dec6,0xbf6dfcf2,0xbf63f473,0xbf57dc7f
.long 0x3f800000,0x3f800000,0x3f800000,0x3f800000,0x3f7e1324,0x3f7dfa38,0x3f7de0b1,0x3f7dc68c
.long 0x3f7853f8,0x3f77f110,0x3f778bc5,0x3f772417,0x3f6ed89e,0x3f6dfcf2,0x3f6d1c1d,0x3f6c3624
.long 0x3f61c598,0x3f604621,0x3f5ebe05,0x3f5d2d53,0x3f514d3d,0x3f4f0417,0x3f4cae79,0x3f4a4c87
.long 0x3f3daef9,0x3f3a7ca4,0x3f373a23,0x3f33e7bc,0x3f273656,0x3f2302d3,0x3f1ebc12,0x3f1a6293
.long 0x3f0e39da,0x3f08f59b,0x3f039c3d,0x3efc5d27,0x3ee63375,0x3ed97cb9,0x3ecc9b8b,0x3ebf926f
.long 0x3eac7cd4,0x3e9d9e78,0x3e8e9a22,0x3e7ee6e1,0x3e605c13,0x3e3e853e,0x3e1c76de,0x3df475c0
.long 0x3dc8bd36,0x3d7b2b74,0x3cc90ab0,0xbc490e90,0xbcc90ab0,0xbd83db0a,0xbdd53db9,0xbe1324ca
.long 0xbe164083,0xbe419b37,0xbe6c9a7f,0xbe8b9507,0xbe888e93,0xbe9f1cdf,0xbeb554ec,0xbecb2aae
.long 0xbec3ef15,0xbedae880,0xbef15aea,0xbf039c3d,0xbefc5d27,0xbf099f4e,0xbf14b039,0xbf1f599f
.long 0xbf187fc0,0xbf239da9,0xbf2e3bde,0xbf385216,0xbf3085bb,0xbf3b0629,0xbf44e3f5,0xbf4e1689
.long 0xbf45e403,0xbf4f7a1f,0xbf584853,0xbf604621,0xbf584853,0xbf60a6cf,0xbf6816a8,0xbf6e8ff8
.long 0xbf676bd8,0xbf6e46be,0xbf740bdd,0xbf78b47b,0xbf731447,0xbf7822d1,0xbf7bf531,0xbf7e868b
.long 0xbf7b14be,0xbf7e1324,0xbf7fb10f,0xbf7fec43,0xbf7f4e6d,0xbf7fffb1,0xbf7f2f9d,0xbf7cdf6c
.long 0xbf7fb10f,0xbf7de0b1,0xbf7a7302,0xbf756d97,0xbf7c3b28,0xbf77beb7,0xbf718f57,0xbf69b7e4
.long 0xbf74fa0b,0xbf6db293,0xbf64aa59,0xbf59f26a,0xbf6a09a7,0xbf5fe4e9,0xbf53fac3,0xbf466354
.long 0xbf5b941a,0xbf4e8d90,0xbf3fc767,0xbf2f61a5,0xbf49d112,0xbf39f2ac,0xbf286605,0xbf1553b7
.long 0x3f800000,0x3f800000,0x3f800000,0x3f800000,0x3f7dabcc,0x3f7d906e,0x3f7d7474,0x3f7d57de
.long 0x3f76ba07,0x3f764d97,0x3f75dec6,0x3f756d97,0x3f6b4b0c,0x3f6a5ad9,0x3f696591,0x3f686b39
.long 0x3f5b941a,0x3f59f26a,0x3f584853,0x3f5695e5,0x3f47de65,0x3f456439,0x3f42de29,0x3f404c5c
.long 0x3f3085bb,0x3f2d1469,0x3f299415,0x3f26050a,0x3f15f6d9,0x3f11796b,0x3f0cead0,0x3f084b92
.long 0x3ef15aea,0x3ee63375,0x3edae880,0x3ecf7bca,0x3eb263ef,0x3ea5129f,0x3e97a117,0x3e8a11f7
.long 0x3e605c13,0x3e419b37,0x3e22abb6,0x3e039502,0x3dafb680,0x3d55880e,0x3c96c9b6,0xbc7b514b
.long 0xbd48fb30,0xbdafb680,0xbdfab273,0xbe22abb6,0xbe3b6ecf,0xbe636c83,0xbe8586ce,0xbe9920fe
.long 0xbea09ae5,0xbeb554ec,0xbec9b953,0xbeddbe79,0xbee0924f,0xbef58035,0xbf04f484,0xbf0ee0db
.long 0xbf0e39da,0xbf187fc0,0xbf226799,0xbf2beb4a,0xbf299415,0xbf33587a,0xbf3ca003,0xbf456439
.long 0xbf41d870,0xbf4ac77f,0xbf531849,0xbf5ac450,0xbf5695e5,0xbf5e5aa6,0xbf655e0b,0xbf6b99fb
.long 0xbf676bd8,0xbf6db293,0xbf731447,0xbf778bc5,0xbf740bdd,0xbf788486,0xbf7bf531,0xbf7e5a38
.long 0xbf7c3b28,0xbf7e9bc9,0xbf7fd397,0xbf7fe129,0xbf7fd397,0xbf7fdaaf,0xbf7e9bc9,0xbf7c187a
.long 0xbf7ec46d,0xbf7c3b28,0xbf7853f8,0xbf731447,0xbf791298,0xbf73ced9,0xbf6d1c1d,0xbf650479
.long 0xbf6ed89e,0xbf66becc,0xbf5d2d53,0xbf5233c6,0xbf604621,0xbf554aa4,0xbf48d8b3,0xbf3b0629
.long 0xbf4d9f02,0xbf3fc767,0xbf3085bb,0xbf1ff6cb,0xbf373a23,0xbf269de3,0xbf14b039,0xbf019573
.long 0xbf1d7fd1,0xbf0a48ad,0xbeebcbbb,0xbec1071e,0xbf00e7e4,0xbed6a399,0xbea986c4,0xbe75c35a
.long 0x3f800000,0x3f800000,0x3f800000,0x3f800000,0x3f7d3aac,0x3f7d1cdd,0x3f7cfe73,0x3f7cdf6c
.long 0x3f74fa0b,0x3f748422,0x3f740bdd,0x3f73913f,0x3f676bd8,0x3f666771,0x3f655e0b,0x3f644fac
.long 0x3f54db31,0x3f531849,0x3f514d3d,0x3f4f7a1f,0x3f3daef9,0x3f3b0629,0x3f385216,0x3f3592e7
.long 0x3f226799,0x3f1ebc12,0x3f1b02c6,0x3f173c07,0x3f039c3d,0x3efdbabb,0x3ef41f07,0x3eea6681
.long 0x3ec3ef15,0x3eb8442a,0x3eac7cd4,0x3ea09ae5,0x3e78cfcc,0x3e5d4b1a,0x3e419b37,0x3e25c58c
.long 0x3dc8bd36,0x3d8a200a,0x3d16c32c,0x3bc90f88,0xbd48fb30,0xbda973ba,0xbdee3876,0xbe195be0
.long 0xbe47c5c2,0xbe6c9a7f,0xbe888e93,0xbe9aa086,0xbeac7cd4,0xbebf926f,0xbed25a09,0xbee4cbfe
.long 0xbef15aea,0xbf0242b1,0xbf0b9a6b,0xbf14b039,0xbf187fc0,0xbf21cbfb,0xbf2ac082,0xbf33587a
.long 0xbf3504f3,0xbf3daef9,0xbf45e403,0xbf4d9f02,0xbf4d9f02,0xbf554aa4,0xbf5c61c7,0xbf62df7b
.long 0xbf61c598,0xbf6816a8,0xbf6db293,0xbf7294f8,0xbf710908,0xbf75a67b,0xbf796e4e,0xbf7c5d3a
.long 0xbf7b14be,0xbf7dabcc,0xbf7f4e6d,0xbf7ffb11,0xbf7fb10f,0xbf7ff84a,0xbf7f2f9d,0xbf7d57de
.long 0xbf7ec46d,0xbf7c7eb0,0xbf791298,0xbf748422,0xbf7853f8,0xbf73530e,0xbf6d1c1d,0xbf65b710
.long 0xbf6c835e,0xbf64aa59,0xbf5b941a,0xbf514d3d,0xbf5b941a,0xbf50d937,0xbf44e3f5,0xbf37c655
.long 0xbf45e403,0xbf385216,0xbf299415,0xbf19c200,0xbf2beb4a,0xbf1ba299,0xbf0a48ad,0xbeeff7fb
.long 0xbf0e39da,0xbef6e0cb,0xbecf7bca,0xbea68f12,0xbedae880,0xbeb0eacb,0xbe8586ce,0xbe3228d4
.long 0xbe94a031,0xbe4dee60,0xbde1bc2e,0xbc96c9b6,0xbe164083,0xbd55880e,0x3d2fe007,0x3e0cec4a
.long 0x3f800000,0x3f800000,0x3f800000,0x3f800000,0x3f7cbfc9,0x3f7c9f8a,0x3f7c7eb0,0x3f7c5d3a
.long 0x3f731447,0x3f7294f8,0x3f721352,0x3f718f57,0x3f633c5a,0x3f62241a,0x3f6106f2,0x3f5fe4e9
.long 0x3f4d9f02,0x3f4bbbf8,0x3f49d112,0x3f47de65,0x3f32c8c9,0x3f2ff3e6,0x3f2d1469,0x3f2a2a80
.long 0x3f13682a,0x3f0f8784,0x3f0b9a6b,0x3f07a136,0x3ee0924f,0x3ed6a399,0x3ecc9b8b,0x3ec27b55
.long 0x3e94a031,0x3e888e93,0x3e78cfcc,0x3e605c13,0x3e09cf86,0x3ddb7d37,0x3da3308c,0x3d55880e
.long 0xbcc90ab0,0xbd621469,0xbdafb680,0xbdee3876,0xbe3b6ecf,0xbe5d4b1a,0xbe7ee6e1,0xbe901c2c
.long 0xbeac7cd4,0xbebe1d4a,0xbecf7bca,0xbee0924f,0xbef6e0cb,0xbf044889,0xbf0cead0,0xbf1553b7
.long 0xbf1d7fd1,0xbf26050a,0xbf2e3bde,0xbf36206c,0xbf3b8f3b,0xbf436051,0xbf4ac77f,0xbf51c0c2
.long 0xbf54db31,0xbf5b941a,0xbf61c598,0xbf676bd8,0xbf68bf3c,0xbf6dfcf2,0xbf7294f8,0xbf76841b
.long 0xbf76ba07,0xbf7a1e84,0xbf7cbfc9,0xbf7e9bc9,0xbf7e70b0,0xbf7fa6e3,0xbf7ffec4,0xbf7f7808
.long 0xbf7fb10f,0xbf7e70b0,0xbf7c3b28,0xbf791298,0xbf7a7302,0xbf76841b,0xbf718f57,0xbf6b99fb
.long 0xbf6ed89e,0xbf6816a8,0xbf604621,0xbf577026,0xbf5d2d53,0xbf5389c7,0xbf48d8b3,0xbf3d27b8
.long 0xbf45e403,0xbf396842,0xbf2beb4a,0xbf1d7fd1,0xbf299415,0xbf1a6293,0xbf0a48ad,0xbef2bd43
.long 0xbf08f59b,0xbeee9479,0xbec9b953,0xbea395c5,0xbec9b953,0xbea21887,0xbe72b651,0xbe1f917b
.long 0xbe78cfcc,0xbe22abb6,0xbd96a905,0x3c490e90,0xbdafb680,0x3b490fc6,0x3dbc3ac3,0x3e3857ec
.long 0x3d96a905,0x3e28defc,0x3e827dc0,0x3eaf713a,0x3e6c9a7f,0x3ea5129f,0x3ed25a09,0x3efdbabb
.long 0x3f800000,0x3f800000,0x3f800000,0x3f800000,0x3f7c3b28,0x3f7c187a,0x3f7bf531,0x3f7bd14d
.long 0x3f710908,0x3f708066,0x3f6ff573,0x3f6f6830,0x3f5ebe05,0x3f5d924d,0x3f5c61c7,0x3f5b2c79
.long 0x3f45e403,0x3f43e200,0x3f41d870,0x3f3fc767,0x3f273656,0x3f24381a,0x3f212ff9,0x3f1e1e22
.long 0x3f039c3d,0x3eff17b2,0x3ef6e0cb,0x3eee9479,0x3eb8442a,0x3eadf73c,0x3ea395c5,0x3e9920fe
.long 0x3e47c5c2,0x3e2f10a2,0x3e164083,0x3dfab273,0x3cc90ab0,0xbb490fc6,0xbcfb49ba,0xbd6ea038
.long 0xbe164083,0xbe354098,0xbe541501,0xbe72b651,0xbea09ae5,0xbeb0eacb,0xbec1071e,0xbed0eb2a
.long 0xbef15aea,0xbf00e7e4,0xbf08f59b,0xbf10d3cd,0xbf1d7fd1,0xbf256bcb,0xbf2d1469,0xbf34768f
.long 0xbf3daef9,0xbf44e3f5,0xbf4bbbf8,0xbf5233c6,0xbf584853,0xbf5e5aa6,0xbf63f473,0xbf6912ae
.long 0xbf6c835e,0xbf710908,0xbf74fa0b,0xbf7853f8,0xbf79c79d,0xbf7c5d3a,0xbf7e4323,0xbf7f7808
.long 0xbf7fb10f,0xbf7ffec4,0xbf7f84ab,0xbf7e4323,0xbf7e1324,0xbf7bd14d,0xbf78b47b,0xbf74bf62
.long 0xbf74fa0b,0xbf6ff573,0xbf6a09a7,0xbf633c5a,0xbf64aa59,0xbf5cc7d1,0xbf53fac3,0xbf4a4c87
.long 0xbf4d9f02,0xbf42de29,0xbf373a23,0xbf2ac082,0xbf3085bb,0xbf2302d3,0xbf14b039,0xbf05a02c
.long 0xbf0e39da,0xbefc5d27,0xbedae880,0xbeb8442a,0xbecf7bca,0xbeab0201,0xbe8586ce,0xbe3e853e
.long 0xbe78cfcc,0xbe28defc,0xbdafb680,0xbbc90f88,0xbd96a905,0x3c16cb58,0x3dbc3ac3,0x3e3228d4
.long 0x3dc8bd36,0x3e3b6ecf,0x3e888e93,0x3eb263ef,0x3e888e93,0x3eb3dca5,0x3eddbe79,0x3f02ef9f
.long 0x3edae880,0x3f0242b1,0x3f15f6d9,0x3f286605,0x3f13682a,0x3f269de3,0x3f385216,0x3f485bca
.long 0x3f800000,0x3f800000,0x3f800000,0x3f800000,0x3f7baccd,0x3f7b87b2,0x3f7b61fc,0x3f7b3bab
.long 0x3f6ed89e,0x3f6e46be,0x3f6db293,0x3f6d1c1d,0x3f59f26a,0x3f58b3a1,0x3f577026,0x3f5627fe
.long 0x3f3daef9,0x3f3b8f3b,0x3f396842,0x3f373a23,0x3f1b02c6,0x3f17de12,0x3f14b039,0x3f11796b
.long 0x3ee63375,0x3eddbe79,0x3ed53641,0x3ecc9b8b,0x3e8e9a22,0x3e840270,0x3e72b651,0x3e5d4b1a
.long 0x3dc8bd36,0x3d96a905,0x3d48fb30,0x3cc90ab0,0xbdafb680,0xbde7fa9a,0xbe1008b7,0xbe2bf804
.long 0xbe888e93,0xbe97a117,0xbea68f12,0xbeb554ec,0xbee0924f,0xbeeff7fb,0xbeff17b2,0xbf06f686
.long 0xbf187fc0,0xbf1ff6cb,0xbf273656,0xbf2e3bde,0xbf3b8f3b,0xbf425b89,0xbf48d8b3,0xbf4f0417
.long 0xbf584853,0xbf5df6be,0xbf633c5a,0xbf6816a8,0xbf6db293,0xbf71d19f,0xbf756d97,0xbf788486
.long 0xbf7b14be,0xbf7d3aac,0xbf7ec46d,0xbf7fb10f,0xbf7ffb11,0xbf7fcbe2,0xbf7eea9d,0xbf7d57de
.long 0xbf7c3b28,0xbf796e4e,0xbf75dec6,0xbf718f57,0xbf6ff573,0xbf6a5ad9,0xbf63f473,0xbf5cc7d1
.long 0xbf5b941a,0xbf531849,0xbf49d112,0xbf3fc767,0xbf3fc767,0xbf34768f,0xbf286605,0xbf1ba299
.long 0xbf1d7fd1,0xbf0f8784,0xbf00e7e4,0xbee363fa,0xbeebcbbb,0xbecb2aae,0xbea986c4,0xbe870ada
.long 0xbe94a031,0xbe605c13,0xbe164083,0xbd96a905,0xbde1bc2e,0xbd0a342f,0x3d2fe007,0x3df475c0
.long 0x3d96a905,0x3e1c76de,0x3e6c9a7f,0x3e9d9e78,0x3e827dc0,0x3eab0201,0x3ed25a09,0x3ef840c8
.long 0x3edae880,0x3f00e7e4,0x3f13682a,0x3f24d225,0x3f15f6d9,0x3f27ce61,0x3f385216,0x3f476085
.long 0x3f396842,0x3f48d8b3,0x3f5695e5,0x3f628210,0x3f5695e5,0x3f62df7b,0x3f6d1c1d,0x3f75341d
.long 0x0,0x0,0x0,0x0,0x3dc8bd36,0x3dcefdb7,0x3dd53db9,0x3ddb7d37
.long 0x3e47c5c2,0x3e4dee60,0x3e541501,0x3e5a3997,0x3e94a031,0x3e9920fe,0x3e9d9e78,0x3ea21887
.long 0x3ec3ef15,0x3ec9b953,0x3ecf7bca,0x3ed53641,0x3ef15aea,0x3ef840c8,0x3eff17b2,0x3f02ef9f
.long 0x3f0e39da,0x3f121eb0,0x3f15f6d9,0x3f19c200,0x3f226799,0x3f269de3,0x3f2ac082,0x3f2ecef7
.long 0x3f3504f3,0x3f396842,0x3f3daef9,0x3f41d870,0x3f45e403,0x3f4a4c87,0x3f4e8d90,0x3f52a649
.long 0x3f54db31,0x3f591e6a,0x3f5d2d53,0x3f6106f2,0x3f61c598,0x3f65b710,0x3f696591,0x3f6cd007
.long 0x3f6c835e,0x3f6ff573,0x3f731447,0x3f75dec6,0x3f74fa0b,0x3f77beb7,0x3f7a1e84,0x3f7c187a
.long 0x3f7b14be,0x3f7cfe73,0x3f7e70b0,0x3f7f6ac7,0x3f7ec46d,0x3f7fa6e3,0x3f7ffec4,0x3f7fcbe2
.long 0x3f800000,0x3f7fb10f,0x3f7ec46d,0x3f7d3aac,0x3f7ec46d,0x3f7d1cdd,0x3f7ac516,0x3f77beb7
.long 0x3f7b14be,0x3f77f110,0x3f740bdd,0x3f6f6830,0x3f74fa0b,0x3f703b37,0x3f6aab7b,0x3f644fac
.long 0x3f6c835e,0x3f660f88,0x3f5ebe05,0x3f5695e5,0x3f61c598,0x3f5988ad,0x3f5064af,0x3f466354
.long 0x3f54db31,0x3f4ac77f,0x3f3fc767,0x3f33e7bc,0x3f45e403,0x3f39f2ac,0x3f2d1469,0x3f1f599f
.long 0x3f3504f3,0x3f273656,0x3f187fc0,0x3f08f59b,0x3f226799,0x3f12c39a,0x3f0242b1,0x3ee1fb6a
.long 0x3f0e39da,0x3ef9a02d,0x3ed53641,0x3eaf713a,0x3ef15aea,0x3ecb2aae,0x3ea395c5,0x3e75c35a
.long 0x3ec3ef15,0x3e9aa086,0x3e605c13,0x3e09cf86,0x3e94a031,0x3e5101f1,0x3dee3876,0x3ce22a7a
.long 0x3e47c5c2,0x3dd53db9,0x3c490e90,0xbda3308c,0x3dc8bd36,0x3b490fc6,0xbdbc3ac3,0xbe3e853e
.long 0x0,0x0,0x0,0x0,0x3de1bc2e,0x3de7fa9a,0x3dee3876,0x3df475c0
.long 0x3e605c13,0x3e667c66,0x3e6c9a7f,0x3e72b651,0x3ea68f12,0x3eab0201,0x3eaf713a,0x3eb3dca5
.long 0x3edae880,0x3ee0924f,0x3ee63375,0x3eebcbbb,0x3f064b82,0x3f099f4e,0x3f0cead0,0x3f102dd5
.long 0x3f1d7fd1,0x3f212ff9,0x3f24d225,0x3f286605,0x3f32c8c9,0x3f36ad7f,0x3f3a7ca4,0x3f3e35c5
.long 0x3f45e403,0x3f49d112,0x3f4d9f02,0x3f514d3d,0x3f5695e5,0x3f5a5ba0,0x3f5df6be,0x3f61668a
.long 0x3f64aa59,0x3f6816a8,0x3f6b4b0c,0x3f6e46be,0x3f6ff573,0x3f72d4eb,0x3f756d97,0x3f77beb7
.long 0x3f7853f8,0x3f7a7302,0x3f7c3b28,0x3f7dabcc,0x3f7dabcc,0x3f7ed7d4,0x3f7f9c18,0x3f7ff84a
.long 0x3f7fec43,0x3f7ff4e6,0x3f7f84ab,0x3f7e9bc9,0x3f7f0e58,0x3f7dc68c,0x3f7bf531,0x3f799b43
.long 0x3f7b14be,0x3f7853f8,0x3f74fa0b,0x3f710908,0x3f740bdd,0x3f6faf1b,0x3f6aab7b,0x3f650479
.long 0x3f6a09a7,0x3f63f473,0x3f5d2d53,0x3f55b993,0x3f5d2d53,0x3f554aa4,0x3f4cae79,0x3f436051
.long 0x3f4d9f02,0x3f43e200,0x3f396842,0x3f2e3bde,0x3f3b8f3b,0x3f2ff3e6,0x3f239da9,0x3f16999f
.long 0x3f273656,0x3f19c200,0x3f0b9a6b,0x3ef9a02d,0x3f10d3cd,0x3f019573,0x3ee363fa,0x3ec27b55
.long 0x3ef15aea,0x3ecf7bca,0x3eac7cd4,0x3e888e93,0x3ebe1d4a,0x3e9920fe,0x3e667c66,0x3e195be0
.long 0x3e888e93,0x3e419b37,0x3de1bc2e,0x3cfb49ba,0x3e22abb6,0x3d9cecf9,0xbbc90f88,0xbdb5f8da
.long 0x3d48fb30,0xbd16c32c,0xbdfab273,0xbe541501,0xbd7b2b74,0xbe195be0,0xbe72b651,0xbea5129f
.long 0xbe2f10a2,0xbe8586ce,0xbeb263ef,0xbeddbe79,0xbe8e9a22,0xbebca7af,0xbee900b7,0xbf099f4e
.long 0x0,0x0,0x0,0x0,0x3dfab273,0x3e007745,0x3e039502,0x3e06b26e
.long 0x3e78cfcc,0x3e7ee6e1,0x3e827dc0,0x3e8586ce,0x3eb8442a,0x3ebca7af,0x3ec1071e,0x3ec5625c
.long 0x3ef15aea,0x3ef6e0cb,0x3efc5d27,0x3f00e7e4,0x3f13682a,0x3f16999f,0x3f19c200,0x3f1ce11f
.long 0x3f2beb4a,0x3f2f61a5,0x3f32c8c9,0x3f36206c,0x3f41d870,0x3f456439,0x3f48d8b3,0x3f4c3578
.long 0x3f54db31,0x3f584853,0x3f5b941a,0x3f5ebe05,0x3f64aa59,0x3f67c187,0x3f6aab7b,0x3f6d67a1
.long 0x3f710908,0x3f73913f,0x3f75dec6,0x3f77f110,0x3f79c79d,0x3f7b87b2,0x3f7cfe73,0x3f7e2b72
.long 0x3f7ec46d,0x3f7f84ab,0x3f7fec43,0x3f7ffb11,0x3f7fec43,0x3f7f7808,0x3f7e9bc9,0x3f7d57de
.long 0x3f7d3aac,0x3f7b61fc,0x3f791298,0x3f764d97,0x3f76ba07,0x3f73530e,0x3f6f6830,0x3f6afb8c
.long 0x3f6c835e,0x3f676bd8,0x3f61c598,0x3f5b941a,0x3f5ebe05,0x3f57dc7f,0x3f5064af,0x3f485bca
.long 0x3f4d9f02,0x3f44e3f5,0x3f3b8f3b,0x3f31a81d,0x3f396842,0x3f2ecef7,0x3f239da9,0x3f17de12
.long 0x3f226799,0x3f15f6d9,0x3f08f59b,0x3ef6e0cb,0x3f08f59b,0x3ef58035,0x3ed8106b,0x3eb9bb1e
.long 0x3edae880,0x3ebb31a0,0x3e9aa086,0x3e72b651,0x3ea09ae5,0x3e7bdba4,0x3e354098,0x3ddb7d37
.long 0x3e47c5c2,0x3dfab273,0x3d48fb30,0xbcc90ab0,0x3d96a905,0xbb490fc6,0xbda3308c,0xbe1f917b
.long 0xbd48fb30,0xbe039502,0xbe541501,0xbe919ddd,0xbe2f10a2,0xbe80f8c0,0xbea986c4,0xbed0eb2a
.long 0xbe94a031,0xbebe1d4a,0xbee63375,0xbf064b82,0xbecf7bca,0xbef840c8,0xbf0f8784,0xbf21cbfb
.long 0xbf039c3d,0xbf173c07,0xbf299415,0xbf3a7ca4,0xbf1d7fd1,0xbf2ff3e6,0xbf40d0da,0xbf4fefa8
.long 0x0,0x0,0x0,0x0,0x3e09cf86,0x3e0cec4a,0x3e1008b7,0x3e1324ca
.long 0x3e888e93,0x3e8b9507,0x3e8e9a22,0x3e919ddd,0x3ec9b953,0x3ece0bea,0x3ed25a09,0x3ed6a399
.long 0x3f039c3d,0x3f064b82,0x3f08f59b,0x3f0b9a6b,0x3f1ff6cb,0x3f2302d3,0x3f26050a,0x3f28fd41
.long 0x3f396842,0x3f3ca003,0x3f3fc767,0x3f42de29,0x3f4f7a1f,0x3f52a649,0x3f55b993,0x3f58b3a1
.long 0x3f61c598,0x3f64aa59,0x3f676bd8,0x3f6a09a7,0x3f6ff573,0x3f725470,0x3f748422,0x3f76841b
.long 0x3f79c79d,0x3f7b61fc,0x3f7cbfc9,0x3f7de0b1,0x3f7f0e58,0x3f7fa6e3,0x3f7ff4e6,0x3f7ff84a
.long 0x3f7fb10f,0x3f7f0e58,0x3f7e1324,0x3f7cbfc9,0x3f7baccd,0x3f799b43,0x3f772417,0x3f74484b
.long 0x3f731447,0x3f6f6830,0x3f6b4b0c,0x3f66becc,0x3f660f88,0x3f60a6cf,0x3f5ac450,0x3f546b3b
.long 0x3f54db31,0x3f4d9f02,0x3f45e403,0x3f3daef9,0x3f3fc767,0x3f36ad7f,0x3f2d1469,0x3f2302d3
.long 0x3f273656,0x3f1c420c,0x3f10d3cd,0x3f04f484,0x3f0b9a6b,0x3efdbabb,0x3ee363fa,0x3ec8477c
.long 0x3edae880,0x3ebe1d4a,0x3ea09ae5,0x3e827dc0,0x3e9aa086,0x3e75c35a,0x3e354098,0x3de7fa9a
.long 0x3e2f10a2,0x3dd53db9,0x3d16c32c,0xbcfb49ba,0x3d16c32c,0xbd0a342f,0xbdd53db9,0xbe3228d4
.long 0xbdc8bd36,0xbe2f10a2,0xbe78cfcc,0xbea09ae5,0xbe6c9a7f,0xbe9c1faf,0xbec1071e,0xbee4cbfe
.long 0xbeb8442a,0xbeddbe79,0xbf00e7e4,0xbf121eb0,0xbef6e0cb,0xbf0d9281,0xbf1ebc12,0xbf2ecef7
.long 0xbf187fc0,0xbf299415,0xbf396842,0xbf47de65,0xbf32c8c9,0xbf425b89,0xbf5064af,0xbf5cc7d1
.long 0xbf49d112,0xbf577026,0xbf633c5a,0xbf6d1c1d,0xbf5d2d53,0xbf686b39,0xbf718f57,0xbf788486
.long 0x0,0x0,0x0,0x0,0x3e164083,0x3e195be0,0x3e1c76de,0x3e1f917b
.long 0x3e94a031,0x3e97a117,0x3e9aa086,0x3e9d9e78,0x3edae880,0x3edf28a9,0x3ee363fa,0x3ee79a5d
.long 0x3f0e39da,0x3f10d3cd,0x3f13682a,0x3f15f6d9,0x3f2beb4a,0x3f2ecef7,0x3f31a81d,0x3f34768f
.long 0x3f45e403,0x3f48d8b3,0x3f4bbbf8,0x3f4e8d90,0x3f5b941a,0x3f5e5aa6,0x3f6106f2,0x3f6398ac
.long 0x3f6c835e,0x3f6ed89e,0x3f710908,0x3f731447,0x3f7853f8,0x3f79f35e,0x3f7b61fc,0x3f7c9f8a
.long 0x3f7ec46d,0x3f7f6ac7,0x3f7fd397,0x3f7ffec4,0x3f7fb10f,0x3f7f1f49,0x3f7e4323,0x3f7d1cdd
.long 0x3f7b14be,0x3f791298,0x3f76ba07,0x3f740bdd,0x3f710908,0x3f6d67a1,0x3f696591,0x3f650479
.long 0x3f61c598,0x3f5c61c7,0x3f5695e5,0x3f5064af,0x3f4d9f02,0x3f466354,0x3f3ebc1b,0x3f36ad7f
.long 0x3f3504f3,0x3f2beb4a,0x3f226799,0x3f187fc0,0x3f187fc0,0x3f0d9281,0x3f0242b1,0x3eed3063
.long 0x3ef15aea,0x3ed8106b,0x3ebe1d4a,0x3ea395c5,0x3eac7cd4,0x3e901c2c,0x3e667c66,0x3e2bf804
.long 0x3e47c5c2,0x3e09cf86,0x3d96a905,0x3c490e90,0x3d48fb30,0xbc7b514b,0xbda3308c,0xbe1324ca
.long 0xbdc8bd36,0xbe28defc,0xbe6c9a7f,0xbe97a117,0xbe78cfcc,0xbe9f1cdf,0xbec1071e,0xbee1fb6a
.long 0xbec3ef15,0xbee63375,0xbf039c3d,0xbf13682a,0xbf039c3d,0xbf140c5f,0xbf239da9,0xbf3238aa
.long 0xbf226799,0xbf31a81d,0xbf3fc767,0xbf4cae79,0xbf3daef9,0xbf4b41fa,0xbf577026,0xbf62241a
.long 0xbf54db31,0xbf604621,0xbf6a09a7,0xbf721352,0xbf676bd8,0xbf703b37,0xbf772417,0xbf7c187a
.long 0xbf74fa0b,0xbf7ac516,0xbf7e70b0,0xbf7ff4e6,0xbf7d3aac,0xbf7fa6e3,0xbf7fc38f,0xbf7d906e
.long 0x0,0x0,0x0,0x0,0x3e22abb6,0x3e25c58c,0x3e28defc,0x3e2bf804
.long 0x3ea09ae5,0x3ea395c5,0x3ea68f12,0x3ea986c4,0x3eebcbbb,0x3eeff7fb,0x3ef41f07,0x3ef840c8
.long 0x3f187fc0,0x3f1b02c6,0x3f1d7fd1,0x3f1ff6cb,0x3f373a23,0x3f39f2ac,0x3f3ca003,0x3f3f41fc
.long 0x3f514d3d,0x3f53fac3,0x3f5695e5,0x3f591e6a,0x3f660f88,0x3f686b39,0x3f6aab7b,0x3f6cd007
.long 0x3f74fa0b,0x3f76ba07,0x3f7853f8,0x3f79c79d,0x3f7dabcc,0x3f7e868b,0x3f7f2f9d,0x3f7fa6e3
.long 0x3f7fec43,0x3f7f9c18,0x3f7f0e58,0x3f7e4323,0x3f7baccd,0x3f79f35e,0x3f77f110,0x3f75a67b
.long 0x3f710908,0x3f6db293,0x3f6a09a7,0x3f660f88,0x3f604621,0x3f5b2c79,0x3f55b993,0x3f4fefa8
.long 0x3f49d112,0x3f42de29,0x3f3b8f3b,0x3f33e7bc,0x3f2e3bde,0x3f256bcb,0x3f1c420c,0x3f12c39a
.long 0x3f0e39da,0x3f039c3d,0x3ef15aea,0x3edae880,0x3ed53641,0x3ebca7af,0x3ea395c5,0x3e8a11f7
.long 0x3e888e93,0x3e5a3997,0x3e22abb6,0x3dd53db9,0x3de1bc2e,0x3d55880e,0xbbc90f88,0xbd83db0a
.long 0xbd48fb30,0xbde1bc2e,0xbe2f10a2,0xbe6c9a7f,0xbe541501,0xbe8a11f7,0xbea986c4,0xbec8477c
.long 0xbeb8442a,0xbed8106b,0xbef6e0cb,0xbf0a48ad,0xbf00e7e4,0xbf102dd5,0xbf1ebc12,0xbf2c800f
.long 0xbf226799,0xbf3085bb,0xbf3daef9,0xbf49d112,0xbf3fc767,0xbf4c3578,0xbf577026,0xbf61668a
.long 0xbf584853,0xbf628210,0xbf6b4b0c,0xbf7294f8,0xbf6b4b0c,0xbf72d4eb,0xbf78b47b,0xbf7cdf6c
.long 0xbf7853f8,0xbf7cbfc9,0xbf7f4e6d,0xbf7ffb11,0xbf7f0e58,0xbf7fffb1,0xbf7eea9d,0xbf7bd14d
.long 0xbf7f4e6d,0xbf7c7eb0,0xbf778bc5,0xbf708066,0xbf791298,0xbf725470,0xbf696591,0xbf5e5aa6
.long 0x0,0x0,0x0,0x0,0x3e2f10a2,0x3e3228d4,0x3e354098,0x3e3857ec
.long 0x3eac7cd4,0x3eaf713a,0x3eb263ef,0x3eb554ec,0x3efc5d27,0x3f003a06,0x3f0242b1,0x3f044889
.long 0x3f226799,0x3f24d225,0x3f273656,0x3f299415,0x3f41d870,0x3f446337,0x3f46e22a,0x3f495521
.long 0x3f5b941a,0x3f5df6be,0x3f604621,0x3f628210,0x3f6ed89e,0x3f70c501,0x3f7294f8,0x3f74484b
.long 0x3f7b14be,0x3f7c3b28,0x3f7d3aac,0x3f7e1324,0x3f7fec43,0x3f7fffb1,0x3f7fe129,0x3f7f90b1
.long 0x3f7d3aac,0x3f7bf531,0x3f7a7302,0x3f78b47b,0x3f731447,0x3f703b37,0x3f6d1c1d,0x3f69b7e4
.long 0x3f61c598,0x3f5d2d53,0x3f584853,0x3f531849,0x3f49d112,0x3f436051,0x3f3ca003,0x3f3592e7
.long 0x3f2beb4a,0x3f239da9,0x3f1b02c6,0x3f121eb0,0x3f08f59b,0x3efdbabb,0x3ee900b7,0x3ed3c867
.long 0x3ec3ef15,0x3eac7cd4,0x3e94a031,0x3e78cfcc,0x3e605c13,0x3e2bf804,0x3dee3876,0x3d83db0a
.long 0x3d48fb30,0xbbc90f88,0xbd7b2b74,0xbdee3876,0xbdfab273,0xbe3857ec,0xbe72b651,0xbe9620d2
.long 0xbe94a031,0xbeb263ef,0xbecf7bca,0xbeebcbbb,0xbee63375,0xbf019573,0xbf0f8784,0xbf1ce11f
.long 0xbf187fc0,0xbf26050a,0xbf32c8c9,0xbf3ebc1b,0xbf396842,0xbf456439,0xbf5064af,0xbf5a5ba0
.long 0xbf54db31,0xbf5ebe05,0xbf676bd8,0xbf6ed89e,0xbf6a09a7,0xbf714c7a,0xbf772417,0xbf7b87b2
.long 0xbf7853f8,0xbf7c7eb0,0xbf7f0e58,0xbf7ffec4,0xbf7f4e6d,0xbf7ffd39,0xbf7eea9d,0xbf7c187a
.long 0xbf7ec46d,0xbf7baccd,0xbf76ba07,0xbf6ff573,0xbf76ba07,0xbf6faf1b,0xbf66becc,0xbf5bfb34
.long 0xbf676bd8,0xbf5c61c7,0xbf4f7a1f,0xbf40d0da,0xbf514d3d,0xbf425b89,0xbf31a81d,0xbf1f599f
.long 0x0,0x0,0x0,0x0,0x3e3b6ecf,0x3e3e853e,0x3e419b37,0x3e44b0b9
.long 0x3eb8442a,0x3ebb31a0,0x3ebe1d4a,0x3ec1071e,0x3f064b82,0x3f084b92,0x3f0a48ad,0x3f0c42c9
.long 0x3f2beb4a,0x3f2e3bde,0x3f3085bb,0x3f32c8c9,0x3f4bbbf8,0x3f4e1689,0x3f5064af,0x3f52a649
.long 0x3f64aa59,0x3f66becc,0x3f68bf3c,0x3f6aab7b,0x3f75dec6,0x3f77583a,0x3f78b47b,0x3f79f35e
.long 0x3f7ec46d,0x3f7f4e6d,0x3f7fb10f,0x3f7fec43,0x3f7f0e58,0x3f7e5a38,0x3f7d7474,0x3f7c5d3a
.long 0x3f76ba07,0x3f748422,0x3f721352,0x3f6f6830,0x3f660f88,0x3f62241a,0x3f5df6be,0x3f5988ad
.long 0x3f4d9f02,0x3f47de65,0x3f41d870,0x3f3b8f3b,0x3f2e3bde,0x3f269de3,0x3f1ebc12,0x3f16999f
.long 0x3f08f59b,0x3eff17b2,0x3eebcbbb,0x3ed8106b,0x3ebe1d4a,0x3ea80b1f,0x3e919ddd,0x3e75c35a
.long 0x3e47c5c2,0x3e164083,0x3dc8bd36,0x3d48fb30,0x3c490e90,0xbd2351cb,0xbdbc3ac3,0xbe1324ca
.long 0xbe2f10a2,0xbe667c66,0xbe8e9a22,0xbea986c4,0xbeb263ef,0xbece0bea,0xbee900b7,0xbf019573
.long 0xbf039c3d,0xbf10d3cd,0xbf1d7fd1,0xbf299415,0xbf299415,0xbf3592e7,0xbf40d0da,0xbf4b41fa
.long 0xbf49d112,0xbf53fac3,0xbf5d2d53,0xbf655e0b,0xbf633c5a,0xbf6afb8c,0xbf718f57,0xbf76ef5b
.long 0xbf74fa0b,0xbf79c79d,0xbf7d3aac,0xbf7f4e6d,0xbf7e70b0,0xbf7fdaaf,0xbf7fc38f,0xbf7e2b72
.long 0xbf7f4e6d,0xbf7cfe73,0xbf791298,0xbf73913f,0xbf778bc5,0xbf714c7a,0xbf696591,0xbf5fe4e9
.long 0xbf676bd8,0xbf5d2d53,0xbf514d3d,0xbf43e200,0xbf4f7a1f,0xbf4154e1,0xbf31a81d,0xbf209393
.long 0xbf3085bb,0xbf1ebc12,0xbf0b9a6b,0xbeee9479,0xbf0b9a6b,0xbeed3063,0xbec1071e,0xbe931f35
.size fft_tbl, 36864
.section .rodata,"a"
.p2align 6
.amdhsa_kernel gated_mix__spectral_fnet__mha_block__prompt_kernel
  .amdhsa_next_free_vgpr 168
  .amdhsa_next_free_sgpr 102
  .amdhsa_accum_offset 168
  .amdhsa_group_segment_fixed_size 0
  .amdhsa_kernarg_size 96
  .amdhsa_user_sgpr_count 2
  .amdhsa_user_sgpr_kernarg_segment_ptr 1
  .amdhsa_system_sgpr_workgroup_id_x 1
  .amdhsa_float_denorm_mode_32 3
.end_amdhsa_kernel
.text
```
